```python
import torch

def _softmax(x, axis=-1):
    return torch.softmax(x, dim=axis)
def _gelu(x):
    return torch.nn.functional.gelu(x, approximate="tanh")
def _silu(x):
    return torch.nn.functional.silu(x)
def _sigmoid(x):
    return torch.sigmoid(x)
def _layernorm(x, axis=-1, eps=1e-5):
    m = x.mean(dim=axis, keepdim=True)
    v = x.var(dim=axis, keepdim=True, unbiased=False)
    return (x - m) / torch.sqrt(v + eps)
def _scatter_add(tgt, idx, src, axis=0):
    return tgt.clone().index_add_(axis, idx, src)
def _segment_sum(src, seg, n):
    out = torch.zeros((n,) + src.shape[1:], dtype=src.dtype)
    return out.index_add_(0, seg, src)
def _pad(x, pw):
    flat = tuple(v for pair in reversed(pw) for v in pair)
    return torch.nn.functional.pad(x, flat)

kernel_name = 'parallel_sum__linear_attn_block__glu_gated_reglu__prompt'

def setup_inputs():

    _w = (lambda a: (lambda t: t.to(torch.bfloat16) if t.is_floating_point() else t)(torch.as_tensor(a)))
    def _A_setup():
        B, S, D = 1, 2048, 576
        return {
            "x": _w((lambda *s: torch.randn(*s, dtype=torch.bfloat16) * 0.05)(B, S, D)),
            "wqkv": _w((lambda *s: torch.randn(*s, dtype=torch.bfloat16) * 0.05)(D, 3 * D)),
            "wo": _w((lambda *s: torch.randn(*s, dtype=torch.bfloat16) * 0.05)(D, D)),
        }
    _A_in = _A_setup()

    def _B_setup():
        B, S, D, F = 1, 2048, 576, 4608
        return {
            "x": _w((lambda *s: torch.randn(*s, dtype=torch.bfloat16) * 0.05)(B, S, D)),
            "W_gate": _w((lambda *s: torch.randn(*s, dtype=torch.bfloat16) * 0.2)(D, F) * (2.0 / D) ** 0.5),
            "W_up": _w((lambda *s: torch.randn(*s, dtype=torch.bfloat16) * 0.2)(D, F) * (2.0 / D) ** 0.5),
            "W_down": _w((lambda *s: torch.randn(*s, dtype=torch.bfloat16) * 0.2)(F, D) * (1.0 / F) ** 0.5),
        }
    _B_in = _B_setup()

    return {
        "A_x": _A_in["x"],
        "A_wqkv": _A_in["wqkv"],
        "A_wo": _A_in["wo"],
        "B_x": _B_in["x"],
        "B_W_gate": _B_in["W_gate"],
        "B_W_up": _B_in["W_up"],
        "B_W_down": _B_in["W_down"],
    }

def reference(A_x, A_wqkv, A_wo, B_x, B_W_gate, B_W_up, B_W_down):
    def _A_ref(x, wqkv, wo):
        B, S, D = x.shape
        H = 32; Dh = D // H
        qkv = (lambda x, *d: x.permute(*d))((x @ wqkv).reshape(B, S, 3, H, Dh), 2, 0, 3, 1, 4)
        q, k, v = qkv[0], qkv[1], qkv[2]
        phi = lambda t: torch.where(t > 0, t + 1, torch.exp(t)) + 1e-6
        pq, pk = phi(q), phi(k)
        kv = torch.einsum("bhsd,bhse->bhde", pk, v)
        z = torch.einsum("bhsd->bhd", pk)
        num = torch.einsum("bhqd,bhde->bhqe", pq, kv)
        den = torch.einsum("bhqd,bhd->bhq", pq, z)[..., None] + 1e-6
        o = num / den
        return (lambda x, *d: x.permute(*d))(o, 0, 2, 1, 3).reshape(B, S, D) @ wo

    def _B_ref(x, W_gate, W_up, W_down):
        gate = torch.einsum("bsd,df->bsf", x, W_gate)
        up = torch.einsum("bsd,df->bsf", x, W_up)
        gate = gate * (lambda x, dt: x.to(dt))(gate > 0, gate.dtype)
        h = gate * up
        return torch.einsum("bsf,fd->bsd", h, W_down)

    x = A_x
    xn = _layernorm(x, axis=-1)
    return x + _A_ref(xn, A_wqkv, A_wo) + _B_ref(xn, B_W_gate, B_W_up, B_W_down)
```

```asm
; @launch grid=(256,1,1) block=(256,1,1) lds=163840
.amdgcn_target "amdgcn-amd-amdhsa--gfx950"
.text
.globl parallel_sum__linear_attn_block__glu_gated_reglu__prompt_kernel
.p2align 8
.type parallel_sum__linear_attn_block__glu_gated_reglu__prompt_kernel,@function
parallel_sum__linear_attn_block__glu_gated_reglu__prompt_kernel:
s_cmp_ge_u32 s2, 256
s_cbranch_scc1 L1_end
s_load_dwordx4 s[64:67], s[0:1], 0
s_load_dwordx2 s[68:69], s[0:1], 16
s_load_dwordx4 s[56:59], s[0:1], 32
s_load_dwordx4 s[60:63], s[0:1], 48
s_load_dwordx4 s[92:95], s[0:1], 64
v_lshrrev_b32 v1, 6, v0
v_and_b32 v0, 63, v0
v_readfirstlane_b32 s3, v1
s_getpc_b64 s[12:13]
L1_pc:
s_sub_u32 s12, s12, L1_pc-parallel_sum__linear_attn_block__glu_gated_reglu__prompt_kernel
s_subb_u32 s13, s13, 0
s_mov_b32 s14, L1_cend-parallel_sum__linear_attn_block__glu_gated_reglu__prompt_kernel
s_mov_b32 s15, 0x20000
s_lshr_b32 s45, s2, 1
s_and_b32 s45, s45, 0xfc
s_add_u32 s45, s45, s3
v_lshlrev_b32 v2, 6, v0
s_add_u32 s46, s45, 0
s_and_b32 s46, s46, 15
s_lshl_b32 s46, s46, 12
v_add_u32 v4, s46, v2
buffer_load_dword a255, v4, s[12:15], 0 offen
s_add_u32 s46, s45, 8
s_and_b32 s46, s46, 15
s_lshl_b32 s46, s46, 12
v_add_u32 v5, s46, v2
buffer_load_dword a255, v5, s[12:15], 0 offen
s_and_b32 s4, s2, 7
s_lshl_b32 s4, s4, 1
s_lshr_b32 s5, s2, 3
s_and_b32 s5, s5, 1
s_or_b32 s4, s4, s5
s_lshr_b32 s5, s2, 4
s_lshl_b32 s88, s5, 2
s_add_u32 s88, s88, s3
s_mul_i32 s88, s88, 36864
s_add_u32 s89, s88, 9216
s_add_u32 s90, s88, 18432
s_add_u32 s91, s88, 27648
s_lshr_b32 s6, s3, 1
s_and_b32 s7, s3, 1
v_lshrrev_b32 v250, 4, v0
v_and_b32 v251, 15, v0
v_bfe_u32 v252, v0, 2, 2
v_and_b32 v253, 3, v0
v_bfe_u32 v254, v0, 2, 3
v_lshrrev_b32 v255, 5, v0
v_lshrrev_b32 v248, 3, v0
v_and_b32 v247, 7, v0
v_mul_u32_u24 v200, 1152, v248
v_lshl_add_u32 v200, v247, 4, v200
s_waitcnt lgkmcnt(0)
s_mov_b32 s8, s64
s_mov_b32 s9, s65
s_mov_b32 s10, 2359296
s_mov_b32 s11, 0x20000
buffer_load_dwordx4 v[48:51], v200, s[8:11], s88 offen offset:0
buffer_load_dwordx4 v[52:55], v200, s[8:11], s89 offen offset:0
s_mov_b32 s12, s66
s_mov_b32 s13, s67
s_mov_b32 s14, 1990656
s_mov_b32 s15, 0x20000
s_lshl_b32 s44, s3, 10
s_mov_b32 s16, s56
s_mov_b32 s17, s57
s_mov_b32 s18, 5308416
s_mov_b32 s19, 0x20000
s_mov_b32 s20, s58
s_mov_b32 s21, s59
s_mov_b32 s22, 5308416
s_mov_b32 s23, 0x20000
s_lshl_b32 s46, s3, 6
v_add_u32 v96, s46, v0
v_min_u32 v97, 215, v96
v_lshrrev_b32 v99, 1, v97
v_mul_u32_u24 v99, 1152, v99
v_and_b32 v97, 1, v97
v_lshl_add_u32 v99, v97, 6, v99
s_mul_i32 s70, s5, 124416
s_mul_i32 s46, s4, 72
s_and_b32 s46, s46, 0xffffffc0
s_add_u32 s70, s70, s46
buffer_load_dword a255, v99, s[12:15], s70 offen
s_mov_b32 s36, s94
s_mov_b32 s37, s95
s_mov_b32 s38, 268435456
s_mov_b32 s39, 0x20000
s_mul_i32 s53, s4, 2359296
buffer_load_dwordx4 v[56:59], v200, s[8:11], s90 offen offset:0
s_mul_i32 s45, s5, 147456
s_add_u32 s53, s53, s45
s_add_u32 s100, s53, s44
v_lshlrev_b32 v23, 4, v0
v_min_u32 v97, 179, v96
v_mul_u32_u24 v98, 13108, v97
v_lshrrev_b32 v98, 16, v98
v_mul_u32_u24 v98, 8576, v98
v_lshl_add_u32 v98, v97, 7, v98
s_mul_i32 s71, s5, 331776
s_mul_i32 s46, s4, 576
s_and_b32 s46, s46, 0xffffff80
s_add_u32 s71, s71, s46
v_lshlrev_b32 v98, 7, v96
v_min_u32 v98, 20608, v98
s_mul_i32 s71, s2, 20736
v_lshlrev_b32 v240, 2, v250
v_sub_u32 v240, v251, v240
s_lshl_b32 s45, s6, 1
v_subrev_u32 v240, s45, v240
v_and_b32 v240, 15, v240
v_min_u32 v240, 14, v240
v_mul_u32_u24 v241, 13, v240
v_lshrrev_b32 v241, 6, v241
v_mul_u32_u24 v242, 1072, v241
v_lshl_add_u32 v242, v240, 4, v242
s_mul_i32 s45, s3, 13824
s_mul_i32 s46, s4, 72
s_and_b32 s47, s46, 0xfffffff0
s_add_u32 s45, s45, s47
buffer_load_dwordx4 v[60:63], v200, s[8:11], s91 offen offset:0
v_mul_u32_u24 v1, 3456, v250
v_add3_u32 v1, v1, v242, s45
s_mov_b32 s32, s68
s_mov_b32 s33, s69
s_mov_b32 s34, 663552
s_mov_b32 s35, 0x20000
s_mov_b32 s28, s60
s_mov_b32 s29, s61
s_mov_b32 s30, 5308416
s_mov_b32 s31, 0x20000
s_mov_b32 s96, s62
s_mov_b32 s97, s63
s_mov_b32 s98, 2359296
s_mov_b32 s99, 0x20000
s_mov_b32 s40, s92
s_mov_b32 s41, s93
s_mov_b32 s42, 256
s_mov_b32 s43, 0x20000
s_cmp_eq_u32 s6, 0
s_cselect_b32 s24, s56, s58
s_cselect_b32 s25, s57, s59
s_mov_b32 s26, 5308416
s_mov_b32 s27, 0x20000
s_and_b32 s45, s4, 1
s_mul_i32 s48, s4, 576
s_lshl_b32 s46, s45, 6
s_xor_b32 s45, s45, 1
s_lshl_b32 s45, s45, 9
s_add_u32 s49, s48, s45
s_add_u32 s48, s48, s46
buffer_load_dwordx4 v[64:67], v200, s[8:11], s88 offen offset:128
s_mul_i32 s50, s48, 576
s_mul_i32 s51, s49, 576
s_mul_i32 s52, s4, 41472
s_lshl_b32 s55, s4, 16
s_add_u32 s55, s55, 50331648
s_lshl_b32 s45, s5, 12
s_add_u32 s54, s55, s45
s_mul_i32 s68, s4, 331776
s_mul_i32 s46, s5, 20736
s_add_u32 s68, s68, s46
s_mul_i32 s69, s5, 2688
s_add_u32 s69, s69, s52
s_lshl_b32 s45, s7, 1
v_xor_b32 v240, s45, v253
v_lshlrev_b32 v240, 4, v240
v_lshl_add_u32 v240, v255, 6, v240
s_mul_i32 s45, s3, 73728
v_mul_u32_u24 v2, 9216, v254
v_add3_u32 v2, v2, v240, s45
v_and_b32 v241, 3, v254
v_lshrrev_b32 v242, 2, v254
v_mul_u32_u24 v241, 1152, v241
v_add_u32 v241, v241, v240
s_mul_i32 s45, s3, 4608
v_mul_u32_u24 v4, 18432, v242
v_add3_u32 v4, v4, v241, s45
v_mul_u32_u24 v5, 23040, v242
v_add3_u32 v5, v5, v241, s45
s_lshl_b32 s45, s3, 28
s_add_u32 s45, s45, 18432
buffer_load_dwordx4 v[68:71], v200, s[8:11], s89 offen offset:128
v_add_u32 v6, s45, v241
v_lshrrev_b32 v241, 2, v0
v_mul_u32_u24 v3, 9216, v241
v_lshlrev_b32 v241, 1, v255
v_xor_b32 v241, v241, v253
v_lshl_add_u32 v3, v241, 4, v3
s_mul_i32 s45, s7, 147456
v_add_u32 v3, s45, v3
v_lshlrev_b32 v240, 6, v252
v_lshl_add_u32 v240, v253, 3, v240
v_and_b32 v241, 1, v250
s_lshl_b32 s45, s7, 9
s_add_u32 s45, s45, 49152
v_add_u32 v24, s45, v240
v_add_u32 v25, 65536, v24
v_lshl_add_u32 v7, v250, 10, v24
v_lshl_add_u32 v7, v241, 5, v7
v_xor_b32 v9, 32, v7
v_add_u32 v8, 65536, v7
v_add_u32 v10, 65536, v9
v_xor_b32 v242, s7, v241
v_lshl_add_u32 v11, v250, 9, v240
v_lshl_add_u32 v11, v242, 5, v11
v_add_u32 v11, 49152, v11
v_add_u32 v12, 65536, v11
v_lshl_add_u32 v242, v250, 3, v252
v_lshlrev_b32 v242, 8, v242
v_add_u32 v242, 49152, v242
v_lshlrev_b32 v243, 6, v252
v_lshl_add_u32 v243, v241, 5, v243
buffer_load_dwordx4 v[72:75], v200, s[8:11], s90 offen offset:128
s_mul_i32 s46, s4, 72
s_and_b32 s46, s46, 15
v_add_u32 v243, s46, v243
s_mul_i32 s46, s7, 40
v_lshl_add_u32 v244, v253, 3, v243
v_add_u32 v244, s46, v244
v_add_u32 v245, 0, v244
v_and_b32 v245, 255, v245
v_add_u32 v13, v245, v242
v_add_u32 v14, 65536, v13
v_add_u32 v245, 80, v244
v_and_b32 v245, 255, v245
v_add_u32 v15, v245, v242
v_add_u32 v16, 65536, v15
v_add_u32 v245, 160, v244
v_and_b32 v245, 255, v245
v_add_u32 v17, v245, v242
v_add_u32 v18, 65536, v17
v_min_u32 v245, 2, v253
v_mul_u32_u24 v245, 80, v245
v_add3_u32 v245, v245, v243, 32
v_and_b32 v245, 255, v245
v_add_u32 v19, v245, v242
v_add_u32 v20, 65536, v19
s_lshl_b32 s45, s3, 11
v_add_u32 v21, s45, v23
s_xor_b32 s45, s45, 2048
v_add_u32 v22, s45, v23
v_lshlrev_b32 v242, 2, v250
v_sub_u32 v242, v251, v242
buffer_load_dwordx4 v[76:79], v200, s[8:11], s91 offen offset:128
v_mov_b32 v26, 0
v_mov_b32 v27, 0
v_mov_b32 v30, 0
v_mov_b32 v31, 0
v_mov_b32 v243, 0x3f80
v_mov_b32 v244, 0x3f800000
v_cmp_eq_u32 vcc, 0, v242
s_nop 1
v_cndmask_b32 v28, v26, v243, vcc
v_cmp_eq_u32 vcc, 1, v242
s_nop 1
v_cndmask_b32 v28, v28, v244, vcc
v_cmp_eq_u32 vcc, 2, v242
s_nop 1
v_cndmask_b32 v29, v26, v243, vcc
v_cmp_eq_u32 vcc, 3, v242
s_nop 1
v_cndmask_b32 v29, v29, v244, vcc
s_cmp_eq_u32 s7, 0
s_cselect_b32 s56, 0xffff, 0
s_mov_b32 s57, 0
s_cselect_b32 s58, 0, 0xffff
s_mov_b32 s59, 0
s_mov_b32 s60, 0xf000f000
s_mov_b32 s61, 0xf000f000
s_mov_b32 s62, 0x3f803f80
s_mov_b32 s63, 0xffff0000
s_mov_b32 s64, 0x3fb8aa3b
s_mov_b32 s65, 0x3fb8aa3b
s_mov_b32 s66, 0x358637bd
s_mov_b32 s67, 0x358637bd
v_lshlrev_b32 v246, 1, v247
v_xor_b32 v246, v246, v248
v_lshlrev_b32 v246, 4, v246
v_lshl_add_u32 v246, v253, 8, v246
v_bfe_u32 v245, v0, 2, 1
v_lshl_add_u32 v246, v245, 13, v246
s_lshl_b32 s45, s3, 11
v_add_u32 v246, s45, v246
v_xor_b32 v245, 128, v246
v_lshlrev_b32 v247, 5, v250
v_xor_b32 v249, v247, v22
v_xor_b32 v247, v247, v21
v_xor_b32 v248, 128, v247
v_xor_b32 v250, 128, v249
v_mov_b32 v252, -1
v_mov_b32 v253, -1
v_mov_b32 v254, -1
v_mov_b32 v255, -1
v_mov_b32 v192, 0
v_mov_b32 v193, 0
v_mov_b32 v194, 0
v_mov_b32 v195, 0
v_mov_b32 v196, 0
v_mov_b32 v197, 0
v_mov_b32 v198, 0
v_mov_b32 v199, 0
buffer_load_dwordx4 v[80:83], v200, s[8:11], s88 offen offset:256
s_waitcnt vmcnt(9)
v_dot2_f32_bf16 v192, v48, s62, v192
v_dot2_f32_bf16 v193, v48, v48, v193
s_waitcnt vmcnt(8)
v_dot2_f32_bf16 v194, v52, s62, v194
v_dot2_f32_bf16 v195, v52, v52, v195
v_lshlrev_b32 v32, 16, v48
v_and_b32 v48, s63, v48
v_lshlrev_b32 v36, 16, v52
v_and_b32 v52, s63, v52
v_dot2_f32_bf16 v192, v49, s62, v192
v_dot2_f32_bf16 v193, v49, v49, v193
v_dot2_f32_bf16 v194, v53, s62, v194
v_dot2_f32_bf16 v195, v53, v53, v195
v_lshlrev_b32 v33, 16, v49
v_and_b32 v49, s63, v49
v_lshlrev_b32 v37, 16, v53
v_and_b32 v53, s63, v53
buffer_load_dwordx4 v[84:87], v200, s[8:11], s89 offen offset:256
v_dot2_f32_bf16 v192, v50, s62, v192
v_dot2_f32_bf16 v193, v50, v50, v193
v_dot2_f32_bf16 v194, v54, s62, v194
v_dot2_f32_bf16 v195, v54, v54, v195
v_lshlrev_b32 v34, 16, v50
v_and_b32 v50, s63, v50
v_lshlrev_b32 v38, 16, v54
v_and_b32 v54, s63, v54
v_dot2_f32_bf16 v192, v51, s62, v192
v_dot2_f32_bf16 v193, v51, v51, v193
v_dot2_f32_bf16 v194, v55, s62, v194
v_dot2_f32_bf16 v195, v55, v55, v195
v_lshlrev_b32 v35, 16, v51
v_and_b32 v51, s63, v51
v_lshlrev_b32 v39, 16, v55
v_and_b32 v55, s63, v55
buffer_load_dwordx4 v[88:91], v200, s[8:11], s90 offen offset:256
s_waitcnt vmcnt(8)
v_dot2_f32_bf16 v196, v56, s62, v196
v_dot2_f32_bf16 v197, v56, v56, v197
s_waitcnt vmcnt(7)
v_dot2_f32_bf16 v198, v60, s62, v198
v_dot2_f32_bf16 v199, v60, v60, v199
v_lshlrev_b32 v40, 16, v56
v_and_b32 v56, s63, v56
v_lshlrev_b32 v44, 16, v60
v_and_b32 v60, s63, v60
v_dot2_f32_bf16 v196, v57, s62, v196
v_dot2_f32_bf16 v197, v57, v57, v197
v_dot2_f32_bf16 v198, v61, s62, v198
v_dot2_f32_bf16 v199, v61, v61, v199
v_lshlrev_b32 v41, 16, v57
v_and_b32 v57, s63, v57
v_lshlrev_b32 v45, 16, v61
v_and_b32 v61, s63, v61
buffer_load_dwordx4 v[92:95], v200, s[8:11], s91 offen offset:256
v_dot2_f32_bf16 v196, v58, s62, v196
v_dot2_f32_bf16 v197, v58, v58, v197
v_dot2_f32_bf16 v198, v62, s62, v198
v_dot2_f32_bf16 v199, v62, v62, v199
v_lshlrev_b32 v42, 16, v58
v_and_b32 v58, s63, v58
v_lshlrev_b32 v46, 16, v62
v_and_b32 v62, s63, v62
v_dot2_f32_bf16 v196, v59, s62, v196
v_dot2_f32_bf16 v197, v59, v59, v197
v_dot2_f32_bf16 v198, v63, s62, v198
v_dot2_f32_bf16 v199, v63, v63, v199
v_lshlrev_b32 v43, 16, v59
v_and_b32 v59, s63, v59
v_lshlrev_b32 v47, 16, v63
v_and_b32 v63, s63, v63
buffer_load_dwordx4 v[112:115], v200, s[8:11], s88 offen offset:384
s_waitcnt vmcnt(8)
v_dot2_f32_bf16 v192, v64, s62, v192
v_dot2_f32_bf16 v193, v64, v64, v193
s_waitcnt vmcnt(7)
v_dot2_f32_bf16 v194, v68, s62, v194
v_dot2_f32_bf16 v195, v68, v68, v195
v_lshlrev_b32 v208, 16, v64
v_and_b32 v64, s63, v64
v_lshlrev_b32 v212, 16, v68
v_and_b32 v68, s63, v68
v_dot2_f32_bf16 v192, v65, s62, v192
v_dot2_f32_bf16 v193, v65, v65, v193
v_dot2_f32_bf16 v194, v69, s62, v194
v_dot2_f32_bf16 v195, v69, v69, v195
v_lshlrev_b32 v209, 16, v65
v_and_b32 v65, s63, v65
v_lshlrev_b32 v213, 16, v69
v_and_b32 v69, s63, v69
buffer_load_dwordx4 v[116:119], v200, s[8:11], s89 offen offset:384
v_dot2_f32_bf16 v192, v66, s62, v192
v_dot2_f32_bf16 v193, v66, v66, v193
v_dot2_f32_bf16 v194, v70, s62, v194
v_dot2_f32_bf16 v195, v70, v70, v195
v_lshlrev_b32 v210, 16, v66
v_and_b32 v66, s63, v66
v_lshlrev_b32 v214, 16, v70
v_and_b32 v70, s63, v70
v_dot2_f32_bf16 v192, v67, s62, v192
v_dot2_f32_bf16 v193, v67, v67, v193
v_dot2_f32_bf16 v194, v71, s62, v194
v_dot2_f32_bf16 v195, v71, v71, v195
v_lshlrev_b32 v211, 16, v67
v_and_b32 v67, s63, v67
v_lshlrev_b32 v215, 16, v71
v_and_b32 v71, s63, v71
buffer_load_dwordx4 v[120:123], v200, s[8:11], s90 offen offset:384
s_waitcnt vmcnt(8)
v_dot2_f32_bf16 v196, v72, s62, v196
v_dot2_f32_bf16 v197, v72, v72, v197
s_waitcnt vmcnt(7)
v_dot2_f32_bf16 v198, v76, s62, v198
v_dot2_f32_bf16 v199, v76, v76, v199
v_lshlrev_b32 v216, 16, v72
v_and_b32 v72, s63, v72
v_lshlrev_b32 v220, 16, v76
v_and_b32 v76, s63, v76
v_dot2_f32_bf16 v196, v73, s62, v196
v_dot2_f32_bf16 v197, v73, v73, v197
v_dot2_f32_bf16 v198, v77, s62, v198
v_dot2_f32_bf16 v199, v77, v77, v199
v_lshlrev_b32 v217, 16, v73
v_and_b32 v73, s63, v73
v_lshlrev_b32 v221, 16, v77
v_and_b32 v77, s63, v77
buffer_load_dwordx4 v[124:127], v200, s[8:11], s91 offen offset:384
v_dot2_f32_bf16 v196, v74, s62, v196
v_dot2_f32_bf16 v197, v74, v74, v197
v_dot2_f32_bf16 v198, v78, s62, v198
v_dot2_f32_bf16 v199, v78, v78, v199
v_lshlrev_b32 v218, 16, v74
v_and_b32 v74, s63, v74
v_lshlrev_b32 v222, 16, v78
v_and_b32 v78, s63, v78
v_dot2_f32_bf16 v196, v75, s62, v196
v_dot2_f32_bf16 v197, v75, v75, v197
v_dot2_f32_bf16 v198, v79, s62, v198
v_dot2_f32_bf16 v199, v79, v79, v199
v_lshlrev_b32 v219, 16, v75
v_and_b32 v75, s63, v75
v_lshlrev_b32 v223, 16, v79
v_and_b32 v79, s63, v79
buffer_load_dwordx4 v[128:131], v200, s[8:11], s88 offen offset:512
s_waitcnt vmcnt(8)
v_dot2_f32_bf16 v192, v80, s62, v192
v_dot2_f32_bf16 v193, v80, v80, v193
s_waitcnt vmcnt(7)
v_dot2_f32_bf16 v194, v84, s62, v194
v_dot2_f32_bf16 v195, v84, v84, v195
v_lshlrev_b32 v100, 16, v80
v_and_b32 v80, s63, v80
v_lshlrev_b32 v104, 16, v84
v_and_b32 v84, s63, v84
v_dot2_f32_bf16 v192, v81, s62, v192
v_dot2_f32_bf16 v193, v81, v81, v193
v_dot2_f32_bf16 v194, v85, s62, v194
v_dot2_f32_bf16 v195, v85, v85, v195
v_lshlrev_b32 v101, 16, v81
v_and_b32 v81, s63, v81
v_lshlrev_b32 v105, 16, v85
v_and_b32 v85, s63, v85
buffer_load_dwordx4 v[132:135], v200, s[8:11], s89 offen offset:512
v_dot2_f32_bf16 v192, v82, s62, v192
v_dot2_f32_bf16 v193, v82, v82, v193
v_dot2_f32_bf16 v194, v86, s62, v194
v_dot2_f32_bf16 v195, v86, v86, v195
v_lshlrev_b32 v102, 16, v82
v_and_b32 v82, s63, v82
v_lshlrev_b32 v106, 16, v86
v_and_b32 v86, s63, v86
v_dot2_f32_bf16 v192, v83, s62, v192
v_dot2_f32_bf16 v193, v83, v83, v193
v_dot2_f32_bf16 v194, v87, s62, v194
v_dot2_f32_bf16 v195, v87, v87, v195
v_lshlrev_b32 v103, 16, v83
v_and_b32 v83, s63, v83
v_lshlrev_b32 v107, 16, v87
v_and_b32 v87, s63, v87
buffer_load_dwordx4 v[136:139], v200, s[8:11], s90 offen offset:512
s_waitcnt vmcnt(8)
v_dot2_f32_bf16 v196, v88, s62, v196
v_dot2_f32_bf16 v197, v88, v88, v197
s_waitcnt vmcnt(7)
v_dot2_f32_bf16 v198, v92, s62, v198
v_dot2_f32_bf16 v199, v92, v92, v199
v_lshlrev_b32 v108, 16, v88
v_and_b32 v88, s63, v88
v_lshlrev_b32 v240, 16, v92
v_and_b32 v92, s63, v92
v_dot2_f32_bf16 v196, v89, s62, v196
v_dot2_f32_bf16 v197, v89, v89, v197
v_dot2_f32_bf16 v198, v93, s62, v198
v_dot2_f32_bf16 v199, v93, v93, v199
v_lshlrev_b32 v109, 16, v89
v_and_b32 v89, s63, v89
v_lshlrev_b32 v241, 16, v93
v_and_b32 v93, s63, v93
buffer_load_dwordx4 v[140:143], v200, s[8:11], s91 offen offset:512
v_dot2_f32_bf16 v196, v90, s62, v196
v_dot2_f32_bf16 v197, v90, v90, v197
v_dot2_f32_bf16 v198, v94, s62, v198
v_dot2_f32_bf16 v199, v94, v94, v199
v_lshlrev_b32 v110, 16, v90
v_and_b32 v90, s63, v90
v_lshlrev_b32 v242, 16, v94
v_and_b32 v94, s63, v94
v_dot2_f32_bf16 v196, v91, s62, v196
v_dot2_f32_bf16 v197, v91, v91, v197
v_dot2_f32_bf16 v198, v95, s62, v198
v_dot2_f32_bf16 v199, v95, v95, v199
v_lshlrev_b32 v111, 16, v91
v_and_b32 v91, s63, v91
v_lshlrev_b32 v243, 16, v95
v_and_b32 v95, s63, v95
buffer_load_dwordx4 v[144:147], v200, s[8:11], s88 offen offset:640
s_waitcnt vmcnt(8)
v_dot2_f32_bf16 v192, v112, s62, v192
v_dot2_f32_bf16 v193, v112, v112, v193
s_waitcnt vmcnt(7)
v_dot2_f32_bf16 v194, v116, s62, v194
v_dot2_f32_bf16 v195, v116, v116, v195
v_dot2_f32_bf16 v192, v113, s62, v192
v_dot2_f32_bf16 v193, v113, v113, v193
v_dot2_f32_bf16 v194, v117, s62, v194
v_dot2_f32_bf16 v195, v117, v117, v195
buffer_load_dwordx4 v[148:151], v200, s[8:11], s89 offen offset:640
v_dot2_f32_bf16 v192, v114, s62, v192
v_dot2_f32_bf16 v193, v114, v114, v193
v_dot2_f32_bf16 v194, v118, s62, v194
v_dot2_f32_bf16 v195, v118, v118, v195
v_dot2_f32_bf16 v192, v115, s62, v192
v_dot2_f32_bf16 v193, v115, v115, v193
v_dot2_f32_bf16 v194, v119, s62, v194
v_dot2_f32_bf16 v195, v119, v119, v195
buffer_load_dwordx4 v[152:155], v200, s[8:11], s90 offen offset:640
s_waitcnt vmcnt(8)
v_dot2_f32_bf16 v196, v120, s62, v196
v_dot2_f32_bf16 v197, v120, v120, v197
s_waitcnt vmcnt(7)
v_dot2_f32_bf16 v198, v124, s62, v198
v_dot2_f32_bf16 v199, v124, v124, v199
v_dot2_f32_bf16 v196, v121, s62, v196
v_dot2_f32_bf16 v197, v121, v121, v197
v_dot2_f32_bf16 v198, v125, s62, v198
v_dot2_f32_bf16 v199, v125, v125, v199
buffer_load_dwordx4 v[156:159], v200, s[8:11], s91 offen offset:640
v_dot2_f32_bf16 v196, v122, s62, v196
v_dot2_f32_bf16 v197, v122, v122, v197
v_dot2_f32_bf16 v198, v126, s62, v198
v_dot2_f32_bf16 v199, v126, v126, v199
v_dot2_f32_bf16 v196, v123, s62, v196
v_dot2_f32_bf16 v197, v123, v123, v197
v_dot2_f32_bf16 v198, v127, s62, v198
v_dot2_f32_bf16 v199, v127, v127, v199
buffer_load_dwordx4 v[160:163], v200, s[8:11], s88 offen offset:768
s_waitcnt vmcnt(8)
v_dot2_f32_bf16 v192, v128, s62, v192
v_dot2_f32_bf16 v193, v128, v128, v193
s_waitcnt vmcnt(7)
v_dot2_f32_bf16 v194, v132, s62, v194
v_dot2_f32_bf16 v195, v132, v132, v195
v_dot2_f32_bf16 v192, v129, s62, v192
v_dot2_f32_bf16 v193, v129, v129, v193
v_dot2_f32_bf16 v194, v133, s62, v194
v_dot2_f32_bf16 v195, v133, v133, v195
buffer_load_dwordx4 v[164:167], v200, s[8:11], s89 offen offset:768
v_dot2_f32_bf16 v192, v130, s62, v192
v_dot2_f32_bf16 v193, v130, v130, v193
v_dot2_f32_bf16 v194, v134, s62, v194
v_dot2_f32_bf16 v195, v134, v134, v195
v_dot2_f32_bf16 v192, v131, s62, v192
v_dot2_f32_bf16 v193, v131, v131, v193
v_dot2_f32_bf16 v194, v135, s62, v194
v_dot2_f32_bf16 v195, v135, v135, v195
buffer_load_dwordx4 v[168:171], v200, s[8:11], s90 offen offset:768
s_waitcnt vmcnt(8)
v_dot2_f32_bf16 v196, v136, s62, v196
v_dot2_f32_bf16 v197, v136, v136, v197
s_waitcnt vmcnt(7)
v_dot2_f32_bf16 v198, v140, s62, v198
v_dot2_f32_bf16 v199, v140, v140, v199
v_dot2_f32_bf16 v196, v137, s62, v196
v_dot2_f32_bf16 v197, v137, v137, v197
v_dot2_f32_bf16 v198, v141, s62, v198
v_dot2_f32_bf16 v199, v141, v141, v199
buffer_load_dwordx4 v[172:175], v200, s[8:11], s91 offen offset:768
v_dot2_f32_bf16 v196, v138, s62, v196
v_dot2_f32_bf16 v197, v138, v138, v197
v_dot2_f32_bf16 v198, v142, s62, v198
v_dot2_f32_bf16 v199, v142, v142, v199
v_dot2_f32_bf16 v196, v139, s62, v196
v_dot2_f32_bf16 v197, v139, v139, v197
v_dot2_f32_bf16 v198, v143, s62, v198
v_dot2_f32_bf16 v199, v143, v143, v199
buffer_load_dwordx4 v[176:179], v200, s[8:11], s88 offen offset:896
s_waitcnt vmcnt(8)
v_dot2_f32_bf16 v192, v144, s62, v192
v_dot2_f32_bf16 v193, v144, v144, v193
s_waitcnt vmcnt(7)
v_dot2_f32_bf16 v194, v148, s62, v194
v_dot2_f32_bf16 v195, v148, v148, v195
v_dot2_f32_bf16 v192, v145, s62, v192
v_dot2_f32_bf16 v193, v145, v145, v193
v_dot2_f32_bf16 v194, v149, s62, v194
v_dot2_f32_bf16 v195, v149, v149, v195
buffer_load_dwordx4 v[180:183], v200, s[8:11], s89 offen offset:896
v_dot2_f32_bf16 v192, v146, s62, v192
v_dot2_f32_bf16 v193, v146, v146, v193
v_dot2_f32_bf16 v194, v150, s62, v194
v_dot2_f32_bf16 v195, v150, v150, v195
v_dot2_f32_bf16 v192, v147, s62, v192
v_dot2_f32_bf16 v193, v147, v147, v193
v_dot2_f32_bf16 v194, v151, s62, v194
v_dot2_f32_bf16 v195, v151, v151, v195
buffer_load_dwordx4 v[184:187], v200, s[8:11], s90 offen offset:896
s_waitcnt vmcnt(8)
v_dot2_f32_bf16 v196, v152, s62, v196
v_dot2_f32_bf16 v197, v152, v152, v197
s_waitcnt vmcnt(7)
v_dot2_f32_bf16 v198, v156, s62, v198
v_dot2_f32_bf16 v199, v156, v156, v199
v_dot2_f32_bf16 v196, v153, s62, v196
v_dot2_f32_bf16 v197, v153, v153, v197
v_dot2_f32_bf16 v198, v157, s62, v198
v_dot2_f32_bf16 v199, v157, v157, v199
buffer_load_dwordx4 v[188:191], v200, s[8:11], s91 offen offset:896
v_dot2_f32_bf16 v196, v154, s62, v196
v_dot2_f32_bf16 v197, v154, v154, v197
v_dot2_f32_bf16 v198, v158, s62, v198
v_dot2_f32_bf16 v199, v158, v158, v199
v_dot2_f32_bf16 v196, v155, s62, v196
v_dot2_f32_bf16 v197, v155, v155, v197
v_dot2_f32_bf16 v198, v159, s62, v198
v_dot2_f32_bf16 v199, v159, v159, v199
buffer_load_dwordx4 v[224:227], v200, s[8:11], s88 offen offset:1024
s_waitcnt vmcnt(8)
v_dot2_f32_bf16 v192, v160, s62, v192
v_dot2_f32_bf16 v193, v160, v160, v193
s_waitcnt vmcnt(7)
v_dot2_f32_bf16 v194, v164, s62, v194
v_dot2_f32_bf16 v195, v164, v164, v195
v_dot2_f32_bf16 v192, v161, s62, v192
v_dot2_f32_bf16 v193, v161, v161, v193
v_dot2_f32_bf16 v194, v165, s62, v194
v_dot2_f32_bf16 v195, v165, v165, v195
buffer_load_dwordx4 v[228:231], v200, s[8:11], s89 offen offset:1024
v_dot2_f32_bf16 v192, v162, s62, v192
v_dot2_f32_bf16 v193, v162, v162, v193
v_dot2_f32_bf16 v194, v166, s62, v194
v_dot2_f32_bf16 v195, v166, v166, v195
v_dot2_f32_bf16 v192, v163, s62, v192
v_dot2_f32_bf16 v193, v163, v163, v193
v_dot2_f32_bf16 v194, v167, s62, v194
v_dot2_f32_bf16 v195, v167, v167, v195
buffer_load_dwordx4 v[232:235], v200, s[8:11], s90 offen offset:1024
s_waitcnt vmcnt(8)
v_dot2_f32_bf16 v196, v168, s62, v196
v_dot2_f32_bf16 v197, v168, v168, v197
s_waitcnt vmcnt(7)
v_dot2_f32_bf16 v198, v172, s62, v198
v_dot2_f32_bf16 v199, v172, v172, v199
v_dot2_f32_bf16 v196, v169, s62, v196
v_dot2_f32_bf16 v197, v169, v169, v197
v_dot2_f32_bf16 v198, v173, s62, v198
v_dot2_f32_bf16 v199, v173, v173, v199
buffer_load_dwordx4 v[236:239], v200, s[8:11], s91 offen offset:1024
v_dot2_f32_bf16 v196, v170, s62, v196
v_dot2_f32_bf16 v197, v170, v170, v197
v_dot2_f32_bf16 v198, v174, s62, v198
v_dot2_f32_bf16 v199, v174, v174, v199
v_dot2_f32_bf16 v196, v171, s62, v196
v_dot2_f32_bf16 v197, v171, v171, v197
v_dot2_f32_bf16 v198, v175, s62, v198
v_dot2_f32_bf16 v199, v175, v175, v199
s_add_u32 m0, s44, 90112
s_mov_b32 s45, 0
buffer_load_dwordx4 v1, s[12:15], s45 offen lds
s_waitcnt vmcnt(8)
v_dot2_f32_bf16 v192, v176, s62, v192
v_dot2_f32_bf16 v193, v176, v176, v193
s_waitcnt vmcnt(7)
v_dot2_f32_bf16 v194, v180, s62, v194
v_dot2_f32_bf16 v195, v180, v180, v195
v_dot2_f32_bf16 v192, v177, s62, v192
v_dot2_f32_bf16 v193, v177, v177, v193
v_dot2_f32_bf16 v194, v181, s62, v194
v_dot2_f32_bf16 v195, v181, v181, v195
s_add_u32 m0, s44, 94208
s_mov_b32 s45, 55296
buffer_load_dwordx4 v1, s[12:15], s45 offen lds
v_dot2_f32_bf16 v192, v178, s62, v192
v_dot2_f32_bf16 v193, v178, v178, v193
v_dot2_f32_bf16 v194, v182, s62, v194
v_dot2_f32_bf16 v195, v182, v182, v195
v_dot2_f32_bf16 v192, v179, s62, v192
v_dot2_f32_bf16 v193, v179, v179, v193
v_dot2_f32_bf16 v194, v183, s62, v194
v_dot2_f32_bf16 v195, v183, v183, v195
s_add_u32 m0, s44, 98304
s_mov_b32 s45, 110592
buffer_load_dwordx4 v1, s[12:15], s45 offen lds
s_waitcnt vmcnt(8)
v_dot2_f32_bf16 v196, v184, s62, v196
v_dot2_f32_bf16 v197, v184, v184, v197
s_waitcnt vmcnt(7)
v_dot2_f32_bf16 v198, v188, s62, v198
v_dot2_f32_bf16 v199, v188, v188, v199
v_dot2_f32_bf16 v196, v185, s62, v196
v_dot2_f32_bf16 v197, v185, v185, v197
v_dot2_f32_bf16 v198, v189, s62, v198
v_dot2_f32_bf16 v199, v189, v189, v199
s_add_u32 m0, s44, 102400
s_mov_b32 s45, 165888
buffer_load_dwordx4 v1, s[12:15], s45 offen lds
v_dot2_f32_bf16 v196, v186, s62, v196
v_dot2_f32_bf16 v197, v186, v186, v197
v_dot2_f32_bf16 v198, v190, s62, v198
v_dot2_f32_bf16 v199, v190, v190, v199
v_dot2_f32_bf16 v196, v187, s62, v196
v_dot2_f32_bf16 v197, v187, v187, v197
v_dot2_f32_bf16 v198, v191, s62, v198
v_dot2_f32_bf16 v199, v191, v191, v199
s_add_u32 m0, s44, 106496
s_mov_b32 s45, 221184
buffer_load_dwordx4 v1, s[12:15], s45 offen lds
s_waitcnt vmcnt(8)
v_dot2_f32_bf16 v192, v224, s62, v192
v_dot2_f32_bf16 v193, v224, v224, v193
s_waitcnt vmcnt(7)
v_dot2_f32_bf16 v194, v228, s62, v194
v_dot2_f32_bf16 v195, v228, v228, v195
v_dot2_f32_bf16 v192, v225, s62, v192
v_dot2_f32_bf16 v193, v225, v225, v193
v_dot2_f32_bf16 v194, v229, s62, v194
v_dot2_f32_bf16 v195, v229, v229, v195
s_add_u32 m0, s44, 110592
s_mov_b32 s45, 276480
buffer_load_dwordx4 v1, s[12:15], s45 offen lds
v_dot2_f32_bf16 v192, v226, s62, v192
v_dot2_f32_bf16 v193, v226, v226, v193
v_dot2_f32_bf16 v194, v230, s62, v194
v_dot2_f32_bf16 v195, v230, v230, v195
v_dot2_f32_bf16 v192, v227, s62, v192
v_dot2_f32_bf16 v193, v227, v227, v193
v_dot2_f32_bf16 v194, v231, s62, v194
v_dot2_f32_bf16 v195, v231, v231, v195
s_waitcnt vmcnt(7)
v_dot2_f32_bf16 v196, v232, s62, v196
v_dot2_f32_bf16 v197, v232, v232, v197
s_waitcnt vmcnt(6)
v_dot2_f32_bf16 v198, v236, s62, v198
v_dot2_f32_bf16 v199, v236, v236, v199
v_dot2_f32_bf16 v196, v233, s62, v196
v_dot2_f32_bf16 v197, v233, v233, v197
v_dot2_f32_bf16 v198, v237, s62, v198
v_dot2_f32_bf16 v199, v237, v237, v199
s_add_u32 m0, s44, 114688
s_mov_b32 s45, 331776
buffer_load_dwordx4 v1, s[12:15], s45 offen lds
v_dot2_f32_bf16 v196, v234, s62, v196
v_dot2_f32_bf16 v197, v234, v234, v197
v_dot2_f32_bf16 v198, v238, s62, v198
v_dot2_f32_bf16 v199, v238, v238, v199
v_dot2_f32_bf16 v196, v235, s62, v196
v_dot2_f32_bf16 v197, v235, v235, v197
v_dot2_f32_bf16 v198, v239, s62, v198
v_dot2_f32_bf16 v199, v239, v239, v199
s_add_u32 m0, s44, 118784
s_mov_b32 s45, 387072
buffer_load_dwordx4 v1, s[12:15], s45 offen lds
v_add_f32_dpp v192, v192, v192 quad_perm:[1,0,3,2] row_mask:0xf bank_mask:0xf
v_add_f32_dpp v193, v193, v193 quad_perm:[1,0,3,2] row_mask:0xf bank_mask:0xf
v_add_f32_dpp v194, v194, v194 quad_perm:[1,0,3,2] row_mask:0xf bank_mask:0xf
v_add_f32_dpp v195, v195, v195 quad_perm:[1,0,3,2] row_mask:0xf bank_mask:0xf
v_add_f32_dpp v196, v196, v196 quad_perm:[1,0,3,2] row_mask:0xf bank_mask:0xf
v_add_f32_dpp v197, v197, v197 quad_perm:[1,0,3,2] row_mask:0xf bank_mask:0xf
v_add_f32_dpp v198, v198, v198 quad_perm:[1,0,3,2] row_mask:0xf bank_mask:0xf
v_add_f32_dpp v199, v199, v199 quad_perm:[1,0,3,2] row_mask:0xf bank_mask:0xf
s_add_u32 m0, s44, 122880
s_mov_b32 s45, 442368
buffer_load_dwordx4 v1, s[12:15], s45 offen lds
v_add_f32_dpp v192, v192, v192 quad_perm:[2,3,0,1] row_mask:0xf bank_mask:0xf
v_add_f32_dpp v193, v193, v193 quad_perm:[2,3,0,1] row_mask:0xf bank_mask:0xf
v_add_f32_dpp v194, v194, v194 quad_perm:[2,3,0,1] row_mask:0xf bank_mask:0xf
v_add_f32_dpp v195, v195, v195 quad_perm:[2,3,0,1] row_mask:0xf bank_mask:0xf
v_add_f32_dpp v196, v196, v196 quad_perm:[2,3,0,1] row_mask:0xf bank_mask:0xf
v_add_f32_dpp v197, v197, v197 quad_perm:[2,3,0,1] row_mask:0xf bank_mask:0xf
v_add_f32_dpp v198, v198, v198 quad_perm:[2,3,0,1] row_mask:0xf bank_mask:0xf
v_add_f32_dpp v199, v199, v199 quad_perm:[2,3,0,1] row_mask:0xf bank_mask:0xf
s_add_u32 m0, s44, 126976
s_mov_b32 s45, 497664
buffer_load_dwordx4 v1, s[12:15], s45 offen lds
v_add_f32_dpp v192, v192, v192 row_half_mirror row_mask:0xf bank_mask:0xf
v_add_f32_dpp v193, v193, v193 row_half_mirror row_mask:0xf bank_mask:0xf
v_add_f32_dpp v194, v194, v194 row_half_mirror row_mask:0xf bank_mask:0xf
v_add_f32_dpp v195, v195, v195 row_half_mirror row_mask:0xf bank_mask:0xf
v_add_f32_dpp v196, v196, v196 row_half_mirror row_mask:0xf bank_mask:0xf
v_add_f32_dpp v197, v197, v197 row_half_mirror row_mask:0xf bank_mask:0xf
v_add_f32_dpp v198, v198, v198 row_half_mirror row_mask:0xf bank_mask:0xf
v_add_f32_dpp v199, v199, v199 row_half_mirror row_mask:0xf bank_mask:0xf
s_add_u32 m0, s44, 131072
s_mov_b32 s45, 552960
buffer_load_dwordx4 v1, s[12:15], s45 offen lds
v_mul_f32 v192, 0x3ae38e39, v192
v_mul_f32 v193, 0x3ae38e39, v193
v_mul_f32 v194, 0x3ae38e39, v194
v_mul_f32 v195, 0x3ae38e39, v195
v_mul_f32 v196, 0x3ae38e39, v196
v_mul_f32 v197, 0x3ae38e39, v197
v_mul_f32 v198, 0x3ae38e39, v198
v_mul_f32 v199, 0x3ae38e39, v199
s_add_u32 m0, s44, 135168
s_mov_b32 s45, 608256
buffer_load_dwordx4 v1, s[12:15], s45 offen lds
v_fma_f32 v193, -v192, v192, v193
v_fma_f32 v195, -v194, v194, v195
v_fma_f32 v197, -v196, v196, v197
v_fma_f32 v199, -v198, v198, v199
v_max_f32 v193, 0, v193
v_max_f32 v195, 0, v195
v_max_f32 v197, 0, v197
v_max_f32 v199, 0, v199
v_add_f32 v193, 0x3727c5ac, v193
v_add_f32 v195, 0x3727c5ac, v195
v_add_f32 v197, 0x3727c5ac, v197
v_add_f32 v199, 0x3727c5ac, v199
v_rsq_f32 v200, v193
v_rsq_f32 v202, v195
v_rsq_f32 v204, v197
v_rsq_f32 v206, v199
s_add_u32 m0, s44, 139264
s_mov_b32 s45, 663552
buffer_load_dwordx4 v1, s[12:15], s45 offen lds
v_mul_f32 v201, -v192, v200
v_mul_f32 v203, -v194, v202
v_mul_f32 v205, -v196, v204
v_mul_f32 v207, -v198, v206
v_pk_fma_f32 v[32:33], v[32:33], v[200:201], v[200:201] op_sel:[0,0,1] op_sel_hi:[1,0,1]
v_pk_fma_f32 v[48:49], v[48:49], v[200:201], v[200:201] op_sel:[0,0,1] op_sel_hi:[1,0,1]
v_pk_fma_f32 v[34:35], v[34:35], v[200:201], v[200:201] op_sel:[0,0,1] op_sel_hi:[1,0,1]
v_pk_fma_f32 v[50:51], v[50:51], v[200:201], v[200:201] op_sel:[0,0,1] op_sel_hi:[1,0,1]
s_add_u32 m0, s44, 143360
s_mov_b32 s45, 718848
buffer_load_dwordx4 v1, s[12:15], s45 offen lds
v_cvt_pk_bf16_f32 v48, v32, v48
v_cvt_pk_bf16_f32 v49, v33, v49
v_cvt_pk_bf16_f32 v50, v34, v50
v_cvt_pk_bf16_f32 v51, v35, v51
ds_write_b128 v246, v[48:51] offset:0
v_pk_fma_f32 v[36:37], v[36:37], v[202:203], v[202:203] op_sel:[0,0,1] op_sel_hi:[1,0,1]
v_pk_fma_f32 v[52:53], v[52:53], v[202:203], v[202:203] op_sel:[0,0,1] op_sel_hi:[1,0,1]
v_pk_fma_f32 v[38:39], v[38:39], v[202:203], v[202:203] op_sel:[0,0,1] op_sel_hi:[1,0,1]
s_add_u32 m0, s44, 147456
s_mov_b32 s45, 774144
buffer_load_dwordx4 v1, s[12:15], s45 offen lds
v_pk_fma_f32 v[54:55], v[54:55], v[202:203], v[202:203] op_sel:[0,0,1] op_sel_hi:[1,0,1]
v_cvt_pk_bf16_f32 v52, v36, v52
v_cvt_pk_bf16_f32 v53, v37, v53
v_cvt_pk_bf16_f32 v54, v38, v54
v_cvt_pk_bf16_f32 v55, v39, v55
ds_write_b128 v245, v[52:55] offset:0
v_pk_fma_f32 v[40:41], v[40:41], v[204:205], v[204:205] op_sel:[0,0,1] op_sel_hi:[1,0,1]
v_pk_fma_f32 v[56:57], v[56:57], v[204:205], v[204:205] op_sel:[0,0,1] op_sel_hi:[1,0,1]
s_add_u32 m0, s44, 151552
s_mov_b32 s45, 829440
buffer_load_dwordx4 v1, s[12:15], s45 offen lds
v_pk_fma_f32 v[42:43], v[42:43], v[204:205], v[204:205] op_sel:[0,0,1] op_sel_hi:[1,0,1]
v_pk_fma_f32 v[58:59], v[58:59], v[204:205], v[204:205] op_sel:[0,0,1] op_sel_hi:[1,0,1]
v_cvt_pk_bf16_f32 v56, v40, v56
v_cvt_pk_bf16_f32 v57, v41, v57
v_cvt_pk_bf16_f32 v58, v42, v58
v_cvt_pk_bf16_f32 v59, v43, v59
ds_write_b128 v246, v[56:59] offset:1024
v_pk_fma_f32 v[44:45], v[44:45], v[206:207], v[206:207] op_sel:[0,0,1] op_sel_hi:[1,0,1]
s_add_u32 m0, s44, 155648
s_mov_b32 s45, 884736
buffer_load_dwordx4 v1, s[12:15], s45 offen lds
v_pk_fma_f32 v[60:61], v[60:61], v[206:207], v[206:207] op_sel:[0,0,1] op_sel_hi:[1,0,1]
v_pk_fma_f32 v[46:47], v[46:47], v[206:207], v[206:207] op_sel:[0,0,1] op_sel_hi:[1,0,1]
v_pk_fma_f32 v[62:63], v[62:63], v[206:207], v[206:207] op_sel:[0,0,1] op_sel_hi:[1,0,1]
v_cvt_pk_bf16_f32 v60, v44, v60
v_cvt_pk_bf16_f32 v61, v45, v61
v_cvt_pk_bf16_f32 v62, v46, v62
v_cvt_pk_bf16_f32 v63, v47, v63
ds_write_b128 v245, v[60:63] offset:1024
s_add_u32 m0, s44, 159744
s_mov_b32 s45, 940032
buffer_load_dwordx4 v1, s[12:15], s45 offen lds
v_pk_fma_f32 v[208:209], v[208:209], v[200:201], v[200:201] op_sel:[0,0,1] op_sel_hi:[1,0,1]
v_pk_fma_f32 v[64:65], v[64:65], v[200:201], v[200:201] op_sel:[0,0,1] op_sel_hi:[1,0,1]
v_pk_fma_f32 v[210:211], v[210:211], v[200:201], v[200:201] op_sel:[0,0,1] op_sel_hi:[1,0,1]
v_pk_fma_f32 v[66:67], v[66:67], v[200:201], v[200:201] op_sel:[0,0,1] op_sel_hi:[1,0,1]
v_cvt_pk_bf16_f32 v64, v208, v64
v_cvt_pk_bf16_f32 v65, v209, v65
v_cvt_pk_bf16_f32 v66, v210, v66
v_cvt_pk_bf16_f32 v67, v211, v67
ds_write_b128 v246, v[64:67] offset:16384
v_pk_fma_f32 v[212:213], v[212:213], v[202:203], v[202:203] op_sel:[0,0,1] op_sel_hi:[1,0,1]
v_pk_fma_f32 v[68:69], v[68:69], v[202:203], v[202:203] op_sel:[0,0,1] op_sel_hi:[1,0,1]
v_pk_fma_f32 v[214:215], v[214:215], v[202:203], v[202:203] op_sel:[0,0,1] op_sel_hi:[1,0,1]
v_pk_fma_f32 v[70:71], v[70:71], v[202:203], v[202:203] op_sel:[0,0,1] op_sel_hi:[1,0,1]
v_cvt_pk_bf16_f32 v68, v212, v68
v_cvt_pk_bf16_f32 v69, v213, v69
v_cvt_pk_bf16_f32 v70, v214, v70
buffer_load_dword a255, v98, s[16:19], s71 offen
v_cvt_pk_bf16_f32 v71, v215, v71
ds_write_b128 v245, v[68:71] offset:16384
v_pk_fma_f32 v[216:217], v[216:217], v[204:205], v[204:205] op_sel:[0,0,1] op_sel_hi:[1,0,1]
v_pk_fma_f32 v[72:73], v[72:73], v[204:205], v[204:205] op_sel:[0,0,1] op_sel_hi:[1,0,1]
v_pk_fma_f32 v[218:219], v[218:219], v[204:205], v[204:205] op_sel:[0,0,1] op_sel_hi:[1,0,1]
v_pk_fma_f32 v[74:75], v[74:75], v[204:205], v[204:205] op_sel:[0,0,1] op_sel_hi:[1,0,1]
v_cvt_pk_bf16_f32 v72, v216, v72
v_cvt_pk_bf16_f32 v73, v217, v73
v_cvt_pk_bf16_f32 v74, v218, v74
v_cvt_pk_bf16_f32 v75, v219, v75
ds_write_b128 v246, v[72:75] offset:17408
v_pk_fma_f32 v[220:221], v[220:221], v[206:207], v[206:207] op_sel:[0,0,1] op_sel_hi:[1,0,1]
v_pk_fma_f32 v[76:77], v[76:77], v[206:207], v[206:207] op_sel:[0,0,1] op_sel_hi:[1,0,1]
v_pk_fma_f32 v[222:223], v[222:223], v[206:207], v[206:207] op_sel:[0,0,1] op_sel_hi:[1,0,1]
v_pk_fma_f32 v[78:79], v[78:79], v[206:207], v[206:207] op_sel:[0,0,1] op_sel_hi:[1,0,1]
v_cvt_pk_bf16_f32 v76, v220, v76
v_cvt_pk_bf16_f32 v77, v221, v77
v_cvt_pk_bf16_f32 v78, v222, v78
v_cvt_pk_bf16_f32 v79, v223, v79
ds_write_b128 v245, v[76:79] offset:17408
v_pk_fma_f32 v[100:101], v[100:101], v[200:201], v[200:201] op_sel:[0,0,1] op_sel_hi:[1,0,1]
v_pk_fma_f32 v[80:81], v[80:81], v[200:201], v[200:201] op_sel:[0,0,1] op_sel_hi:[1,0,1]
v_pk_fma_f32 v[102:103], v[102:103], v[200:201], v[200:201] op_sel:[0,0,1] op_sel_hi:[1,0,1]
v_pk_fma_f32 v[82:83], v[82:83], v[200:201], v[200:201] op_sel:[0,0,1] op_sel_hi:[1,0,1]
v_cvt_pk_bf16_f32 v80, v100, v80
v_cvt_pk_bf16_f32 v81, v101, v81
v_cvt_pk_bf16_f32 v82, v102, v82
v_cvt_pk_bf16_f32 v83, v103, v83
ds_write_b128 v246, v[80:83] offset:32768
v_pk_fma_f32 v[104:105], v[104:105], v[202:203], v[202:203] op_sel:[0,0,1] op_sel_hi:[1,0,1]
v_pk_fma_f32 v[84:85], v[84:85], v[202:203], v[202:203] op_sel:[0,0,1] op_sel_hi:[1,0,1]
v_pk_fma_f32 v[106:107], v[106:107], v[202:203], v[202:203] op_sel:[0,0,1] op_sel_hi:[1,0,1]
v_pk_fma_f32 v[86:87], v[86:87], v[202:203], v[202:203] op_sel:[0,0,1] op_sel_hi:[1,0,1]
v_cvt_pk_bf16_f32 v84, v104, v84
v_cvt_pk_bf16_f32 v85, v105, v85
v_cvt_pk_bf16_f32 v86, v106, v86
v_cvt_pk_bf16_f32 v87, v107, v87
ds_write_b128 v245, v[84:87] offset:32768
v_pk_fma_f32 v[108:109], v[108:109], v[204:205], v[204:205] op_sel:[0,0,1] op_sel_hi:[1,0,1]
v_pk_fma_f32 v[88:89], v[88:89], v[204:205], v[204:205] op_sel:[0,0,1] op_sel_hi:[1,0,1]
v_pk_fma_f32 v[110:111], v[110:111], v[204:205], v[204:205] op_sel:[0,0,1] op_sel_hi:[1,0,1]
v_pk_fma_f32 v[90:91], v[90:91], v[204:205], v[204:205] op_sel:[0,0,1] op_sel_hi:[1,0,1]
v_cvt_pk_bf16_f32 v88, v108, v88
v_cvt_pk_bf16_f32 v89, v109, v89
v_cvt_pk_bf16_f32 v90, v110, v90
v_cvt_pk_bf16_f32 v91, v111, v91
ds_write_b128 v246, v[88:91] offset:33792
v_pk_fma_f32 v[240:241], v[240:241], v[206:207], v[206:207] op_sel:[0,0,1] op_sel_hi:[1,0,1]
v_pk_fma_f32 v[92:93], v[92:93], v[206:207], v[206:207] op_sel:[0,0,1] op_sel_hi:[1,0,1]
v_pk_fma_f32 v[242:243], v[242:243], v[206:207], v[206:207] op_sel:[0,0,1] op_sel_hi:[1,0,1]
v_pk_fma_f32 v[94:95], v[94:95], v[206:207], v[206:207] op_sel:[0,0,1] op_sel_hi:[1,0,1]
v_cvt_pk_bf16_f32 v92, v240, v92
v_cvt_pk_bf16_f32 v93, v241, v93
v_cvt_pk_bf16_f32 v94, v242, v94
v_cvt_pk_bf16_f32 v95, v243, v95
ds_write_b128 v245, v[92:95] offset:33792
s_waitcnt vmcnt(13) lgkmcnt(0)
s_barrier
ds_read_b128 a[0:3], v247 offset:0
ds_read_b128 a[4:7], v247 offset:1024
ds_read_b128 a[8:11], v249 offset:0
ds_read_b128 a[12:15], v249 offset:1024
ds_read_b64_tr_b16 v[32:33], v13 offset:40960
ds_read_b64_tr_b16 v[34:35], v13 offset:41984
ds_read_b64_tr_b16 v[36:37], v15 offset:40960
ds_read_b64_tr_b16 v[38:39], v15 offset:41984
ds_read_b64_tr_b16 v[40:41], v17 offset:40960
ds_read_b64_tr_b16 v[42:43], v17 offset:41984
ds_read_b128 a[16:19], v248 offset:8192
ds_read_b128 a[20:23], v248 offset:9216
ds_read_b128 a[24:27], v250 offset:8192
ds_read_b128 a[28:31], v250 offset:9216
s_waitcnt lgkmcnt(8)
v_mfma_f32_16x16x32_bf16 v[48:51], v[32:35], a[0:3], 0
ds_read_b64_tr_b16 v[44:45], v19 offset:40960
ds_read_b128 a[32:35], v247 offset:16384
ds_read_b128 a[36:39], v247 offset:17408
ds_read_b128 a[40:43], v249 offset:16384
v_mfma_f32_16x16x32_bf16 v[52:55], v[32:35], a[4:7], 0
ds_read_b64_tr_b16 v[46:47], v19 offset:41984
ds_read_b128 a[44:47], v249 offset:17408
ds_read_b128 a[48:51], v248 offset:24576
ds_read_b128 a[52:55], v248 offset:25600
v_mfma_f32_16x16x32_bf16 v[56:59], v[32:35], a[8:11], 0
ds_read_b128 a[56:59], v250 offset:24576
ds_read_b128 a[60:63], v250 offset:25600
ds_read_b128 a[64:67], v247 offset:32768
ds_read_b128 a[68:71], v247 offset:33792
v_mfma_f32_16x16x32_bf16 v[60:63], v[32:35], a[12:15], 0
ds_read_b128 a[72:75], v249 offset:32768
ds_read_b128 a[76:79], v249 offset:33792
ds_read_b128 a[80:83], v248 offset:40960
ds_read_b128 a[84:87], v248 offset:41984
s_waitcnt lgkmcnt(15)
v_mfma_f32_16x16x32_bf16 v[64:67], a[0:3], v[36:39], 0
ds_read_b64_tr_b16 v[32:33], v13 offset:49152
ds_read_b128 a[88:91], v250 offset:40960
ds_read_b128 a[92:95], v250 offset:41984
v_lshlrev_b32 v208, 16, v112
v_mfma_f32_16x16x32_bf16 v[68:71], a[4:7], v[36:39], 0
ds_read_b64_tr_b16 v[34:35], v13 offset:50176
v_and_b32 v209, s63, v112
v_lshlrev_b32 v210, 16, v113
v_and_b32 v211, s63, v113
v_mfma_f32_16x16x32_bf16 v[72:75], a[8:11], v[36:39], 0
v_lshlrev_b32 v212, 16, v114
v_and_b32 v213, s63, v114
v_lshlrev_b32 v214, 16, v115
v_and_b32 v215, s63, v115
v_mfma_f32_16x16x32_bf16 v[76:79], a[12:15], v[36:39], 0
v_fma_f32 v208, v208, v200, v201
v_fma_f32 v209, v209, v200, v201
v_fma_f32 v210, v210, v200, v201
v_fma_f32 v211, v211, v200, v201
v_mfma_f32_16x16x32_bf16 v[80:83], a[0:3], v[40:43], 0
ds_read_b64_tr_b16 v[36:37], v15 offset:49152
v_fma_f32 v212, v212, v200, v201
v_fma_f32 v213, v213, v200, v201
v_fma_f32 v214, v214, v200, v201
v_mfma_f32_16x16x32_bf16 v[84:87], a[4:7], v[40:43], 0
ds_read_b64_tr_b16 v[38:39], v15 offset:50176
v_fma_f32 v215, v215, v200, v201
v_cvt_pk_bf16_f32 v112, v208, v209
v_cvt_pk_bf16_f32 v113, v210, v211
v_mfma_f32_16x16x32_bf16 v[88:91], a[8:11], v[40:43], 0
v_cvt_pk_bf16_f32 v114, v212, v213
v_cvt_pk_bf16_f32 v115, v214, v215
ds_write_b128 v246, v[112:115] offset:49152
v_lshlrev_b32 v216, 16, v116
v_mfma_f32_16x16x32_bf16 v[92:95], a[12:15], v[40:43], 0
v_and_b32 v217, s63, v116
v_lshlrev_b32 v218, 16, v117
v_and_b32 v219, s63, v117
v_lshlrev_b32 v220, 16, v118
s_waitcnt lgkmcnt(15)
v_mfma_f32_16x16x32_bf16 v[96:99], a[0:3], v[44:47], 0
ds_read_b64_tr_b16 v[40:41], v17 offset:49152
v_and_b32 v221, s63, v118
v_lshlrev_b32 v222, 16, v119
v_and_b32 v223, s63, v119
v_mfma_f32_16x16x32_bf16 v[100:103], a[4:7], v[44:47], 0
ds_read_b64_tr_b16 v[42:43], v17 offset:50176
v_fma_f32 v216, v216, v202, v203
v_fma_f32 v217, v217, v202, v203
v_fma_f32 v218, v218, v202, v203
v_mfma_f32_16x16x32_bf16 v[104:107], a[8:11], v[44:47], 0
v_fma_f32 v219, v219, v202, v203
v_fma_f32 v220, v220, v202, v203
v_fma_f32 v221, v221, v202, v203
v_fma_f32 v222, v222, v202, v203
v_mfma_f32_16x16x32_bf16 v[108:111], a[12:15], v[44:47], 0
v_fma_f32 v223, v223, v202, v203
v_cvt_pk_bf16_f32 v116, v216, v217
v_cvt_pk_bf16_f32 v117, v218, v219
v_cvt_pk_bf16_f32 v118, v220, v221
s_waitcnt lgkmcnt(5)
v_mfma_f32_16x16x32_bf16 v[48:51], v[32:35], a[16:19], v[48:51]
ds_read_b64_tr_b16 v[44:45], v19 offset:49152
v_cvt_pk_bf16_f32 v119, v222, v223
ds_write_b128 v245, v[116:119] offset:49152
v_lshlrev_b32 v208, 16, v120
v_mfma_f32_16x16x32_bf16 v[52:55], v[32:35], a[20:23], v[52:55]
ds_read_b64_tr_b16 v[46:47], v19 offset:50176
v_and_b32 v209, s63, v120
v_lshlrev_b32 v210, 16, v121
v_and_b32 v211, s63, v121
v_mfma_f32_16x16x32_bf16 v[56:59], v[32:35], a[24:27], v[56:59]
v_lshlrev_b32 v212, 16, v122
v_and_b32 v213, s63, v122
v_lshlrev_b32 v214, 16, v123
v_and_b32 v215, s63, v123
v_mfma_f32_16x16x32_bf16 v[60:63], v[32:35], a[28:31], v[60:63]
v_fma_f32 v208, v208, v204, v205
v_fma_f32 v209, v209, v204, v205
v_fma_f32 v210, v210, v204, v205
v_fma_f32 v211, v211, v204, v205
s_waitcnt lgkmcnt(6)
v_mfma_f32_16x16x32_bf16 v[64:67], a[16:19], v[36:39], v[64:67]
ds_read_b64_tr_b16 v[32:33], v13 offset:57344
v_fma_f32 v212, v212, v204, v205
v_fma_f32 v213, v213, v204, v205
v_fma_f32 v214, v214, v204, v205
v_mfma_f32_16x16x32_bf16 v[68:71], a[20:23], v[36:39], v[68:71]
ds_read_b64_tr_b16 v[34:35], v13 offset:58368
v_fma_f32 v215, v215, v204, v205
v_cvt_pk_bf16_f32 v120, v208, v209
v_cvt_pk_bf16_f32 v121, v210, v211
v_mfma_f32_16x16x32_bf16 v[72:75], a[24:27], v[36:39], v[72:75]
v_cvt_pk_bf16_f32 v122, v212, v213
v_cvt_pk_bf16_f32 v123, v214, v215
ds_write_b128 v246, v[120:123] offset:50176
v_lshlrev_b32 v216, 16, v124
v_mfma_f32_16x16x32_bf16 v[76:79], a[28:31], v[36:39], v[76:79]
v_and_b32 v217, s63, v124
v_lshlrev_b32 v218, 16, v125
v_and_b32 v219, s63, v125
v_lshlrev_b32 v220, 16, v126
s_waitcnt lgkmcnt(6)
v_mfma_f32_16x16x32_bf16 v[80:83], a[16:19], v[40:43], v[80:83]
ds_read_b64_tr_b16 v[36:37], v15 offset:57344
v_and_b32 v221, s63, v126
v_lshlrev_b32 v222, 16, v127
v_and_b32 v223, s63, v127
v_mfma_f32_16x16x32_bf16 v[84:87], a[20:23], v[40:43], v[84:87]
ds_read_b64_tr_b16 v[38:39], v15 offset:58368
v_fma_f32 v216, v216, v206, v207
v_fma_f32 v217, v217, v206, v207
v_fma_f32 v218, v218, v206, v207
v_mfma_f32_16x16x32_bf16 v[88:91], a[24:27], v[40:43], v[88:91]
v_fma_f32 v219, v219, v206, v207
v_fma_f32 v220, v220, v206, v207
v_fma_f32 v221, v221, v206, v207
v_fma_f32 v222, v222, v206, v207
v_mfma_f32_16x16x32_bf16 v[92:95], a[28:31], v[40:43], v[92:95]
v_fma_f32 v223, v223, v206, v207
v_cvt_pk_bf16_f32 v124, v216, v217
v_cvt_pk_bf16_f32 v125, v218, v219
v_cvt_pk_bf16_f32 v126, v220, v221
s_waitcnt lgkmcnt(5)
v_mfma_f32_16x16x32_bf16 v[96:99], a[16:19], v[44:47], v[96:99]
ds_read_b64_tr_b16 v[40:41], v17 offset:57344
v_cvt_pk_bf16_f32 v127, v222, v223
ds_write_b128 v245, v[124:127] offset:50176
v_mfma_f32_16x16x32_bf16 v[100:103], a[20:23], v[44:47], v[100:103]
ds_read_b64_tr_b16 v[42:43], v17 offset:58368
v_mfma_f32_16x16x32_bf16 v[104:107], a[24:27], v[44:47], v[104:107]
v_mfma_f32_16x16x32_bf16 v[108:111], a[28:31], v[44:47], v[108:111]
s_waitcnt lgkmcnt(6)
v_mfma_f32_16x16x32_bf16 v[48:51], v[32:35], a[32:35], v[48:51]
ds_read_b64_tr_b16 v[44:45], v19 offset:57344
v_mfma_f32_16x16x32_bf16 v[52:55], v[32:35], a[36:39], v[52:55]
ds_read_b64_tr_b16 v[46:47], v19 offset:58368
v_mfma_f32_16x16x32_bf16 v[56:59], v[32:35], a[40:43], v[56:59]
v_mfma_f32_16x16x32_bf16 v[60:63], v[32:35], a[44:47], v[60:63]
s_waitcnt lgkmcnt(5)
v_mfma_f32_16x16x32_bf16 v[64:67], a[32:35], v[36:39], v[64:67]
s_waitcnt vmcnt(7) lgkmcnt(0)
s_barrier
ds_read_b64_tr_b16 v[32:33], v14 offset:0
v_mfma_f32_16x16x32_bf16 v[68:71], a[36:39], v[36:39], v[68:71]
ds_read_b64_tr_b16 v[34:35], v14 offset:1024
v_mfma_f32_16x16x32_bf16 v[72:75], a[40:43], v[36:39], v[72:75]
v_mfma_f32_16x16x32_bf16 v[76:79], a[44:47], v[36:39], v[76:79]
s_add_u32 m0, s44, 90112
s_mov_b32 s45, 995328
v_mfma_f32_16x16x32_bf16 v[80:83], a[32:35], v[40:43], v[80:83]
ds_read_b64_tr_b16 v[36:37], v16 offset:0
v_lshlrev_b32 v208, 16, v128
v_and_b32 v209, s63, v128
v_lshlrev_b32 v210, 16, v129
v_mfma_f32_16x16x32_bf16 v[84:87], a[36:39], v[40:43], v[84:87]
ds_read_b64_tr_b16 v[38:39], v16 offset:1024
v_and_b32 v211, s63, v129
v_lshlrev_b32 v212, 16, v130
v_and_b32 v213, s63, v130
v_mfma_f32_16x16x32_bf16 v[88:91], a[40:43], v[40:43], v[88:91]
buffer_load_dwordx4 v1, s[12:15], s45 offen lds
v_lshlrev_b32 v214, 16, v131
v_and_b32 v215, s63, v131
v_fma_f32 v208, v208, v200, v201
v_mfma_f32_16x16x32_bf16 v[92:95], a[44:47], v[40:43], v[92:95]
s_add_u32 m0, s44, 94208
s_mov_b32 s45, 1050624
v_fma_f32 v209, v209, v200, v201
v_fma_f32 v210, v210, v200, v201
v_fma_f32 v211, v211, v200, v201
v_mfma_f32_16x16x32_bf16 v[96:99], a[32:35], v[44:47], v[96:99]
ds_read_b64_tr_b16 v[40:41], v18 offset:0
v_fma_f32 v212, v212, v200, v201
v_fma_f32 v213, v213, v200, v201
v_fma_f32 v214, v214, v200, v201
v_mfma_f32_16x16x32_bf16 v[100:103], a[36:39], v[44:47], v[100:103]
ds_read_b64_tr_b16 v[42:43], v18 offset:1024
v_fma_f32 v215, v215, v200, v201
v_cvt_pk_bf16_f32 v128, v208, v209
v_cvt_pk_bf16_f32 v129, v210, v211
v_mfma_f32_16x16x32_bf16 v[104:107], a[40:43], v[44:47], v[104:107]
buffer_load_dwordx4 v1, s[12:15], s45 offen lds
v_cvt_pk_bf16_f32 v130, v212, v213
v_cvt_pk_bf16_f32 v131, v214, v215
ds_write_b128 v246, v[128:131] offset:0
v_mfma_f32_16x16x32_bf16 v[108:111], a[44:47], v[44:47], v[108:111]
v_lshlrev_b32 v216, 16, v132
v_and_b32 v217, s63, v132
v_lshlrev_b32 v218, 16, v133
v_and_b32 v219, s63, v133
s_waitcnt lgkmcnt(5)
v_mfma_f32_16x16x32_bf16 v[48:51], v[32:35], a[48:51], v[48:51]
ds_read_b64_tr_b16 v[44:45], v20 offset:0
v_lshlrev_b32 v220, 16, v134
v_and_b32 v221, s63, v134
v_lshlrev_b32 v222, 16, v135
v_mfma_f32_16x16x32_bf16 v[52:55], v[32:35], a[52:55], v[52:55]
ds_read_b64_tr_b16 v[46:47], v20 offset:1024
v_and_b32 v223, s63, v135
v_fma_f32 v216, v216, v202, v203
v_fma_f32 v217, v217, v202, v203
v_mfma_f32_16x16x32_bf16 v[56:59], v[32:35], a[56:59], v[56:59]
v_fma_f32 v218, v218, v202, v203
v_fma_f32 v219, v219, v202, v203
v_fma_f32 v220, v220, v202, v203
v_fma_f32 v221, v221, v202, v203
v_mfma_f32_16x16x32_bf16 v[60:63], v[32:35], a[60:63], v[60:63]
s_add_u32 m0, s44, 98304
s_mov_b32 s45, 1105920
v_fma_f32 v222, v222, v202, v203
v_fma_f32 v223, v223, v202, v203
v_cvt_pk_bf16_f32 v132, v216, v217
s_waitcnt lgkmcnt(5)
v_mfma_f32_16x16x32_bf16 v[64:67], a[48:51], v[36:39], v[64:67]
ds_read_b64_tr_b16 v[32:33], v14 offset:8192
v_cvt_pk_bf16_f32 v133, v218, v219
v_cvt_pk_bf16_f32 v134, v220, v221
v_cvt_pk_bf16_f32 v135, v222, v223
v_mfma_f32_16x16x32_bf16 v[68:71], a[52:55], v[36:39], v[68:71]
ds_read_b64_tr_b16 v[34:35], v14 offset:9216
ds_write_b128 v245, v[132:135] offset:0
v_lshlrev_b32 v208, 16, v136
v_and_b32 v209, s63, v136
v_mfma_f32_16x16x32_bf16 v[72:75], a[56:59], v[36:39], v[72:75]
buffer_load_dwordx4 v1, s[12:15], s45 offen lds
v_lshlrev_b32 v210, 16, v137
v_and_b32 v211, s63, v137
v_lshlrev_b32 v212, 16, v138
v_mfma_f32_16x16x32_bf16 v[76:79], a[60:63], v[36:39], v[76:79]
s_add_u32 m0, s44, 102400
s_mov_b32 s45, 1161216
v_and_b32 v213, s63, v138
v_lshlrev_b32 v214, 16, v139
v_and_b32 v215, s63, v139
s_waitcnt lgkmcnt(6)
v_mfma_f32_16x16x32_bf16 v[80:83], a[48:51], v[40:43], v[80:83]
ds_read_b64_tr_b16 v[36:37], v16 offset:8192
v_fma_f32 v208, v208, v204, v205
v_fma_f32 v209, v209, v204, v205
v_fma_f32 v210, v210, v204, v205
v_mfma_f32_16x16x32_bf16 v[84:87], a[52:55], v[40:43], v[84:87]
ds_read_b64_tr_b16 v[38:39], v16 offset:9216
v_fma_f32 v211, v211, v204, v205
v_fma_f32 v212, v212, v204, v205
v_fma_f32 v213, v213, v204, v205
v_mfma_f32_16x16x32_bf16 v[88:91], a[56:59], v[40:43], v[88:91]
buffer_load_dwordx4 v1, s[12:15], s45 offen lds
v_fma_f32 v214, v214, v204, v205
v_fma_f32 v215, v215, v204, v205
v_cvt_pk_bf16_f32 v136, v208, v209
v_mfma_f32_16x16x32_bf16 v[92:95], a[60:63], v[40:43], v[92:95]
v_cvt_pk_bf16_f32 v137, v210, v211
v_cvt_pk_bf16_f32 v138, v212, v213
v_cvt_pk_bf16_f32 v139, v214, v215
ds_write_b128 v246, v[136:139] offset:1024
s_waitcnt lgkmcnt(6)
v_mfma_f32_16x16x32_bf16 v[96:99], a[48:51], v[44:47], v[96:99]
ds_read_b64_tr_b16 v[40:41], v18 offset:8192
v_lshlrev_b32 v216, 16, v140
v_and_b32 v217, s63, v140
v_lshlrev_b32 v218, 16, v141
v_mfma_f32_16x16x32_bf16 v[100:103], a[52:55], v[44:47], v[100:103]
ds_read_b64_tr_b16 v[42:43], v18 offset:9216
v_and_b32 v219, s63, v141
v_lshlrev_b32 v220, 16, v142
v_and_b32 v221, s63, v142
v_mfma_f32_16x16x32_bf16 v[104:107], a[56:59], v[44:47], v[104:107]
v_lshlrev_b32 v222, 16, v143
v_and_b32 v223, s63, v143
v_fma_f32 v216, v216, v206, v207
v_fma_f32 v217, v217, v206, v207
v_mfma_f32_16x16x32_bf16 v[108:111], a[60:63], v[44:47], v[108:111]
s_add_u32 m0, s44, 106496
s_mov_b32 s45, 1216512
v_fma_f32 v218, v218, v206, v207
v_fma_f32 v219, v219, v206, v207
v_fma_f32 v220, v220, v206, v207
s_waitcnt lgkmcnt(6)
v_mfma_f32_16x16x32_bf16 v[48:51], v[32:35], a[64:67], v[48:51]
ds_read_b64_tr_b16 v[44:45], v20 offset:8192
v_fma_f32 v221, v221, v206, v207
v_fma_f32 v222, v222, v206, v207
v_fma_f32 v223, v223, v206, v207
v_mfma_f32_16x16x32_bf16 v[52:55], v[32:35], a[68:71], v[52:55]
ds_read_b64_tr_b16 v[46:47], v20 offset:9216
v_cvt_pk_bf16_f32 v140, v216, v217
v_cvt_pk_bf16_f32 v141, v218, v219
v_cvt_pk_bf16_f32 v142, v220, v221
v_mfma_f32_16x16x32_bf16 v[56:59], v[32:35], a[72:75], v[56:59]
buffer_load_dwordx4 v1, s[12:15], s45 offen lds
v_cvt_pk_bf16_f32 v143, v222, v223
ds_write_b128 v245, v[140:143] offset:1024
v_add_u32 v240, s44, v23
v_mfma_f32_16x16x32_bf16 v[60:63], v[32:35], a[76:79], v[60:63]
s_add_u32 m0, s44, 110592
s_mov_b32 s45, 1271808
v_lshlrev_b32 v240, 3, v240
v_min_u32 v240, 20608, v240
buffer_load_dword v251, v240, s[20:23], s71 offen
s_waitcnt lgkmcnt(6)
v_mfma_f32_16x16x32_bf16 v[64:67], a[64:67], v[36:39], v[64:67]
ds_read_b64_tr_b16 v[32:33], v14 offset:16384
v_lshlrev_b32 v208, 16, v144
v_and_b32 v209, s63, v144
v_lshlrev_b32 v210, 16, v145
v_mfma_f32_16x16x32_bf16 v[68:71], a[68:71], v[36:39], v[68:71]
ds_read_b64_tr_b16 v[34:35], v14 offset:17408
v_and_b32 v211, s63, v145
v_lshlrev_b32 v212, 16, v146
v_and_b32 v213, s63, v146
v_mfma_f32_16x16x32_bf16 v[72:75], a[72:75], v[36:39], v[72:75]
buffer_load_dwordx4 v1, s[12:15], s45 offen lds
v_lshlrev_b32 v214, 16, v147
v_and_b32 v215, s63, v147
v_fma_f32 v208, v208, v200, v201
v_mfma_f32_16x16x32_bf16 v[76:79], a[76:79], v[36:39], v[76:79]
v_fma_f32 v209, v209, v200, v201
v_fma_f32 v210, v210, v200, v201
v_fma_f32 v211, v211, v200, v201
v_fma_f32 v212, v212, v200, v201
s_waitcnt lgkmcnt(5)
v_mfma_f32_16x16x32_bf16 v[80:83], a[64:67], v[40:43], v[80:83]
ds_read_b64_tr_b16 v[36:37], v16 offset:16384
v_fma_f32 v213, v213, v200, v201
v_fma_f32 v214, v214, v200, v201
v_fma_f32 v215, v215, v200, v201
v_mfma_f32_16x16x32_bf16 v[84:87], a[68:71], v[40:43], v[84:87]
ds_read_b64_tr_b16 v[38:39], v16 offset:17408
v_cvt_pk_bf16_f32 v144, v208, v209
v_cvt_pk_bf16_f32 v145, v210, v211
v_cvt_pk_bf16_f32 v146, v212, v213
v_mfma_f32_16x16x32_bf16 v[88:91], a[72:75], v[40:43], v[88:91]
v_cvt_pk_bf16_f32 v147, v214, v215
ds_write_b128 v246, v[144:147] offset:16384
v_lshlrev_b32 v216, 16, v148
v_and_b32 v217, s63, v148
v_mfma_f32_16x16x32_bf16 v[92:95], a[76:79], v[40:43], v[92:95]
v_lshlrev_b32 v218, 16, v149
v_and_b32 v219, s63, v149
v_lshlrev_b32 v220, 16, v150
v_and_b32 v221, s63, v150
s_waitcnt lgkmcnt(6)
v_mfma_f32_16x16x32_bf16 v[96:99], a[64:67], v[44:47], v[96:99]
ds_read_b64_tr_b16 v[40:41], v18 offset:16384
v_lshlrev_b32 v222, 16, v151
v_and_b32 v223, s63, v151
v_fma_f32 v216, v216, v202, v203
v_mfma_f32_16x16x32_bf16 v[100:103], a[68:71], v[44:47], v[100:103]
ds_read_b64_tr_b16 v[42:43], v18 offset:17408
v_fma_f32 v217, v217, v202, v203
v_fma_f32 v218, v218, v202, v203
v_fma_f32 v219, v219, v202, v203
v_mfma_f32_16x16x32_bf16 v[104:107], a[72:75], v[44:47], v[104:107]
v_fma_f32 v220, v220, v202, v203
v_fma_f32 v221, v221, v202, v203
v_fma_f32 v222, v222, v202, v203
v_fma_f32 v223, v223, v202, v203
v_mfma_f32_16x16x32_bf16 v[108:111], a[76:79], v[44:47], v[108:111]
v_cvt_pk_bf16_f32 v148, v216, v217
v_cvt_pk_bf16_f32 v149, v218, v219
v_cvt_pk_bf16_f32 v150, v220, v221
v_cvt_pk_bf16_f32 v151, v222, v223
s_waitcnt lgkmcnt(5)
v_mfma_f32_16x16x32_bf16 v[48:51], v[32:35], a[80:83], v[48:51]
ds_read_b64_tr_b16 v[44:45], v20 offset:16384
ds_write_b128 v245, v[148:151] offset:16384
v_lshlrev_b32 v208, 16, v152
v_and_b32 v209, s63, v152
v_mfma_f32_16x16x32_bf16 v[52:55], v[32:35], a[84:87], v[52:55]
ds_read_b64_tr_b16 v[46:47], v20 offset:17408
v_lshlrev_b32 v210, 16, v153
v_and_b32 v211, s63, v153
v_lshlrev_b32 v212, 16, v154
v_mfma_f32_16x16x32_bf16 v[56:59], v[32:35], a[88:91], v[56:59]
v_and_b32 v213, s63, v154
v_lshlrev_b32 v214, 16, v155
v_and_b32 v215, s63, v155
v_fma_f32 v208, v208, v204, v205
v_mfma_f32_16x16x32_bf16 v[60:63], v[32:35], a[92:95], v[60:63]
v_fma_f32 v209, v209, v204, v205
v_fma_f32 v210, v210, v204, v205
v_fma_f32 v211, v211, v204, v205
v_fma_f32 v212, v212, v204, v205
s_waitcnt lgkmcnt(6)
v_mfma_f32_16x16x32_bf16 v[64:67], a[80:83], v[36:39], v[64:67]
s_waitcnt vmcnt(8) lgkmcnt(0)
s_barrier
ds_read_b64_tr_b16 v[32:33], v14 offset:24576
v_fma_f32 v213, v213, v204, v205
v_fma_f32 v214, v214, v204, v205
v_fma_f32 v215, v215, v204, v205
v_mfma_f32_16x16x32_bf16 v[68:71], a[84:87], v[36:39], v[68:71]
ds_read_b64_tr_b16 v[34:35], v14 offset:25600
v_cvt_pk_bf16_f32 v152, v208, v209
v_cvt_pk_bf16_f32 v153, v210, v211
v_cvt_pk_bf16_f32 v154, v212, v213
v_mfma_f32_16x16x32_bf16 v[72:75], a[88:91], v[36:39], v[72:75]
v_cvt_pk_bf16_f32 v155, v214, v215
ds_write_b128 v246, v[152:155] offset:17408
v_lshlrev_b32 v216, 16, v156
v_and_b32 v217, s63, v156
v_mfma_f32_16x16x32_bf16 v[76:79], a[92:95], v[36:39], v[76:79]
s_add_u32 m0, s44, 114688
s_mov_b32 s45, 1327104
v_lshlrev_b32 v218, 16, v157
v_and_b32 v219, s63, v157
v_lshlrev_b32 v220, 16, v158
v_mfma_f32_16x16x32_bf16 v[80:83], a[80:83], v[40:43], v[80:83]
ds_read_b64_tr_b16 v[36:37], v16 offset:24576
ds_read_b128 a[96:99], v247 offset:49152
ds_read_b128 a[100:103], v247 offset:50176
ds_read_b128 a[104:107], v249 offset:49152
v_mfma_f32_16x16x32_bf16 v[84:87], a[84:87], v[40:43], v[84:87]
ds_read_b64_tr_b16 v[38:39], v16 offset:25600
ds_read_b128 a[108:111], v249 offset:50176
ds_read_b128 a[112:115], v248 offset:57344
ds_read_b128 a[116:119], v248 offset:58368
v_mfma_f32_16x16x32_bf16 v[88:91], a[88:91], v[40:43], v[88:91]
buffer_load_dwordx4 v1, s[12:15], s45 offen lds
ds_read_b128 a[120:123], v250 offset:57344
ds_read_b128 a[124:127], v250 offset:58368
ds_read_b128 a[128:131], v247 offset:0
v_mfma_f32_16x16x32_bf16 v[92:95], a[92:95], v[40:43], v[92:95]
s_add_u32 m0, s44, 118784
s_mov_b32 s45, 1382400
ds_read_b128 a[132:135], v247 offset:1024
ds_read_b128 a[136:139], v249 offset:0
ds_read_b128 a[140:143], v249 offset:1024
v_mfma_f32_16x16x32_bf16 v[96:99], a[80:83], v[44:47], v[96:99]
ds_read_b64_tr_b16 v[40:41], v18 offset:24576
ds_read_b128 a[144:147], v248 offset:8192
ds_read_b128 a[148:151], v248 offset:9216
ds_read_b128 a[152:155], v250 offset:8192
v_mfma_f32_16x16x32_bf16 v[100:103], a[84:87], v[44:47], v[100:103]
ds_read_b64_tr_b16 v[42:43], v18 offset:25600
ds_read_b128 a[156:159], v250 offset:9216
v_and_b32 v221, s63, v158
v_lshlrev_b32 v222, 16, v159
v_mfma_f32_16x16x32_bf16 v[104:107], a[88:91], v[44:47], v[104:107]
buffer_load_dwordx4 v1, s[12:15], s45 offen lds
v_and_b32 v223, s63, v159
v_fma_f32 v216, v216, v206, v207
v_fma_f32 v217, v217, v206, v207
v_mfma_f32_16x16x32_bf16 v[108:111], a[92:95], v[44:47], v[108:111]
v_fma_f32 v218, v218, v206, v207
v_fma_f32 v219, v219, v206, v207
v_fma_f32 v220, v220, v206, v207
v_fma_f32 v221, v221, v206, v207
s_waitcnt lgkmcnt(15)
v_mfma_f32_16x16x32_bf16 v[48:51], v[32:35], a[96:99], v[48:51]
ds_read_b64_tr_b16 v[44:45], v20 offset:24576
v_fma_f32 v222, v222, v206, v207
v_fma_f32 v223, v223, v206, v207
v_cvt_pk_bf16_f32 v156, v216, v217
v_mfma_f32_16x16x32_bf16 v[52:55], v[32:35], a[100:103], v[52:55]
ds_read_b64_tr_b16 v[46:47], v20 offset:25600
v_cvt_pk_bf16_f32 v157, v218, v219
v_cvt_pk_bf16_f32 v158, v220, v221
v_cvt_pk_bf16_f32 v159, v222, v223
v_mfma_f32_16x16x32_bf16 v[56:59], v[32:35], a[104:107], v[56:59]
ds_write_b128 v245, v[156:159] offset:17408
v_lshlrev_b32 v208, 16, v160
v_and_b32 v209, s63, v160
v_lshlrev_b32 v210, 16, v161
s_waitcnt lgkmcnt(15)
v_mfma_f32_16x16x32_bf16 v[60:63], v[32:35], a[108:111], v[60:63]
s_add_u32 m0, s44, 122880
s_mov_b32 s45, 1437696
v_and_b32 v211, s63, v161
v_lshlrev_b32 v212, 16, v162
v_and_b32 v213, s63, v162
v_mfma_f32_16x16x32_bf16 v[64:67], a[96:99], v[36:39], v[64:67]
ds_read_b64_tr_b16 v[32:33], v14 offset:32768
v_lshlrev_b32 v214, 16, v163
v_and_b32 v215, s63, v163
v_fma_f32 v208, v208, v200, v201
v_mfma_f32_16x16x32_bf16 v[68:71], a[100:103], v[36:39], v[68:71]
ds_read_b64_tr_b16 v[34:35], v14 offset:33792
v_fma_f32 v209, v209, v200, v201
v_fma_f32 v210, v210, v200, v201
v_fma_f32 v211, v211, v200, v201
v_mfma_f32_16x16x32_bf16 v[72:75], a[104:107], v[36:39], v[72:75]
buffer_load_dwordx4 v1, s[12:15], s45 offen lds
v_fma_f32 v212, v212, v200, v201
v_fma_f32 v213, v213, v200, v201
v_fma_f32 v214, v214, v200, v201
v_mfma_f32_16x16x32_bf16 v[76:79], a[108:111], v[36:39], v[76:79]
s_add_u32 m0, s44, 126976
s_mov_b32 s45, 1492992
v_fma_f32 v215, v215, v200, v201
v_cvt_pk_bf16_f32 v160, v208, v209
v_cvt_pk_bf16_f32 v161, v210, v211
s_waitcnt lgkmcnt(6)
v_mfma_f32_16x16x32_bf16 v[80:83], a[96:99], v[40:43], v[80:83]
ds_read_b64_tr_b16 v[36:37], v16 offset:32768
v_cvt_pk_bf16_f32 v162, v212, v213
v_cvt_pk_bf16_f32 v163, v214, v215
ds_write_b128 v246, v[160:163] offset:32768
v_mfma_f32_16x16x32_bf16 v[84:87], a[100:103], v[40:43], v[84:87]
ds_read_b64_tr_b16 v[38:39], v16 offset:33792
v_lshlrev_b32 v216, 16, v164
v_and_b32 v217, s63, v164
v_lshlrev_b32 v218, 16, v165
v_mfma_f32_16x16x32_bf16 v[88:91], a[104:107], v[40:43], v[88:91]
buffer_load_dwordx4 v1, s[12:15], s45 offen lds
v_and_b32 v219, s63, v165
v_lshlrev_b32 v220, 16, v166
v_and_b32 v221, s63, v166
v_mfma_f32_16x16x32_bf16 v[92:95], a[108:111], v[40:43], v[92:95]
v_lshlrev_b32 v222, 16, v167
v_and_b32 v223, s63, v167
v_fma_f32 v216, v216, v202, v203
v_fma_f32 v217, v217, v202, v203
s_waitcnt lgkmcnt(6)
v_mfma_f32_16x16x32_bf16 v[96:99], a[96:99], v[44:47], v[96:99]
ds_read_b64_tr_b16 v[40:41], v18 offset:32768
v_fma_f32 v218, v218, v202, v203
v_fma_f32 v219, v219, v202, v203
v_fma_f32 v220, v220, v202, v203
v_mfma_f32_16x16x32_bf16 v[100:103], a[100:103], v[44:47], v[100:103]
ds_read_b64_tr_b16 v[42:43], v18 offset:33792
v_fma_f32 v221, v221, v202, v203
v_fma_f32 v222, v222, v202, v203
v_fma_f32 v223, v223, v202, v203
v_mfma_f32_16x16x32_bf16 v[104:107], a[104:107], v[44:47], v[104:107]
v_cvt_pk_bf16_f32 v164, v216, v217
v_cvt_pk_bf16_f32 v165, v218, v219
v_cvt_pk_bf16_f32 v166, v220, v221
v_cvt_pk_bf16_f32 v167, v222, v223
v_mfma_f32_16x16x32_bf16 v[108:111], a[108:111], v[44:47], v[108:111]
s_add_u32 m0, s44, 131072
s_mov_b32 s45, 1548288
ds_write_b128 v245, v[164:167] offset:32768
v_lshlrev_b32 v208, 16, v168
v_and_b32 v209, s63, v168
s_waitcnt lgkmcnt(6)
v_mfma_f32_16x16x32_bf16 v[48:51], v[32:35], a[112:115], v[48:51]
ds_read_b64_tr_b16 v[44:45], v20 offset:32768
v_lshlrev_b32 v210, 16, v169
v_and_b32 v211, s63, v169
v_lshlrev_b32 v212, 16, v170
v_mfma_f32_16x16x32_bf16 v[52:55], v[32:35], a[116:119], v[52:55]
ds_read_b64_tr_b16 v[46:47], v20 offset:33792
v_and_b32 v213, s63, v170
v_lshlrev_b32 v214, 16, v171
v_and_b32 v215, s63, v171
v_mfma_f32_16x16x32_bf16 v[56:59], v[32:35], a[120:123], v[56:59]
buffer_load_dwordx4 v1, s[12:15], s45 offen lds
v_fma_f32 v208, v208, v204, v205
v_fma_f32 v209, v209, v204, v205
v_fma_f32 v210, v210, v204, v205
v_mfma_f32_16x16x32_bf16 v[60:63], v[32:35], a[124:127], v[60:63]
s_add_u32 m0, s44, 135168
s_mov_b32 s45, 1603584
v_fma_f32 v211, v211, v204, v205
v_fma_f32 v212, v212, v204, v205
v_fma_f32 v213, v213, v204, v205
s_waitcnt lgkmcnt(5)
v_mfma_f32_16x16x32_bf16 v[64:67], a[112:115], v[36:39], v[64:67]
ds_read_b64_tr_b16 v[32:33], v14 offset:40960
v_fma_f32 v214, v214, v204, v205
v_fma_f32 v215, v215, v204, v205
v_cvt_pk_bf16_f32 v168, v208, v209
v_mfma_f32_16x16x32_bf16 v[68:71], a[116:119], v[36:39], v[68:71]
ds_read_b64_tr_b16 v[34:35], v14 offset:41984
v_cvt_pk_bf16_f32 v169, v210, v211
v_cvt_pk_bf16_f32 v170, v212, v213
v_cvt_pk_bf16_f32 v171, v214, v215
v_mfma_f32_16x16x32_bf16 v[72:75], a[120:123], v[36:39], v[72:75]
buffer_load_dwordx4 v1, s[12:15], s45 offen lds
ds_write_b128 v246, v[168:171] offset:33792
v_lshlrev_b32 v216, 16, v172
v_and_b32 v217, s63, v172
v_mfma_f32_16x16x32_bf16 v[76:79], a[124:127], v[36:39], v[76:79]
v_lshlrev_b32 v218, 16, v173
v_and_b32 v219, s63, v173
v_lshlrev_b32 v220, 16, v174
v_and_b32 v221, s63, v174
s_waitcnt lgkmcnt(6)
v_mfma_f32_16x16x32_bf16 v[80:83], a[112:115], v[40:43], v[80:83]
ds_read_b64_tr_b16 v[36:37], v16 offset:40960
v_lshlrev_b32 v222, 16, v175
v_and_b32 v223, s63, v175
v_fma_f32 v216, v216, v206, v207
v_mfma_f32_16x16x32_bf16 v[84:87], a[116:119], v[40:43], v[84:87]
ds_read_b64_tr_b16 v[38:39], v16 offset:41984
v_fma_f32 v217, v217, v206, v207
v_fma_f32 v218, v218, v206, v207
v_fma_f32 v219, v219, v206, v207
v_mfma_f32_16x16x32_bf16 v[88:91], a[120:123], v[40:43], v[88:91]
v_fma_f32 v220, v220, v206, v207
v_fma_f32 v221, v221, v206, v207
v_fma_f32 v222, v222, v206, v207
v_fma_f32 v223, v223, v206, v207
v_mfma_f32_16x16x32_bf16 v[92:95], a[124:127], v[40:43], v[92:95]
v_cvt_pk_bf16_f32 v172, v216, v217
v_cvt_pk_bf16_f32 v173, v218, v219
v_cvt_pk_bf16_f32 v174, v220, v221
v_cvt_pk_bf16_f32 v175, v222, v223
s_waitcnt lgkmcnt(5)
v_mfma_f32_16x16x32_bf16 v[96:99], a[112:115], v[44:47], v[96:99]
ds_read_b64_tr_b16 v[40:41], v18 offset:40960
ds_write_b128 v245, v[172:175] offset:33792
v_mfma_f32_16x16x32_bf16 v[100:103], a[116:119], v[44:47], v[100:103]
ds_read_b64_tr_b16 v[42:43], v18 offset:41984
v_mfma_f32_16x16x32_bf16 v[104:107], a[120:123], v[44:47], v[104:107]
v_mfma_f32_16x16x32_bf16 v[108:111], a[124:127], v[44:47], v[108:111]
s_waitcnt lgkmcnt(6)
v_mfma_f32_16x16x32_bf16 v[48:51], v[32:35], a[128:131], v[48:51]
ds_read_b64_tr_b16 v[44:45], v20 offset:40960
v_mfma_f32_16x16x32_bf16 v[52:55], v[32:35], a[132:135], v[52:55]
ds_read_b64_tr_b16 v[46:47], v20 offset:41984
v_mfma_f32_16x16x32_bf16 v[56:59], v[32:35], a[136:139], v[56:59]
v_mfma_f32_16x16x32_bf16 v[60:63], v[32:35], a[140:143], v[60:63]
s_waitcnt lgkmcnt(5)
v_mfma_f32_16x16x32_bf16 v[64:67], a[128:131], v[36:39], v[64:67]
s_waitcnt vmcnt(6) lgkmcnt(0)
s_barrier
ds_read_b64_tr_b16 v[32:33], v13 offset:40960
v_mfma_f32_16x16x32_bf16 v[68:71], a[132:135], v[36:39], v[68:71]
ds_read_b64_tr_b16 v[34:35], v13 offset:41984
v_mfma_f32_16x16x32_bf16 v[72:75], a[136:139], v[36:39], v[72:75]
v_mfma_f32_16x16x32_bf16 v[76:79], a[140:143], v[36:39], v[76:79]
s_add_u32 m0, s44, 139264
s_mov_b32 s45, 1658880
v_mfma_f32_16x16x32_bf16 v[80:83], a[128:131], v[40:43], v[80:83]
ds_read_b64_tr_b16 v[36:37], v15 offset:40960
ds_read_b128 a[160:163], v247 offset:16384
ds_read_b128 a[164:167], v247 offset:17408
ds_read_b128 a[168:171], v249 offset:16384
v_mfma_f32_16x16x32_bf16 v[84:87], a[132:135], v[40:43], v[84:87]
ds_read_b64_tr_b16 v[38:39], v15 offset:41984
ds_read_b128 a[172:175], v249 offset:17408
ds_read_b128 a[176:179], v248 offset:24576
ds_read_b128 a[180:183], v248 offset:25600
v_mfma_f32_16x16x32_bf16 v[88:91], a[136:139], v[40:43], v[88:91]
buffer_load_dwordx4 v1, s[12:15], s45 offen lds
ds_read_b128 a[184:187], v250 offset:24576
ds_read_b128 a[188:191], v250 offset:25600
v_lshlrev_b32 v208, 16, v176
v_mfma_f32_16x16x32_bf16 v[92:95], a[140:143], v[40:43], v[92:95]
s_add_u32 m0, s44, 143360
s_mov_b32 s45, 1714176
v_and_b32 v209, s63, v176
v_lshlrev_b32 v210, 16, v177
v_and_b32 v211, s63, v177
v_mfma_f32_16x16x32_bf16 v[96:99], a[128:131], v[44:47], v[96:99]
ds_read_b64_tr_b16 v[40:41], v17 offset:40960
v_lshlrev_b32 v212, 16, v178
v_and_b32 v213, s63, v178
v_lshlrev_b32 v214, 16, v179
v_mfma_f32_16x16x32_bf16 v[100:103], a[132:135], v[44:47], v[100:103]
ds_read_b64_tr_b16 v[42:43], v17 offset:41984
v_and_b32 v215, s63, v179
v_fma_f32 v208, v208, v200, v201
v_fma_f32 v209, v209, v200, v201
v_mfma_f32_16x16x32_bf16 v[104:107], a[136:139], v[44:47], v[104:107]
buffer_load_dwordx4 v1, s[12:15], s45 offen lds
v_fma_f32 v210, v210, v200, v201
v_fma_f32 v211, v211, v200, v201
v_fma_f32 v212, v212, v200, v201
v_mfma_f32_16x16x32_bf16 v[108:111], a[140:143], v[44:47], v[108:111]
v_fma_f32 v213, v213, v200, v201
v_fma_f32 v214, v214, v200, v201
v_fma_f32 v215, v215, v200, v201
v_cvt_pk_bf16_f32 v176, v208, v209
s_waitcnt lgkmcnt(12)
v_mfma_f32_16x16x32_bf16 v[48:51], v[32:35], a[144:147], v[48:51]
ds_read_b64_tr_b16 v[44:45], v19 offset:40960
v_cvt_pk_bf16_f32 v177, v210, v211
v_cvt_pk_bf16_f32 v178, v212, v213
v_cvt_pk_bf16_f32 v179, v214, v215
v_mfma_f32_16x16x32_bf16 v[52:55], v[32:35], a[148:151], v[52:55]
ds_read_b64_tr_b16 v[46:47], v19 offset:41984
ds_write_b128 v246, v[176:179] offset:49152
v_lshlrev_b32 v216, 16, v180
v_and_b32 v217, s63, v180
v_mfma_f32_16x16x32_bf16 v[56:59], v[32:35], a[152:155], v[56:59]
v_lshlrev_b32 v218, 16, v181
v_and_b32 v219, s63, v181
v_lshlrev_b32 v220, 16, v182
v_and_b32 v221, s63, v182
v_mfma_f32_16x16x32_bf16 v[60:63], v[32:35], a[156:159], v[60:63]
s_add_u32 m0, s44, 147456
s_mov_b32 s45, 1769472
v_lshlrev_b32 v222, 16, v183
v_and_b32 v223, s63, v183
v_fma_f32 v216, v216, v202, v203
s_waitcnt lgkmcnt(10)
v_mfma_f32_16x16x32_bf16 v[64:67], a[144:147], v[36:39], v[64:67]
ds_read_b64_tr_b16 v[32:33], v13 offset:49152
v_fma_f32 v217, v217, v202, v203
v_fma_f32 v218, v218, v202, v203
v_fma_f32 v219, v219, v202, v203
v_mfma_f32_16x16x32_bf16 v[68:71], a[148:151], v[36:39], v[68:71]
ds_read_b64_tr_b16 v[34:35], v13 offset:50176
v_fma_f32 v220, v220, v202, v203
v_fma_f32 v221, v221, v202, v203
v_fma_f32 v222, v222, v202, v203
v_mfma_f32_16x16x32_bf16 v[72:75], a[152:155], v[36:39], v[72:75]
buffer_load_dwordx4 v1, s[12:15], s45 offen lds
v_fma_f32 v223, v223, v202, v203
v_cvt_pk_bf16_f32 v180, v216, v217
v_cvt_pk_bf16_f32 v181, v218, v219
v_mfma_f32_16x16x32_bf16 v[76:79], a[156:159], v[36:39], v[76:79]
s_add_u32 m0, s44, 151552
s_mov_b32 s45, 1824768
v_cvt_pk_bf16_f32 v182, v220, v221
v_cvt_pk_bf16_f32 v183, v222, v223
ds_write_b128 v245, v[180:183] offset:49152
s_waitcnt lgkmcnt(6)
v_mfma_f32_16x16x32_bf16 v[80:83], a[144:147], v[40:43], v[80:83]
ds_read_b64_tr_b16 v[36:37], v15 offset:49152
v_lshlrev_b32 v208, 16, v184
v_and_b32 v209, s63, v184
v_lshlrev_b32 v210, 16, v185
v_mfma_f32_16x16x32_bf16 v[84:87], a[148:151], v[40:43], v[84:87]
ds_read_b64_tr_b16 v[38:39], v15 offset:50176
v_and_b32 v211, s63, v185
v_lshlrev_b32 v212, 16, v186
v_and_b32 v213, s63, v186
v_mfma_f32_16x16x32_bf16 v[88:91], a[152:155], v[40:43], v[88:91]
buffer_load_dwordx4 v1, s[12:15], s45 offen lds
v_lshlrev_b32 v214, 16, v187
v_and_b32 v215, s63, v187
v_fma_f32 v208, v208, v204, v205
v_mfma_f32_16x16x32_bf16 v[92:95], a[156:159], v[40:43], v[92:95]
v_fma_f32 v209, v209, v204, v205
v_fma_f32 v210, v210, v204, v205
v_fma_f32 v211, v211, v204, v205
v_fma_f32 v212, v212, v204, v205
s_waitcnt lgkmcnt(6)
v_mfma_f32_16x16x32_bf16 v[96:99], a[144:147], v[44:47], v[96:99]
ds_read_b64_tr_b16 v[40:41], v17 offset:49152
v_fma_f32 v213, v213, v204, v205
v_fma_f32 v214, v214, v204, v205
v_fma_f32 v215, v215, v204, v205
v_mfma_f32_16x16x32_bf16 v[100:103], a[148:151], v[44:47], v[100:103]
ds_read_b64_tr_b16 v[42:43], v17 offset:50176
v_cvt_pk_bf16_f32 v184, v208, v209
v_cvt_pk_bf16_f32 v185, v210, v211
v_cvt_pk_bf16_f32 v186, v212, v213
v_mfma_f32_16x16x32_bf16 v[104:107], a[152:155], v[44:47], v[104:107]
v_cvt_pk_bf16_f32 v187, v214, v215
ds_write_b128 v246, v[184:187] offset:50176
v_lshlrev_b32 v216, 16, v188
v_and_b32 v217, s63, v188
v_mfma_f32_16x16x32_bf16 v[108:111], a[156:159], v[44:47], v[108:111]
s_add_u32 m0, s44, 155648
s_mov_b32 s45, 1880064
v_lshlrev_b32 v218, 16, v189
v_and_b32 v219, s63, v189
v_lshlrev_b32 v220, 16, v190
s_waitcnt lgkmcnt(6)
v_mfma_f32_16x16x32_bf16 v[48:51], v[32:35], a[160:163], v[48:51]
ds_read_b64_tr_b16 v[44:45], v19 offset:49152
v_and_b32 v221, s63, v190
v_lshlrev_b32 v222, 16, v191
v_and_b32 v223, s63, v191
v_mfma_f32_16x16x32_bf16 v[52:55], v[32:35], a[164:167], v[52:55]
ds_read_b64_tr_b16 v[46:47], v19 offset:50176
v_fma_f32 v216, v216, v206, v207
v_fma_f32 v217, v217, v206, v207
v_fma_f32 v218, v218, v206, v207
v_mfma_f32_16x16x32_bf16 v[56:59], v[32:35], a[168:171], v[56:59]
buffer_load_dwordx4 v1, s[12:15], s45 offen lds
v_fma_f32 v219, v219, v206, v207
v_fma_f32 v220, v220, v206, v207
v_fma_f32 v221, v221, v206, v207
v_mfma_f32_16x16x32_bf16 v[60:63], v[32:35], a[172:175], v[60:63]
s_add_u32 m0, s44, 159744
s_mov_b32 s45, 1935360
v_fma_f32 v222, v222, v206, v207
v_fma_f32 v223, v223, v206, v207
v_cvt_pk_bf16_f32 v188, v216, v217
s_waitcnt lgkmcnt(5)
v_mfma_f32_16x16x32_bf16 v[64:67], a[160:163], v[36:39], v[64:67]
ds_read_b64_tr_b16 v[32:33], v13 offset:57344
v_cvt_pk_bf16_f32 v189, v218, v219
v_cvt_pk_bf16_f32 v190, v220, v221
v_cvt_pk_bf16_f32 v191, v222, v223
v_mfma_f32_16x16x32_bf16 v[68:71], a[164:167], v[36:39], v[68:71]
ds_read_b64_tr_b16 v[34:35], v13 offset:58368
ds_write_b128 v245, v[188:191] offset:50176
v_add_u32 v240, s44, v23
v_lshlrev_b32 v240, 3, v240
v_mfma_f32_16x16x32_bf16 v[72:75], a[168:171], v[36:39], v[72:75]
buffer_load_dwordx4 v1, s[12:15], s45 offen lds
v_min_u32 v241, 20608, v240
v_min_u32 v240, 2560, v240
buffer_load_dword v251, v241, s[28:31], s68 offen
v_mfma_f32_16x16x32_bf16 v[76:79], a[172:175], v[36:39], v[76:79]
buffer_load_dword v251, v240, s[32:35], s69 offen
v_lshlrev_b32 v208, 16, v224
v_and_b32 v209, s63, v224
v_lshlrev_b32 v210, 16, v225
s_waitcnt lgkmcnt(6)
v_mfma_f32_16x16x32_bf16 v[80:83], a[160:163], v[40:43], v[80:83]
ds_read_b64_tr_b16 v[36:37], v15 offset:57344
v_and_b32 v211, s63, v225
v_lshlrev_b32 v212, 16, v226
v_and_b32 v213, s63, v226
v_mfma_f32_16x16x32_bf16 v[84:87], a[164:167], v[40:43], v[84:87]
ds_read_b64_tr_b16 v[38:39], v15 offset:58368
v_lshlrev_b32 v214, 16, v227
v_and_b32 v215, s63, v227
v_fma_f32 v208, v208, v200, v201
v_mfma_f32_16x16x32_bf16 v[88:91], a[168:171], v[40:43], v[88:91]
v_fma_f32 v209, v209, v200, v201
v_fma_f32 v210, v210, v200, v201
v_fma_f32 v211, v211, v200, v201
v_fma_f32 v212, v212, v200, v201
v_mfma_f32_16x16x32_bf16 v[92:95], a[172:175], v[40:43], v[92:95]
v_fma_f32 v213, v213, v200, v201
v_fma_f32 v214, v214, v200, v201
v_fma_f32 v215, v215, v200, v201
v_cvt_pk_bf16_f32 v224, v208, v209
s_waitcnt lgkmcnt(5)
v_mfma_f32_16x16x32_bf16 v[96:99], a[160:163], v[44:47], v[96:99]
ds_read_b64_tr_b16 v[40:41], v17 offset:57344
v_cvt_pk_bf16_f32 v225, v210, v211
v_cvt_pk_bf16_f32 v226, v212, v213
v_cvt_pk_bf16_f32 v227, v214, v215
v_mfma_f32_16x16x32_bf16 v[100:103], a[164:167], v[44:47], v[100:103]
ds_read_b64_tr_b16 v[42:43], v17 offset:58368
ds_write_b128 v246, v[224:227] offset:0
v_lshlrev_b32 v216, 16, v228
v_and_b32 v217, s63, v228
v_mfma_f32_16x16x32_bf16 v[104:107], a[168:171], v[44:47], v[104:107]
v_lshlrev_b32 v218, 16, v229
v_and_b32 v219, s63, v229
v_lshlrev_b32 v220, 16, v230
v_and_b32 v221, s63, v230
v_mfma_f32_16x16x32_bf16 v[108:111], a[172:175], v[44:47], v[108:111]
v_lshlrev_b32 v222, 16, v231
v_and_b32 v223, s63, v231
v_fma_f32 v216, v216, v202, v203
v_fma_f32 v217, v217, v202, v203
s_waitcnt lgkmcnt(6)
v_mfma_f32_16x16x32_bf16 v[48:51], v[32:35], a[176:179], v[48:51]
ds_read_b64_tr_b16 v[44:45], v19 offset:57344
v_fma_f32 v218, v218, v202, v203
v_fma_f32 v219, v219, v202, v203
v_fma_f32 v220, v220, v202, v203
v_mfma_f32_16x16x32_bf16 v[52:55], v[32:35], a[180:183], v[52:55]
ds_read_b64_tr_b16 v[46:47], v19 offset:58368
v_fma_f32 v221, v221, v202, v203
v_fma_f32 v222, v222, v202, v203
v_fma_f32 v223, v223, v202, v203
v_mfma_f32_16x16x32_bf16 v[56:59], v[32:35], a[184:187], v[56:59]
v_cvt_pk_bf16_f32 v228, v216, v217
v_cvt_pk_bf16_f32 v229, v218, v219
v_cvt_pk_bf16_f32 v230, v220, v221
v_cvt_pk_bf16_f32 v231, v222, v223
v_mfma_f32_16x16x32_bf16 v[60:63], v[32:35], a[188:191], v[60:63]
ds_write_b128 v245, v[228:231] offset:0
v_lshlrev_b32 v208, 16, v232
v_and_b32 v209, s63, v232
v_lshlrev_b32 v210, 16, v233
s_waitcnt lgkmcnt(6)
v_mfma_f32_16x16x32_bf16 v[64:67], a[176:179], v[36:39], v[64:67]
s_waitcnt vmcnt(8) lgkmcnt(0)
s_barrier
ds_read_b64_tr_b16 v[32:33], v14 offset:0
v_and_b32 v211, s63, v233
v_lshlrev_b32 v212, 16, v234
v_mfma_f32_16x16x32_bf16 v[68:71], a[180:183], v[36:39], v[68:71]
ds_read_b64_tr_b16 v[34:35], v14 offset:1024
v_and_b32 v213, s63, v234
v_lshlrev_b32 v214, 16, v235
v_mfma_f32_16x16x32_bf16 v[72:75], a[184:187], v[36:39], v[72:75]
v_and_b32 v215, s63, v235
v_fma_f32 v208, v208, v204, v205
v_fma_f32 v209, v209, v204, v205
v_mfma_f32_16x16x32_bf16 v[76:79], a[188:191], v[36:39], v[76:79]
s_add_u32 m0, s44, 90112
s_add_u32 s45, s48, 0
v_fma_f32 v210, v210, v204, v205
v_fma_f32 v211, v211, v204, v205
v_mfma_f32_16x16x32_bf16 v[80:83], a[176:179], v[40:43], v[80:83]
ds_read_b64_tr_b16 v[36:37], v16 offset:0
ds_read_b128 a[192:195], v247 offset:32768
ds_read_b128 a[196:199], v247 offset:33792
v_mfma_f32_16x16x32_bf16 v[84:87], a[180:183], v[40:43], v[84:87]
ds_read_b64_tr_b16 v[38:39], v16 offset:1024
ds_read_b128 a[200:203], v249 offset:32768
ds_read_b128 a[204:207], v249 offset:33792
v_mfma_f32_16x16x32_bf16 v[88:91], a[184:187], v[40:43], v[88:91]
buffer_load_dwordx4 v2, s[16:19], s45 offen lds
ds_read_b128 a[208:211], v248 offset:40960
ds_read_b128 a[212:215], v248 offset:41984
v_mfma_f32_16x16x32_bf16 v[92:95], a[188:191], v[40:43], v[92:95]
s_add_u32 m0, s44, 94208
s_add_u32 s45, s48, 294912
ds_read_b128 a[216:219], v250 offset:40960
ds_read_b128 a[220:223], v250 offset:41984
v_mfma_f32_16x16x32_bf16 v[96:99], a[176:179], v[44:47], v[96:99]
ds_read_b64_tr_b16 v[40:41], v18 offset:0
ds_read_b128 a[224:227], v247 offset:49152
ds_read_b128 a[228:231], v247 offset:50176
v_mfma_f32_16x16x32_bf16 v[100:103], a[180:183], v[44:47], v[100:103]
ds_read_b64_tr_b16 v[42:43], v18 offset:1024
ds_read_b128 a[232:235], v249 offset:49152
ds_read_b128 a[236:239], v249 offset:50176
v_mfma_f32_16x16x32_bf16 v[104:107], a[184:187], v[44:47], v[104:107]
buffer_load_dwordx4 v2, s[16:19], s45 offen lds
ds_read_b128 a[240:243], v248 offset:57344
ds_read_b128 a[244:247], v248 offset:58368
v_mfma_f32_16x16x32_bf16 v[108:111], a[188:191], v[44:47], v[108:111]
ds_read_b128 a[248:251], v250 offset:57344
ds_read_b128 a[252:255], v250 offset:58368
v_fma_f32 v212, v212, v204, v205
s_waitcnt lgkmcnt(15)
v_mfma_f32_16x16x32_bf16 v[48:51], v[32:35], a[192:195], v[48:51]
ds_read_b64_tr_b16 v[44:45], v20 offset:0
v_fma_f32 v213, v213, v204, v205
v_fma_f32 v214, v214, v204, v205
v_mfma_f32_16x16x32_bf16 v[52:55], v[32:35], a[196:199], v[52:55]
ds_read_b64_tr_b16 v[46:47], v20 offset:1024
v_fma_f32 v215, v215, v204, v205
v_cvt_pk_bf16_f32 v232, v208, v209
v_mfma_f32_16x16x32_bf16 v[56:59], v[32:35], a[200:203], v[56:59]
v_cvt_pk_bf16_f32 v233, v210, v211
v_cvt_pk_bf16_f32 v234, v212, v213
v_cvt_pk_bf16_f32 v235, v214, v215
s_waitcnt lgkmcnt(15)
v_mfma_f32_16x16x32_bf16 v[60:63], v[32:35], a[204:207], v[60:63]
s_add_u32 m0, s44, 98304
s_add_u32 s45, s48, 589824
ds_write_b128 v246, v[232:235] offset:1024
v_lshlrev_b32 v216, 16, v236
v_mfma_f32_16x16x32_bf16 v[64:67], a[192:195], v[36:39], v[64:67]
ds_read_b64_tr_b16 v[32:33], v14 offset:8192
v_and_b32 v217, s63, v236
v_lshlrev_b32 v218, 16, v237
v_mfma_f32_16x16x32_bf16 v[68:71], a[196:199], v[36:39], v[68:71]
ds_read_b64_tr_b16 v[34:35], v14 offset:9216
v_and_b32 v219, s63, v237
v_lshlrev_b32 v220, 16, v238
v_mfma_f32_16x16x32_bf16 v[72:75], a[200:203], v[36:39], v[72:75]
buffer_load_dwordx4 v2, s[16:19], s45 offen lds
v_and_b32 v221, s63, v238
v_lshlrev_b32 v222, 16, v239
v_mfma_f32_16x16x32_bf16 v[76:79], a[204:207], v[36:39], v[76:79]
s_add_u32 m0, s44, 102400
s_add_u32 s45, s48, 884736
v_and_b32 v223, s63, v239
v_fma_f32 v216, v216, v206, v207
s_waitcnt lgkmcnt(11)
v_mfma_f32_16x16x32_bf16 v[80:83], a[192:195], v[40:43], v[80:83]
ds_read_b64_tr_b16 v[36:37], v16 offset:8192
v_fma_f32 v217, v217, v206, v207
v_fma_f32 v218, v218, v206, v207
v_mfma_f32_16x16x32_bf16 v[84:87], a[196:199], v[40:43], v[84:87]
ds_read_b64_tr_b16 v[38:39], v16 offset:9216
v_fma_f32 v219, v219, v206, v207
v_fma_f32 v220, v220, v206, v207
v_mfma_f32_16x16x32_bf16 v[88:91], a[200:203], v[40:43], v[88:91]
buffer_load_dwordx4 v2, s[16:19], s45 offen lds
v_fma_f32 v221, v221, v206, v207
v_fma_f32 v222, v222, v206, v207
v_mfma_f32_16x16x32_bf16 v[92:95], a[204:207], v[40:43], v[92:95]
v_fma_f32 v223, v223, v206, v207
v_cvt_pk_bf16_f32 v236, v216, v217
v_cvt_pk_bf16_f32 v237, v218, v219
s_waitcnt lgkmcnt(5)
v_mfma_f32_16x16x32_bf16 v[96:99], a[192:195], v[44:47], v[96:99]
ds_read_b64_tr_b16 v[40:41], v18 offset:8192
v_cvt_pk_bf16_f32 v238, v220, v221
v_cvt_pk_bf16_f32 v239, v222, v223
v_mfma_f32_16x16x32_bf16 v[100:103], a[196:199], v[44:47], v[100:103]
ds_read_b64_tr_b16 v[42:43], v18 offset:9216
ds_write_b128 v245, v[236:239] offset:1024
v_mfma_f32_16x16x32_bf16 v[104:107], a[200:203], v[44:47], v[104:107]
v_mfma_f32_16x16x32_bf16 v[108:111], a[204:207], v[44:47], v[108:111]
s_add_u32 m0, s44, 106496
s_add_u32 s45, s48, 1179648
s_waitcnt lgkmcnt(5)
v_mfma_f32_16x16x32_bf16 v[48:51], v[32:35], a[208:211], v[48:51]
ds_read_b64_tr_b16 v[44:45], v20 offset:8192
v_mfma_f32_16x16x32_bf16 v[52:55], v[32:35], a[212:215], v[52:55]
ds_read_b64_tr_b16 v[46:47], v20 offset:9216
v_mfma_f32_16x16x32_bf16 v[56:59], v[32:35], a[216:219], v[56:59]
buffer_load_dwordx4 v2, s[16:19], s45 offen lds
v_mfma_f32_16x16x32_bf16 v[60:63], v[32:35], a[220:223], v[60:63]
s_add_u32 m0, s44, 110592
s_add_u32 s45, s48, 1474560
s_waitcnt lgkmcnt(5)
v_mfma_f32_16x16x32_bf16 v[64:67], a[208:211], v[36:39], v[64:67]
ds_read_b64_tr_b16 v[32:33], v14 offset:16384
v_mfma_f32_16x16x32_bf16 v[68:71], a[212:215], v[36:39], v[68:71]
ds_read_b64_tr_b16 v[34:35], v14 offset:17408
v_mfma_f32_16x16x32_bf16 v[72:75], a[216:219], v[36:39], v[72:75]
buffer_load_dwordx4 v2, s[16:19], s45 offen lds
v_mfma_f32_16x16x32_bf16 v[76:79], a[220:223], v[36:39], v[76:79]
s_waitcnt lgkmcnt(5)
v_mfma_f32_16x16x32_bf16 v[80:83], a[208:211], v[40:43], v[80:83]
ds_read_b64_tr_b16 v[36:37], v16 offset:16384
v_mfma_f32_16x16x32_bf16 v[84:87], a[212:215], v[40:43], v[84:87]
ds_read_b64_tr_b16 v[38:39], v16 offset:17408
v_mfma_f32_16x16x32_bf16 v[88:91], a[216:219], v[40:43], v[88:91]
v_mfma_f32_16x16x32_bf16 v[92:95], a[220:223], v[40:43], v[92:95]
s_waitcnt lgkmcnt(4)
v_mfma_f32_16x16x32_bf16 v[96:99], a[208:211], v[44:47], v[96:99]
ds_read_b64_tr_b16 v[40:41], v18 offset:16384
v_mfma_f32_16x16x32_bf16 v[100:103], a[212:215], v[44:47], v[100:103]
ds_read_b64_tr_b16 v[42:43], v18 offset:17408
v_mfma_f32_16x16x32_bf16 v[104:107], a[216:219], v[44:47], v[104:107]
v_mfma_f32_16x16x32_bf16 v[108:111], a[220:223], v[44:47], v[108:111]
s_waitcnt lgkmcnt(4)
v_mfma_f32_16x16x32_bf16 v[48:51], v[32:35], a[224:227], v[48:51]
ds_read_b64_tr_b16 v[44:45], v20 offset:16384
v_mfma_f32_16x16x32_bf16 v[52:55], v[32:35], a[228:231], v[52:55]
ds_read_b64_tr_b16 v[46:47], v20 offset:17408
v_mfma_f32_16x16x32_bf16 v[56:59], v[32:35], a[232:235], v[56:59]
v_mfma_f32_16x16x32_bf16 v[60:63], v[32:35], a[236:239], v[60:63]
s_waitcnt lgkmcnt(4)
v_mfma_f32_16x16x32_bf16 v[64:67], a[224:227], v[36:39], v[64:67]
s_waitcnt vmcnt(8) lgkmcnt(0)
s_barrier
ds_read_b64_tr_b16 v[32:33], v14 offset:24576
v_mfma_f32_16x16x32_bf16 v[68:71], a[228:231], v[36:39], v[68:71]
ds_read_b64_tr_b16 v[34:35], v14 offset:25600
v_mfma_f32_16x16x32_bf16 v[72:75], a[232:235], v[36:39], v[72:75]
v_mfma_f32_16x16x32_bf16 v[76:79], a[236:239], v[36:39], v[76:79]
s_add_u32 m0, s44, 114688
s_add_u32 s45, s48, 1769472
v_mfma_f32_16x16x32_bf16 v[80:83], a[224:227], v[40:43], v[80:83]
ds_read_b64_tr_b16 v[36:37], v16 offset:24576
ds_read_b128 v[144:147], v247 offset:0
ds_read_b128 v[148:151], v247 offset:1024
v_mfma_f32_16x16x32_bf16 v[84:87], a[228:231], v[40:43], v[84:87]
ds_read_b64_tr_b16 v[38:39], v16 offset:25600
ds_read_b128 v[152:155], v249 offset:0
ds_read_b128 v[156:159], v249 offset:1024
v_mfma_f32_16x16x32_bf16 v[88:91], a[232:235], v[40:43], v[88:91]
buffer_load_dwordx4 v2, s[16:19], s45 offen lds
ds_read_b128 v[160:163], v248 offset:8192
ds_read_b128 v[164:167], v248 offset:9216
v_mfma_f32_16x16x32_bf16 v[92:95], a[236:239], v[40:43], v[92:95]
s_add_u32 m0, s44, 118784
s_add_u32 s45, s48, 2064384
ds_read_b128 v[168:171], v250 offset:8192
ds_read_b128 v[172:175], v250 offset:9216
v_mfma_f32_16x16x32_bf16 v[96:99], a[224:227], v[44:47], v[96:99]
ds_read_b64_tr_b16 v[40:41], v18 offset:24576
v_mfma_f32_16x16x32_bf16 v[100:103], a[228:231], v[44:47], v[100:103]
ds_read_b64_tr_b16 v[42:43], v18 offset:25600
v_mfma_f32_16x16x32_bf16 v[104:107], a[232:235], v[44:47], v[104:107]
buffer_load_dwordx4 v2, s[16:19], s45 offen lds
v_mfma_f32_16x16x32_bf16 v[108:111], a[236:239], v[44:47], v[108:111]
s_waitcnt lgkmcnt(12)
v_mfma_f32_16x16x32_bf16 v[48:51], v[32:35], a[240:243], v[48:51]
ds_read_b64_tr_b16 v[44:45], v20 offset:24576
v_mfma_f32_16x16x32_bf16 v[52:55], v[32:35], a[244:247], v[52:55]
ds_read_b64_tr_b16 v[46:47], v20 offset:25600
v_mfma_f32_16x16x32_bf16 v[56:59], v[32:35], a[248:251], v[56:59]
v_mfma_f32_16x16x32_bf16 v[60:63], v[32:35], a[252:255], v[60:63]
s_add_u32 m0, s44, 122880
s_add_u32 s45, s48, 2359296
s_waitcnt lgkmcnt(10)
v_mfma_f32_16x16x32_bf16 v[64:67], a[240:243], v[36:39], v[64:67]
ds_read_b64_tr_b16 v[32:33], v14 offset:32768
v_mfma_f32_16x16x32_bf16 v[68:71], a[244:247], v[36:39], v[68:71]
ds_read_b64_tr_b16 v[34:35], v14 offset:33792
v_mfma_f32_16x16x32_bf16 v[72:75], a[248:251], v[36:39], v[72:75]
buffer_load_dwordx4 v2, s[16:19], s45 offen lds
v_mfma_f32_16x16x32_bf16 v[76:79], a[252:255], v[36:39], v[76:79]
s_add_u32 m0, s44, 126976
s_add_u32 s45, s48, 2654208
s_waitcnt lgkmcnt(4)
v_mfma_f32_16x16x32_bf16 v[80:83], a[240:243], v[40:43], v[80:83]
ds_read_b64_tr_b16 v[36:37], v16 offset:32768
v_mfma_f32_16x16x32_bf16 v[84:87], a[244:247], v[40:43], v[84:87]
ds_read_b64_tr_b16 v[38:39], v16 offset:33792
v_mfma_f32_16x16x32_bf16 v[88:91], a[248:251], v[40:43], v[88:91]
buffer_load_dwordx4 v2, s[16:19], s45 offen lds
v_mfma_f32_16x16x32_bf16 v[92:95], a[252:255], v[40:43], v[92:95]
s_waitcnt lgkmcnt(4)
v_mfma_f32_16x16x32_bf16 v[96:99], a[240:243], v[44:47], v[96:99]
ds_read_b64_tr_b16 v[40:41], v18 offset:32768
v_mfma_f32_16x16x32_bf16 v[100:103], a[244:247], v[44:47], v[100:103]
ds_read_b64_tr_b16 v[42:43], v18 offset:33792
v_mfma_f32_16x16x32_bf16 v[104:107], a[248:251], v[44:47], v[104:107]
v_mfma_f32_16x16x32_bf16 v[108:111], a[252:255], v[44:47], v[108:111]
s_add_u32 m0, s44, 131072
s_add_u32 s45, s48, 2949120
s_waitcnt lgkmcnt(4)
v_mfma_f32_16x16x32_bf16 v[48:51], v[32:35], v[144:147], v[48:51]
ds_read_b64_tr_b16 v[44:45], v20 offset:32768
v_mfma_f32_16x16x32_bf16 v[52:55], v[32:35], v[148:151], v[52:55]
ds_read_b64_tr_b16 v[46:47], v20 offset:33792
v_mfma_f32_16x16x32_bf16 v[56:59], v[32:35], v[152:155], v[56:59]
buffer_load_dwordx4 v2, s[16:19], s45 offen lds
v_mfma_f32_16x16x32_bf16 v[60:63], v[32:35], v[156:159], v[60:63]
s_add_u32 m0, s44, 135168
s_add_u32 s45, s48, 3244032
s_waitcnt lgkmcnt(4)
v_mfma_f32_16x16x32_bf16 v[64:67], v[144:147], v[36:39], v[64:67]
ds_read_b64_tr_b16 v[32:33], v14 offset:40960
v_mfma_f32_16x16x32_bf16 v[68:71], v[148:151], v[36:39], v[68:71]
ds_read_b64_tr_b16 v[34:35], v14 offset:41984
v_mfma_f32_16x16x32_bf16 v[72:75], v[152:155], v[36:39], v[72:75]
buffer_load_dwordx4 v2, s[16:19], s45 offen lds
v_mfma_f32_16x16x32_bf16 v[76:79], v[156:159], v[36:39], v[76:79]
s_waitcnt lgkmcnt(4)
v_mfma_f32_16x16x32_bf16 v[80:83], v[144:147], v[40:43], v[80:83]
ds_read_b64_tr_b16 v[36:37], v16 offset:40960
v_mfma_f32_16x16x32_bf16 v[84:87], v[148:151], v[40:43], v[84:87]
ds_read_b64_tr_b16 v[38:39], v16 offset:41984
v_mfma_f32_16x16x32_bf16 v[88:91], v[152:155], v[40:43], v[88:91]
v_mfma_f32_16x16x32_bf16 v[92:95], v[156:159], v[40:43], v[92:95]
s_waitcnt lgkmcnt(4)
v_mfma_f32_16x16x32_bf16 v[96:99], v[144:147], v[44:47], v[96:99]
ds_read_b64_tr_b16 v[40:41], v18 offset:40960
v_mfma_f32_16x16x32_bf16 v[100:103], v[148:151], v[44:47], v[100:103]
ds_read_b64_tr_b16 v[42:43], v18 offset:41984
v_mfma_f32_16x16x32_bf16 v[104:107], v[152:155], v[44:47], v[104:107]
v_mfma_f32_16x16x32_bf16 v[108:111], v[156:159], v[44:47], v[108:111]
s_waitcnt lgkmcnt(4)
v_mfma_f32_16x16x32_bf16 v[48:51], v[32:35], v[160:163], v[48:51]
ds_read_b64_tr_b16 v[44:45], v20 offset:40960
v_mfma_f32_16x16x32_bf16 v[52:55], v[32:35], v[164:167], v[52:55]
ds_read_b64_tr_b16 v[46:47], v20 offset:41984
v_mfma_f32_16x16x32_bf16 v[56:59], v[32:35], v[168:171], v[56:59]
v_mfma_f32_16x16x32_bf16 v[60:63], v[32:35], v[172:175], v[60:63]
s_waitcnt lgkmcnt(4)
v_mfma_f32_16x16x32_bf16 v[64:67], v[160:163], v[36:39], v[64:67]
s_waitcnt vmcnt(6) lgkmcnt(0)
s_barrier
ds_read_b64_tr_b16 v[32:33], v7 offset:40960
v_mfma_f32_16x16x32_bf16 v[68:71], v[164:167], v[36:39], v[68:71]
ds_read_b64_tr_b16 v[34:35], v7 offset:41216
v_mfma_f32_16x16x32_bf16 v[72:75], v[168:171], v[36:39], v[72:75]
v_mfma_f32_16x16x32_bf16 v[76:79], v[172:175], v[36:39], v[76:79]
s_add_u32 m0, s44, 139264
s_add_u32 s45, s48, 3538944
v_mfma_f32_16x16x32_bf16 v[80:83], v[160:163], v[40:43], v[80:83]
ds_read_b64_tr_b16 v[36:37], v9 offset:40960
v_mfma_f32_16x16x32_bf16 v[84:87], v[164:167], v[40:43], v[84:87]
ds_read_b64_tr_b16 v[38:39], v9 offset:41216
v_mfma_f32_16x16x32_bf16 v[88:91], v[168:171], v[40:43], v[88:91]
buffer_load_dwordx4 v2, s[16:19], s45 offen lds
v_mfma_f32_16x16x32_bf16 v[92:95], v[172:175], v[40:43], v[92:95]
s_add_u32 m0, s44, 143360
s_add_u32 s45, s48, 3833856
v_mfma_f32_16x16x32_bf16 v[96:99], v[160:163], v[44:47], v[96:99]
ds_read_b64_tr_b16 v[40:41], v7 offset:45056
s_add_u32 s88, s100, 0
buffer_store_dwordx4 v[252:255], v23, s[36:39], s88 offen sc1
v_mfma_f32_16x16x32_bf16 v[100:103], v[164:167], v[44:47], v[100:103]
ds_read_b64_tr_b16 v[42:43], v7 offset:45312
v_mfma_f32_16x16x32_bf16 v[104:107], v[168:171], v[44:47], v[104:107]
buffer_load_dwordx4 v2, s[16:19], s45 offen lds
v_mfma_f32_16x16x32_bf16 v[108:111], v[172:175], v[44:47], v[108:111]
s_waitcnt lgkmcnt(4)
v_mfma_f32_16x16x32_bf16 v[112:115], v[32:35], a[0:3], 0
ds_read_b64_tr_b16 v[44:45], v9 offset:45056
v_mfma_f32_16x16x32_bf16 v[116:119], v[32:35], a[4:7], 0
ds_read_b64_tr_b16 v[46:47], v9 offset:45312
v_mfma_f32_16x16x32_bf16 v[120:123], v[32:35], a[8:11], 0
v_mfma_f32_16x16x32_bf16 v[124:127], v[32:35], a[12:15], 0
s_add_u32 m0, s44, 147456
s_add_u32 s45, s48, 4128768
s_waitcnt lgkmcnt(4)
v_mfma_f32_16x16x32_bf16 v[128:131], v[36:39], a[0:3], 0
ds_read_b64_tr_b16 v[32:33], v7 offset:49152
v_mul_f32 v240, s64, v64
v_mul_f32 v241, s65, v65
v_mfma_f32_16x16x32_bf16 v[132:135], v[36:39], a[4:7], 0
ds_read_b64_tr_b16 v[34:35], v7 offset:49408
v_mul_f32 v242, s64, v66
v_mul_f32 v243, s65, v67
v_mfma_f32_16x16x32_bf16 v[136:139], v[36:39], a[8:11], 0
buffer_load_dwordx4 v2, s[16:19], s45 offen lds
v_mul_f32 v244, s64, v68
v_mul_f32 v245, s65, v69
v_mfma_f32_16x16x32_bf16 v[140:143], v[36:39], a[12:15], 0
s_add_u32 m0, s44, 151552
s_add_u32 s45, s48, 4423680
v_mul_f32 v246, s64, v70
v_mul_f32 v247, s65, v71
s_waitcnt lgkmcnt(4)
v_mfma_f32_16x16x32_bf16 v[112:115], v[40:43], a[16:19], v[112:115]
ds_read_b64_tr_b16 v[36:37], v9 offset:49152
v_exp_f32 v240, v240 clamp
v_mfma_f32_16x16x32_bf16 v[116:119], v[40:43], a[20:23], v[116:119]
ds_read_b64_tr_b16 v[38:39], v9 offset:49408
v_exp_f32 v241, v241 clamp
v_mfma_f32_16x16x32_bf16 v[120:123], v[40:43], a[24:27], v[120:123]
buffer_load_dwordx4 v2, s[16:19], s45 offen lds
v_exp_f32 v242, v242 clamp
v_mfma_f32_16x16x32_bf16 v[124:127], v[40:43], a[28:31], v[124:127]
v_exp_f32 v243, v243 clamp
s_waitcnt lgkmcnt(4)
v_mfma_f32_16x16x32_bf16 v[128:131], v[44:47], a[16:19], v[128:131]
ds_read_b64_tr_b16 v[40:41], v7 offset:53248
v_exp_f32 v244, v244 clamp
v_mfma_f32_16x16x32_bf16 v[132:135], v[44:47], a[20:23], v[132:135]
ds_read_b64_tr_b16 v[42:43], v7 offset:53504
v_exp_f32 v245, v245 clamp
v_mfma_f32_16x16x32_bf16 v[136:139], v[44:47], a[24:27], v[136:139]
v_exp_f32 v246, v246 clamp
v_mfma_f32_16x16x32_bf16 v[140:143], v[44:47], a[28:31], v[140:143]
s_add_u32 m0, s44, 155648
s_add_u32 s45, s48, 4718592
v_exp_f32 v247, v247 clamp
s_waitcnt lgkmcnt(4)
v_mfma_f32_16x16x32_bf16 v[112:115], v[32:35], a[32:35], v[112:115]
ds_read_b64_tr_b16 v[44:45], v9 offset:53248
v_max_f32 v64, 0, v64
v_mfma_f32_16x16x32_bf16 v[116:119], v[32:35], a[36:39], v[116:119]
ds_read_b64_tr_b16 v[46:47], v9 offset:53504
v_max_f32 v65, 0, v65
v_max_f32 v66, 0, v66
v_mfma_f32_16x16x32_bf16 v[120:123], v[32:35], a[40:43], v[120:123]
buffer_load_dwordx4 v2, s[16:19], s45 offen lds
v_max_f32 v67, 0, v67
v_max_f32 v68, 0, v68
v_mfma_f32_16x16x32_bf16 v[124:127], v[32:35], a[44:47], v[124:127]
s_add_u32 m0, s44, 159744
s_add_u32 s45, s48, 5013504
v_max_f32 v69, 0, v69
v_max_f32 v70, 0, v70
s_waitcnt lgkmcnt(4)
v_mfma_f32_16x16x32_bf16 v[128:131], v[36:39], a[32:35], v[128:131]
ds_read_b64_tr_b16 v[32:33], v7 offset:57344
v_max_f32 v71, 0, v71
v_add_f32 v64, v240, v64
v_mfma_f32_16x16x32_bf16 v[132:135], v[36:39], a[36:39], v[132:135]
ds_read_b64_tr_b16 v[34:35], v7 offset:57600
v_add_f32 v65, v241, v65
v_add_f32 v66, v242, v66
v_mfma_f32_16x16x32_bf16 v[136:139], v[36:39], a[40:43], v[136:139]
buffer_load_dwordx4 v2, s[16:19], s45 offen lds
v_add_f32 v67, v243, v67
v_add_f32 v68, v244, v68
v_mfma_f32_16x16x32_bf16 v[140:143], v[36:39], a[44:47], v[140:143]
v_add_f32 v69, v245, v69
v_add_f32 v70, v246, v70
v_add_f32 v71, v247, v71
s_waitcnt lgkmcnt(4)
v_mfma_f32_16x16x32_bf16 v[112:115], v[40:43], a[48:51], v[112:115]
ds_read_b64_tr_b16 v[36:37], v9 offset:57344
v_add_f32 v64, s66, v64
v_add_f32 v65, s67, v65
v_mfma_f32_16x16x32_bf16 v[116:119], v[40:43], a[52:55], v[116:119]
ds_read_b64_tr_b16 v[38:39], v9 offset:57600
v_add_f32 v66, s66, v66
v_add_f32 v67, s67, v67
v_mfma_f32_16x16x32_bf16 v[120:123], v[40:43], a[56:59], v[120:123]
v_add_f32 v68, s66, v68
v_add_f32 v69, s67, v69
v_add_f32 v70, s66, v70
v_mfma_f32_16x16x32_bf16 v[124:127], v[40:43], a[60:63], v[124:127]
s_add_u32 m0, s44, 49152
s_add_u32 s45, s48, 0
v_add_f32 v71, s67, v71
v_mul_f32 v240, s64, v72
s_waitcnt lgkmcnt(4)
v_mfma_f32_16x16x32_bf16 v[128:131], v[44:47], a[48:51], v[128:131]
ds_read_b64_tr_b16 v[40:41], v7 offset:61440
v_mul_f32 v241, s65, v73
v_mul_f32 v242, s64, v74
v_mfma_f32_16x16x32_bf16 v[132:135], v[44:47], a[52:55], v[132:135]
ds_read_b64_tr_b16 v[42:43], v7 offset:61696
v_mul_f32 v243, s65, v75
v_mul_f32 v244, s64, v76
v_mfma_f32_16x16x32_bf16 v[136:139], v[44:47], a[56:59], v[136:139]
buffer_load_dwordx4 v2, s[20:23], s45 offen lds
v_mul_f32 v245, s65, v77
v_mul_f32 v246, s64, v78
v_mfma_f32_16x16x32_bf16 v[140:143], v[44:47], a[60:63], v[140:143]
s_add_u32 m0, s44, 53248
s_add_u32 s45, s48, 294912
v_mul_f32 v247, s65, v79
v_exp_f32 v240, v240 clamp
s_waitcnt lgkmcnt(4)
v_mfma_f32_16x16x32_bf16 v[112:115], v[32:35], a[64:67], v[112:115]
ds_read_b64_tr_b16 v[44:45], v9 offset:61440
v_exp_f32 v241, v241 clamp
v_mfma_f32_16x16x32_bf16 v[116:119], v[32:35], a[68:71], v[116:119]
ds_read_b64_tr_b16 v[46:47], v9 offset:61696
v_exp_f32 v242, v242 clamp
v_mfma_f32_16x16x32_bf16 v[120:123], v[32:35], a[72:75], v[120:123]
buffer_load_dwordx4 v2, s[20:23], s45 offen lds
v_exp_f32 v243, v243 clamp
v_mfma_f32_16x16x32_bf16 v[124:127], v[32:35], a[76:79], v[124:127]
v_exp_f32 v244, v244 clamp
s_waitcnt lgkmcnt(4)
v_mfma_f32_16x16x32_bf16 v[128:131], v[36:39], a[64:67], v[128:131]
s_waitcnt vmcnt(9) lgkmcnt(0)
s_barrier
ds_read_b64_tr_b16 v[32:33], v8 offset:0
v_exp_f32 v245, v245 clamp
v_mfma_f32_16x16x32_bf16 v[132:135], v[36:39], a[68:71], v[132:135]
ds_read_b64_tr_b16 v[34:35], v8 offset:256
v_exp_f32 v246, v246 clamp
v_mfma_f32_16x16x32_bf16 v[136:139], v[36:39], a[72:75], v[136:139]
v_exp_f32 v247, v247 clamp
v_mfma_f32_16x16x32_bf16 v[140:143], v[36:39], a[76:79], v[140:143]
s_add_u32 m0, s44, 57344
s_add_u32 s45, s48, 589824
v_max_f32 v72, 0, v72
v_mfma_f32_16x16x32_bf16 v[112:115], v[40:43], a[80:83], v[112:115]
ds_read_b64_tr_b16 v[36:37], v10 offset:0
v_max_f32 v73, 0, v73
v_max_f32 v74, 0, v74
v_mfma_f32_16x16x32_bf16 v[116:119], v[40:43], a[84:87], v[116:119]
ds_read_b64_tr_b16 v[38:39], v10 offset:256
v_max_f32 v75, 0, v75
v_max_f32 v76, 0, v76
v_mfma_f32_16x16x32_bf16 v[120:123], v[40:43], a[88:91], v[120:123]
buffer_load_dwordx4 v2, s[20:23], s45 offen lds
v_max_f32 v77, 0, v77
v_max_f32 v78, 0, v78
v_mfma_f32_16x16x32_bf16 v[124:127], v[40:43], a[92:95], v[124:127]
s_add_u32 m0, s44, 61440
s_add_u32 s45, s48, 884736
v_max_f32 v79, 0, v79
v_add_f32 v72, v240, v72
v_mfma_f32_16x16x32_bf16 v[128:131], v[44:47], a[80:83], v[128:131]
ds_read_b64_tr_b16 v[40:41], v8 offset:4096
v_add_f32 v73, v241, v73
v_add_f32 v74, v242, v74
v_mfma_f32_16x16x32_bf16 v[132:135], v[44:47], a[84:87], v[132:135]
ds_read_b64_tr_b16 v[42:43], v8 offset:4352
v_add_f32 v75, v243, v75
v_add_f32 v76, v244, v76
v_mfma_f32_16x16x32_bf16 v[136:139], v[44:47], a[88:91], v[136:139]
buffer_load_dwordx4 v2, s[20:23], s45 offen lds
v_add_f32 v77, v245, v77
v_add_f32 v78, v246, v78
v_mfma_f32_16x16x32_bf16 v[140:143], v[44:47], a[92:95], v[140:143]
v_add_f32 v79, v247, v79
v_add_f32 v72, s66, v72
v_add_f32 v73, s67, v73
s_waitcnt lgkmcnt(4)
v_mfma_f32_16x16x32_bf16 v[112:115], v[32:35], a[96:99], v[112:115]
ds_read_b64_tr_b16 v[44:45], v10 offset:4096
v_add_f32 v74, s66, v74
v_add_f32 v75, s67, v75
v_mfma_f32_16x16x32_bf16 v[116:119], v[32:35], a[100:103], v[116:119]
ds_read_b64_tr_b16 v[46:47], v10 offset:4352
v_add_f32 v76, s66, v76
v_add_f32 v77, s67, v77
v_mfma_f32_16x16x32_bf16 v[120:123], v[32:35], a[104:107], v[120:123]
v_add_f32 v78, s66, v78
v_add_f32 v79, s67, v79
v_cvt_pk_bf16_f32 v192, v64, v65
v_mfma_f32_16x16x32_bf16 v[124:127], v[32:35], a[108:111], v[124:127]
s_add_u32 m0, s44, 65536
s_add_u32 s45, s48, 1179648
v_cvt_pk_bf16_f32 v193, v66, v67
v_cvt_pk_bf16_f32 v194, v68, v69
s_waitcnt lgkmcnt(4)
v_mfma_f32_16x16x32_bf16 v[128:131], v[36:39], a[96:99], v[128:131]
ds_read_b64_tr_b16 v[32:33], v8 offset:8192
v_cvt_pk_bf16_f32 v195, v70, v71
v_cvt_pk_bf16_f32 v196, v72, v73
v_mfma_f32_16x16x32_bf16 v[132:135], v[36:39], a[100:103], v[132:135]
ds_read_b64_tr_b16 v[34:35], v8 offset:8448
v_cvt_pk_bf16_f32 v197, v74, v75
v_cvt_pk_bf16_f32 v198, v76, v77
v_mfma_f32_16x16x32_bf16 v[136:139], v[36:39], a[104:107], v[136:139]
buffer_load_dwordx4 v2, s[20:23], s45 offen lds
v_cvt_pk_bf16_f32 v199, v78, v79
v_mul_f32 v240, s64, v48
v_mfma_f32_16x16x32_bf16 v[140:143], v[36:39], a[108:111], v[140:143]
s_add_u32 m0, s44, 69632
s_add_u32 s45, s48, 1474560
v_mul_f32 v241, s65, v49
v_mul_f32 v242, s64, v50
s_waitcnt lgkmcnt(4)
v_mfma_f32_16x16x32_bf16 v[112:115], v[40:43], a[112:115], v[112:115]
ds_read_b64_tr_b16 v[36:37], v10 offset:8192
v_mul_f32 v243, s65, v51
v_mul_f32 v244, s64, v52
v_mfma_f32_16x16x32_bf16 v[116:119], v[40:43], a[116:119], v[116:119]
ds_read_b64_tr_b16 v[38:39], v10 offset:8448
v_mul_f32 v245, s65, v53
v_mul_f32 v246, s64, v54
v_mfma_f32_16x16x32_bf16 v[120:123], v[40:43], a[120:123], v[120:123]
buffer_load_dwordx4 v2, s[20:23], s45 offen lds
v_mul_f32 v247, s65, v55
v_exp_f32 v240, v240 clamp
v_mfma_f32_16x16x32_bf16 v[124:127], v[40:43], a[124:127], v[124:127]
v_exp_f32 v241, v241 clamp
s_waitcnt lgkmcnt(4)
v_mfma_f32_16x16x32_bf16 v[128:131], v[44:47], a[112:115], v[128:131]
ds_read_b64_tr_b16 v[40:41], v8 offset:12288
v_exp_f32 v242, v242 clamp
v_mfma_f32_16x16x32_bf16 v[132:135], v[44:47], a[116:119], v[132:135]
ds_read_b64_tr_b16 v[42:43], v8 offset:12544
v_exp_f32 v243, v243 clamp
v_mfma_f32_16x16x32_bf16 v[136:139], v[44:47], a[120:123], v[136:139]
v_exp_f32 v244, v244 clamp
v_mfma_f32_16x16x32_bf16 v[140:143], v[44:47], a[124:127], v[140:143]
s_add_u32 m0, s44, 90112
s_add_u32 s45, s48, 1769472
v_exp_f32 v245, v245 clamp
s_waitcnt lgkmcnt(4)
v_mfma_f32_16x16x32_bf16 v[112:115], v[32:35], a[128:131], v[112:115]
ds_read_b64_tr_b16 v[44:45], v10 offset:12288
v_exp_f32 v246, v246 clamp
v_mfma_f32_16x16x32_bf16 v[116:119], v[32:35], a[132:135], v[116:119]
ds_read_b64_tr_b16 v[46:47], v10 offset:12544
v_exp_f32 v247, v247 clamp
v_mfma_f32_16x16x32_bf16 v[120:123], v[32:35], a[136:139], v[120:123]
buffer_load_dwordx4 v2, s[20:23], s45 offen lds
v_max_f32 v48, 0, v48
v_mfma_f32_16x16x32_bf16 v[124:127], v[32:35], a[140:143], v[124:127]
s_add_u32 m0, s44, 94208
s_add_u32 s45, s48, 2064384
v_max_f32 v49, 0, v49
v_max_f32 v50, 0, v50
s_waitcnt lgkmcnt(4)
v_mfma_f32_16x16x32_bf16 v[128:131], v[36:39], a[128:131], v[128:131]
ds_read_b64_tr_b16 v[32:33], v8 offset:16384
v_max_f32 v51, 0, v51
v_max_f32 v52, 0, v52
v_mfma_f32_16x16x32_bf16 v[132:135], v[36:39], a[132:135], v[132:135]
ds_read_b64_tr_b16 v[34:35], v8 offset:16640
v_max_f32 v53, 0, v53
v_max_f32 v54, 0, v54
v_mfma_f32_16x16x32_bf16 v[136:139], v[36:39], a[136:139], v[136:139]
buffer_load_dwordx4 v2, s[20:23], s45 offen lds
v_max_f32 v55, 0, v55
v_add_f32 v48, v240, v48
v_mfma_f32_16x16x32_bf16 v[140:143], v[36:39], a[140:143], v[140:143]
v_add_f32 v49, v241, v49
v_add_f32 v50, v242, v50
v_add_f32 v51, v243, v51
s_waitcnt lgkmcnt(4)
v_mfma_f32_16x16x32_bf16 v[112:115], v[40:43], a[144:147], v[112:115]
ds_read_b64_tr_b16 v[36:37], v10 offset:16384
v_add_f32 v52, v244, v52
v_add_f32 v53, v245, v53
v_mfma_f32_16x16x32_bf16 v[116:119], v[40:43], a[148:151], v[116:119]
ds_read_b64_tr_b16 v[38:39], v10 offset:16640
v_add_f32 v54, v246, v54
v_add_f32 v55, v247, v55
v_mfma_f32_16x16x32_bf16 v[120:123], v[40:43], a[152:155], v[120:123]
v_add_f32 v48, s66, v48
v_add_f32 v49, s67, v49
v_add_f32 v50, s66, v50
v_mfma_f32_16x16x32_bf16 v[124:127], v[40:43], a[156:159], v[124:127]
s_add_u32 m0, s44, 98304
s_add_u32 s45, s48, 2359296
v_add_f32 v51, s67, v51
v_add_f32 v52, s66, v52
s_waitcnt lgkmcnt(4)
v_mfma_f32_16x16x32_bf16 v[128:131], v[44:47], a[144:147], v[128:131]
ds_read_b64_tr_b16 v[40:41], v8 offset:20480
v_add_f32 v53, s67, v53
v_add_f32 v54, s66, v54
v_mfma_f32_16x16x32_bf16 v[132:135], v[44:47], a[148:151], v[132:135]
ds_read_b64_tr_b16 v[42:43], v8 offset:20736
v_add_f32 v55, s67, v55
v_mul_f32 v240, s64, v56
v_mfma_f32_16x16x32_bf16 v[136:139], v[44:47], a[152:155], v[136:139]
buffer_load_dwordx4 v2, s[20:23], s45 offen lds
v_mul_f32 v241, s65, v57
v_mul_f32 v242, s64, v58
v_mfma_f32_16x16x32_bf16 v[140:143], v[44:47], a[156:159], v[140:143]
s_add_u32 m0, s44, 102400
s_add_u32 s45, s48, 2654208
v_mul_f32 v243, s65, v59
v_mul_f32 v244, s64, v60
s_waitcnt lgkmcnt(4)
v_mfma_f32_16x16x32_bf16 v[112:115], v[32:35], a[160:163], v[112:115]
ds_read_b64_tr_b16 v[44:45], v10 offset:20480
v_mul_f32 v245, s65, v61
v_mul_f32 v246, s64, v62
v_mfma_f32_16x16x32_bf16 v[116:119], v[32:35], a[164:167], v[116:119]
ds_read_b64_tr_b16 v[46:47], v10 offset:20736
v_mul_f32 v247, s65, v63
v_exp_f32 v240, v240 clamp
v_mfma_f32_16x16x32_bf16 v[120:123], v[32:35], a[168:171], v[120:123]
buffer_load_dwordx4 v2, s[20:23], s45 offen lds
v_exp_f32 v241, v241 clamp
v_mfma_f32_16x16x32_bf16 v[124:127], v[32:35], a[172:175], v[124:127]
v_exp_f32 v242, v242 clamp
s_waitcnt lgkmcnt(4)
v_mfma_f32_16x16x32_bf16 v[128:131], v[36:39], a[160:163], v[128:131]
s_waitcnt vmcnt(10) lgkmcnt(0)
s_barrier
ds_read_b64_tr_b16 v[32:33], v8 offset:24576
v_exp_f32 v243, v243 clamp
v_mfma_f32_16x16x32_bf16 v[132:135], v[36:39], a[164:167], v[132:135]
ds_read_b64_tr_b16 v[34:35], v8 offset:24832
v_exp_f32 v244, v244 clamp
v_mfma_f32_16x16x32_bf16 v[136:139], v[36:39], a[168:171], v[136:139]
v_exp_f32 v245, v245 clamp
v_mfma_f32_16x16x32_bf16 v[140:143], v[36:39], a[172:175], v[140:143]
s_add_u32 m0, s44, 106496
s_add_u32 s45, s48, 2949120
v_exp_f32 v246, v246 clamp
v_mfma_f32_16x16x32_bf16 v[112:115], v[40:43], a[176:179], v[112:115]
ds_read_b64_tr_b16 v[36:37], v10 offset:24576
v_exp_f32 v247, v247 clamp
v_mfma_f32_16x16x32_bf16 v[116:119], v[40:43], a[180:183], v[116:119]
ds_read_b64_tr_b16 v[38:39], v10 offset:24832
v_max_f32 v56, 0, v56
v_mfma_f32_16x16x32_bf16 v[120:123], v[40:43], a[184:187], v[120:123]
buffer_load_dwordx4 v2, s[20:23], s45 offen lds
v_max_f32 v57, 0, v57
v_max_f32 v58, 0, v58
v_mfma_f32_16x16x32_bf16 v[124:127], v[40:43], a[188:191], v[124:127]
s_add_u32 m0, s44, 110592
s_add_u32 s45, s48, 3244032
v_max_f32 v59, 0, v59
v_max_f32 v60, 0, v60
v_mfma_f32_16x16x32_bf16 v[128:131], v[44:47], a[176:179], v[128:131]
ds_read_b64_tr_b16 v[40:41], v8 offset:28672
v_max_f32 v61, 0, v61
v_max_f32 v62, 0, v62
v_mfma_f32_16x16x32_bf16 v[132:135], v[44:47], a[180:183], v[132:135]
ds_read_b64_tr_b16 v[42:43], v8 offset:28928
v_max_f32 v63, 0, v63
v_add_f32 v56, v240, v56
v_mfma_f32_16x16x32_bf16 v[136:139], v[44:47], a[184:187], v[136:139]
buffer_load_dwordx4 v2, s[20:23], s45 offen lds
v_add_f32 v57, v241, v57
v_add_f32 v58, v242, v58
v_mfma_f32_16x16x32_bf16 v[140:143], v[44:47], a[188:191], v[140:143]
v_add_f32 v59, v243, v59
v_add_f32 v60, v244, v60
v_add_f32 v61, v245, v61
s_waitcnt lgkmcnt(4)
v_mfma_f32_16x16x32_bf16 v[112:115], v[32:35], a[192:195], v[112:115]
ds_read_b64_tr_b16 v[44:45], v10 offset:28672
v_add_f32 v62, v246, v62
v_add_f32 v63, v247, v63
v_mfma_f32_16x16x32_bf16 v[116:119], v[32:35], a[196:199], v[116:119]
ds_read_b64_tr_b16 v[46:47], v10 offset:28928
v_add_f32 v56, s66, v56
v_add_f32 v57, s67, v57
v_mfma_f32_16x16x32_bf16 v[120:123], v[32:35], a[200:203], v[120:123]
v_add_f32 v58, s66, v58
v_add_f32 v59, s67, v59
v_add_f32 v60, s66, v60
v_mfma_f32_16x16x32_bf16 v[124:127], v[32:35], a[204:207], v[124:127]
s_add_u32 m0, s44, 114688
s_add_u32 s45, s48, 3538944
v_add_f32 v61, s67, v61
v_add_f32 v62, s66, v62
s_waitcnt lgkmcnt(4)
v_mfma_f32_16x16x32_bf16 v[128:131], v[36:39], a[192:195], v[128:131]
ds_read_b64_tr_b16 v[32:33], v8 offset:32768
v_add_f32 v63, s67, v63
v_cvt_pk_bf16_f32 v176, v48, v49
v_mfma_f32_16x16x32_bf16 v[132:135], v[36:39], a[196:199], v[132:135]
ds_read_b64_tr_b16 v[34:35], v8 offset:33024
v_cvt_pk_bf16_f32 v177, v50, v51
v_cvt_pk_bf16_f32 v180, v52, v53
v_mfma_f32_16x16x32_bf16 v[136:139], v[36:39], a[200:203], v[136:139]
buffer_load_dwordx4 v2, s[20:23], s45 offen lds
v_cvt_pk_bf16_f32 v181, v54, v55
v_cvt_pk_bf16_f32 v184, v56, v57
v_mfma_f32_16x16x32_bf16 v[140:143], v[36:39], a[204:207], v[140:143]
s_add_u32 m0, s44, 118784
s_add_u32 s45, s48, 3833856
v_cvt_pk_bf16_f32 v185, v58, v59
v_cvt_pk_bf16_f32 v188, v60, v61
s_waitcnt lgkmcnt(4)
v_mfma_f32_16x16x32_bf16 v[112:115], v[40:43], a[208:211], v[112:115]
ds_read_b64_tr_b16 v[36:37], v10 offset:32768
v_cvt_pk_bf16_f32 v189, v62, v63
v_cvt_pk_bf16_f32 v200, v80, v81
v_mfma_f32_16x16x32_bf16 v[116:119], v[40:43], a[212:215], v[116:119]
ds_read_b64_tr_b16 v[38:39], v10 offset:33024
v_cvt_pk_bf16_f32 v201, v82, v83
v_cvt_pk_bf16_f32 v202, v84, v85
v_mfma_f32_16x16x32_bf16 v[120:123], v[40:43], a[216:219], v[120:123]
buffer_load_dwordx4 v2, s[20:23], s45 offen lds
v_cvt_pk_bf16_f32 v203, v86, v87
v_cvt_pk_bf16_f32 v204, v88, v89
v_mfma_f32_16x16x32_bf16 v[124:127], v[40:43], a[220:223], v[124:127]
v_cvt_pk_bf16_f32 v205, v90, v91
v_cvt_pk_bf16_f32 v206, v92, v93
v_cvt_pk_bf16_f32 v207, v94, v95
s_waitcnt lgkmcnt(4)
v_mfma_f32_16x16x32_bf16 v[128:131], v[44:47], a[208:211], v[128:131]
ds_read_b64_tr_b16 v[40:41], v8 offset:36864
v_cvt_pk_bf16_f32 v208, v96, v97
v_cvt_pk_bf16_f32 v209, v98, v99
v_mfma_f32_16x16x32_bf16 v[132:135], v[44:47], a[212:215], v[132:135]
ds_read_b64_tr_b16 v[42:43], v8 offset:37120
v_cvt_pk_bf16_f32 v210, v100, v101
v_cvt_pk_bf16_f32 v211, v102, v103
v_mfma_f32_16x16x32_bf16 v[136:139], v[44:47], a[216:219], v[136:139]
v_cvt_pk_bf16_f32 v212, v104, v105
v_cvt_pk_bf16_f32 v213, v106, v107
v_cvt_pk_bf16_f32 v214, v108, v109
v_mfma_f32_16x16x32_bf16 v[140:143], v[44:47], a[220:223], v[140:143]
s_add_u32 m0, s44, 122880
s_add_u32 s45, s48, 4128768
v_cvt_pk_bf16_f32 v215, v110, v111
v_mov_b32 v224, s62
s_waitcnt lgkmcnt(4)
v_mfma_f32_16x16x32_bf16 v[112:115], v[32:35], a[224:227], v[112:115]
ds_read_b64_tr_b16 v[44:45], v10 offset:36864
v_cndmask_b32 v208, v208, v224, s[60:61]
v_cndmask_b32 v209, v209, v224, s[60:61]
v_mfma_f32_16x16x32_bf16 v[116:119], v[32:35], a[228:231], v[116:119]
ds_read_b64_tr_b16 v[46:47], v10 offset:37120
v_cndmask_b32 v210, v210, v224, s[60:61]
v_cndmask_b32 v211, v211, v224, s[60:61]
v_mfma_f32_16x16x32_bf16 v[120:123], v[32:35], a[232:235], v[120:123]
buffer_load_dwordx4 v2, s[20:23], s45 offen lds
v_cndmask_b32 v212, v212, v224, s[60:61]
v_cndmask_b32 v213, v213, v224, s[60:61]
v_mfma_f32_16x16x32_bf16 v[124:127], v[32:35], a[236:239], v[124:127]
s_add_u32 m0, s44, 126976
s_add_u32 s45, s48, 4423680
v_cndmask_b32 v214, v214, v224, s[60:61]
v_cndmask_b32 v215, v215, v224, s[60:61]
s_waitcnt lgkmcnt(4)
v_mfma_f32_16x16x32_bf16 v[128:131], v[36:39], a[224:227], v[128:131]
ds_read_b64_tr_b16 v[32:33], v8 offset:40960
v_mul_f32 v240, s64, v96
v_mul_f32 v241, s65, v97
v_mfma_f32_16x16x32_bf16 v[132:135], v[36:39], a[228:231], v[132:135]
ds_read_b64_tr_b16 v[34:35], v8 offset:41216
v_mul_f32 v242, s64, v98
v_mul_f32 v243, s65, v99
v_mfma_f32_16x16x32_bf16 v[136:139], v[36:39], a[232:235], v[136:139]
buffer_load_dwordx4 v2, s[20:23], s45 offen lds
v_mul_f32 v244, s64, v100
v_mul_f32 v245, s65, v101
v_mfma_f32_16x16x32_bf16 v[140:143], v[36:39], a[236:239], v[140:143]
v_mul_f32 v246, s64, v102
v_mul_f32 v247, s65, v103
v_exp_f32 v240, v240 clamp
s_waitcnt lgkmcnt(4)
v_mfma_f32_16x16x32_bf16 v[112:115], v[40:43], a[240:243], v[112:115]
ds_read_b64_tr_b16 v[36:37], v10 offset:40960
v_exp_f32 v241, v241 clamp
v_mfma_f32_16x16x32_bf16 v[116:119], v[40:43], a[244:247], v[116:119]
ds_read_b64_tr_b16 v[38:39], v10 offset:41216
v_exp_f32 v242, v242 clamp
v_mfma_f32_16x16x32_bf16 v[120:123], v[40:43], a[248:251], v[120:123]
v_exp_f32 v243, v243 clamp
v_mfma_f32_16x16x32_bf16 v[124:127], v[40:43], a[252:255], v[124:127]
s_add_u32 m0, s44, 131072
s_add_u32 s45, s48, 4718592
v_exp_f32 v244, v244 clamp
s_waitcnt lgkmcnt(4)
v_mfma_f32_16x16x32_bf16 v[128:131], v[44:47], a[240:243], v[128:131]
ds_read_b64_tr_b16 v[40:41], v8 offset:45056
v_exp_f32 v245, v245 clamp
v_mfma_f32_16x16x32_bf16 v[132:135], v[44:47], a[244:247], v[132:135]
ds_read_b64_tr_b16 v[42:43], v8 offset:45312
v_exp_f32 v246, v246 clamp
v_mfma_f32_16x16x32_bf16 v[136:139], v[44:47], a[248:251], v[136:139]
buffer_load_dwordx4 v2, s[20:23], s45 offen lds
v_exp_f32 v247, v247 clamp
v_mfma_f32_16x16x32_bf16 v[140:143], v[44:47], a[252:255], v[140:143]
s_add_u32 m0, s44, 135168
s_add_u32 s45, s48, 5013504
v_max_f32 v96, 0, v96
s_waitcnt lgkmcnt(4)
v_mfma_f32_16x16x32_bf16 v[112:115], v[32:35], v[144:147], v[112:115]
ds_read_b64_tr_b16 v[44:45], v10 offset:45056
v_max_f32 v97, 0, v97
v_mfma_f32_16x16x32_bf16 v[116:119], v[32:35], v[148:151], v[116:119]
ds_read_b64_tr_b16 v[46:47], v10 offset:45312
v_max_f32 v98, 0, v98
v_mfma_f32_16x16x32_bf16 v[120:123], v[32:35], v[152:155], v[120:123]
buffer_load_dwordx4 v2, s[20:23], s45 offen lds
v_max_f32 v99, 0, v99
v_mfma_f32_16x16x32_bf16 v[124:127], v[32:35], v[156:159], v[124:127]
v_max_f32 v100, 0, v100
v_max_f32 v101, 0, v101
s_waitcnt lgkmcnt(4)
v_mfma_f32_16x16x32_bf16 v[128:131], v[36:39], v[144:147], v[128:131]
s_waitcnt vmcnt(12) lgkmcnt(0)
s_barrier
ds_read_b64_tr_b16 v[32:33], v7 offset:0
v_max_f32 v102, 0, v102
v_mfma_f32_16x16x32_bf16 v[132:135], v[36:39], v[148:151], v[132:135]
ds_read_b64_tr_b16 v[34:35], v7 offset:256
v_max_f32 v103, 0, v103
v_mfma_f32_16x16x32_bf16 v[136:139], v[36:39], v[152:155], v[136:139]
v_add_f32 v96, v240, v96
v_add_f32 v97, v241, v97
v_mfma_f32_16x16x32_bf16 v[140:143], v[36:39], v[156:159], v[140:143]
s_add_u32 m0, s44, 139264
s_add_u32 s45, s48, 128
v_add_f32 v98, v242, v98
v_mfma_f32_16x16x32_bf16 v[112:115], v[40:43], v[160:163], v[112:115]
ds_read_b64_tr_b16 v[36:37], v9 offset:0
v_add_f32 v99, v243, v99
v_mfma_f32_16x16x32_bf16 v[116:119], v[40:43], v[164:167], v[116:119]
ds_read_b64_tr_b16 v[38:39], v9 offset:256
v_add_f32 v100, v244, v100
v_mfma_f32_16x16x32_bf16 v[120:123], v[40:43], v[168:171], v[120:123]
buffer_load_dwordx4 v2, s[16:19], s45 offen lds
v_add_f32 v101, v245, v101
v_mfma_f32_16x16x32_bf16 v[124:127], v[40:43], v[172:175], v[124:127]
s_add_u32 m0, s44, 143360
s_add_u32 s45, s48, 295040
v_add_f32 v102, v246, v102
v_mfma_f32_16x16x32_bf16 v[128:131], v[44:47], v[160:163], v[128:131]
ds_read_b64_tr_b16 v[40:41], v7 offset:4096
v_add_f32 v103, v247, v103
v_add_f32 v96, s66, v96
v_mfma_f32_16x16x32_bf16 v[132:135], v[44:47], v[164:167], v[132:135]
ds_read_b64_tr_b16 v[42:43], v7 offset:4352
v_add_f32 v97, s67, v97
v_add_f32 v98, s66, v98
v_mfma_f32_16x16x32_bf16 v[136:139], v[44:47], v[168:171], v[136:139]
buffer_load_dwordx4 v2, s[16:19], s45 offen lds
v_add_f32 v99, s67, v99
v_add_f32 v100, s66, v100
v_mfma_f32_16x16x32_bf16 v[140:143], v[44:47], v[172:175], v[140:143]
v_add_f32 v101, s67, v101
v_add_f32 v102, s66, v102
v_add_f32 v103, s67, v103
s_waitcnt lgkmcnt(4)
v_mfma_f32_16x16x32_bf16 v[48:51], v[32:35], a[0:3], 0
ds_read_b64_tr_b16 v[44:45], v9 offset:4096
v_mul_f32 v240, s64, v104
v_mfma_f32_16x16x32_bf16 v[52:55], v[32:35], a[4:7], 0
ds_read_b64_tr_b16 v[46:47], v9 offset:4352
v_mul_f32 v241, s65, v105
v_mfma_f32_16x16x32_bf16 v[56:59], v[32:35], a[8:11], 0
v_mul_f32 v242, s64, v106
v_mul_f32 v243, s65, v107
v_mfma_f32_16x16x32_bf16 v[60:63], v[32:35], a[12:15], 0
s_add_u32 m0, s44, 147456
s_add_u32 s45, s48, 589952
v_mul_f32 v244, s64, v108
s_waitcnt lgkmcnt(4)
v_mfma_f32_16x16x32_bf16 v[64:67], v[36:39], a[0:3], 0
ds_read_b64_tr_b16 v[32:33], v7 offset:8192
v_mul_f32 v245, s65, v109
v_mfma_f32_16x16x32_bf16 v[68:71], v[36:39], a[4:7], 0
ds_read_b64_tr_b16 v[34:35], v7 offset:8448
v_mul_f32 v246, s64, v110
v_mfma_f32_16x16x32_bf16 v[72:75], v[36:39], a[8:11], 0
buffer_load_dwordx4 v2, s[16:19], s45 offen lds
v_mul_f32 v247, s65, v111
v_mfma_f32_16x16x32_bf16 v[76:79], v[36:39], a[12:15], 0
s_add_u32 m0, s44, 151552
s_add_u32 s45, s48, 884864
v_exp_f32 v240, v240 clamp
s_waitcnt lgkmcnt(4)
v_mfma_f32_16x16x32_bf16 v[48:51], v[40:43], a[16:19], v[48:51]
ds_read_b64_tr_b16 v[36:37], v9 offset:8192
v_mfma_f32_16x16x32_bf16 v[52:55], v[40:43], a[20:23], v[52:55]
ds_read_b64_tr_b16 v[38:39], v9 offset:8448
v_exp_f32 v241, v241 clamp
v_mfma_f32_16x16x32_bf16 v[56:59], v[40:43], a[24:27], v[56:59]
buffer_load_dwordx4 v2, s[16:19], s45 offen lds
v_mfma_f32_16x16x32_bf16 v[60:63], v[40:43], a[28:31], v[60:63]
v_exp_f32 v242, v242 clamp
s_waitcnt lgkmcnt(4)
v_mfma_f32_16x16x32_bf16 v[64:67], v[44:47], a[16:19], v[64:67]
ds_read_b64_tr_b16 v[40:41], v7 offset:12288
v_mfma_f32_16x16x32_bf16 v[68:71], v[44:47], a[20:23], v[68:71]
ds_read_b64_tr_b16 v[42:43], v7 offset:12544
v_exp_f32 v243, v243 clamp
v_mfma_f32_16x16x32_bf16 v[72:75], v[44:47], a[24:27], v[72:75]
v_exp_f32 v244, v244 clamp
v_mfma_f32_16x16x32_bf16 v[76:79], v[44:47], a[28:31], v[76:79]
s_add_u32 m0, s44, 155648
s_add_u32 s45, s48, 1179776
s_waitcnt lgkmcnt(4)
v_mfma_f32_16x16x32_bf16 v[48:51], v[32:35], a[32:35], v[48:51]
ds_read_b64_tr_b16 v[44:45], v9 offset:12288
v_exp_f32 v245, v245 clamp
v_mfma_f32_16x16x32_bf16 v[52:55], v[32:35], a[36:39], v[52:55]
ds_read_b64_tr_b16 v[46:47], v9 offset:12544
v_mfma_f32_16x16x32_bf16 v[56:59], v[32:35], a[40:43], v[56:59]
buffer_load_dwordx4 v2, s[16:19], s45 offen lds
v_exp_f32 v246, v246 clamp
v_mfma_f32_16x16x32_bf16 v[60:63], v[32:35], a[44:47], v[60:63]
s_add_u32 m0, s44, 159744
s_add_u32 s45, s48, 1474688
s_waitcnt lgkmcnt(4)
v_mfma_f32_16x16x32_bf16 v[64:67], v[36:39], a[32:35], v[64:67]
ds_read_b64_tr_b16 v[32:33], v7 offset:16384
v_exp_f32 v247, v247 clamp
v_mfma_f32_16x16x32_bf16 v[68:71], v[36:39], a[36:39], v[68:71]
ds_read_b64_tr_b16 v[34:35], v7 offset:16640
v_mfma_f32_16x16x32_bf16 v[72:75], v[36:39], a[40:43], v[72:75]
buffer_load_dwordx4 v2, s[16:19], s45 offen lds
v_max_f32 v104, 0, v104
v_mfma_f32_16x16x32_bf16 v[76:79], v[36:39], a[44:47], v[76:79]
v_max_f32 v105, 0, v105
v_max_f32 v106, 0, v106
s_waitcnt lgkmcnt(4)
v_mfma_f32_16x16x32_bf16 v[48:51], v[40:43], a[48:51], v[48:51]
ds_read_b64_tr_b16 v[36:37], v9 offset:16384
v_max_f32 v107, 0, v107
v_mfma_f32_16x16x32_bf16 v[52:55], v[40:43], a[52:55], v[52:55]
ds_read_b64_tr_b16 v[38:39], v9 offset:16640
v_max_f32 v108, 0, v108
v_mfma_f32_16x16x32_bf16 v[56:59], v[40:43], a[56:59], v[56:59]
v_max_f32 v109, 0, v109
v_max_f32 v110, 0, v110
v_mfma_f32_16x16x32_bf16 v[60:63], v[40:43], a[60:63], v[60:63]
v_max_f32 v111, 0, v111
v_add_f32 v104, v240, v104
s_waitcnt lgkmcnt(4)
v_mfma_f32_16x16x32_bf16 v[64:67], v[44:47], a[48:51], v[64:67]
ds_read_b64_tr_b16 v[40:41], v7 offset:20480
v_add_f32 v105, v241, v105
v_mfma_f32_16x16x32_bf16 v[68:71], v[44:47], a[52:55], v[68:71]
ds_read_b64_tr_b16 v[42:43], v7 offset:20736
v_add_f32 v106, v242, v106
v_mfma_f32_16x16x32_bf16 v[72:75], v[44:47], a[56:59], v[72:75]
v_add_f32 v107, v243, v107
v_add_f32 v108, v244, v108
v_mfma_f32_16x16x32_bf16 v[76:79], v[44:47], a[60:63], v[76:79]
v_add_f32 v109, v245, v109
v_add_f32 v110, v246, v110
s_waitcnt lgkmcnt(4)
v_mfma_f32_16x16x32_bf16 v[48:51], v[32:35], a[64:67], v[48:51]
ds_read_b64_tr_b16 v[44:45], v9 offset:20480
v_add_f32 v111, v247, v111
v_mfma_f32_16x16x32_bf16 v[52:55], v[32:35], a[68:71], v[52:55]
ds_read_b64_tr_b16 v[46:47], v9 offset:20736
v_add_f32 v104, s66, v104
v_mfma_f32_16x16x32_bf16 v[56:59], v[32:35], a[72:75], v[56:59]
v_add_f32 v105, s67, v105
v_add_f32 v106, s66, v106
v_mfma_f32_16x16x32_bf16 v[60:63], v[32:35], a[76:79], v[60:63]
v_add_f32 v107, s67, v107
v_add_f32 v108, s66, v108
s_waitcnt lgkmcnt(4)
v_mfma_f32_16x16x32_bf16 v[64:67], v[36:39], a[64:67], v[64:67]
s_waitcnt vmcnt(12) lgkmcnt(0)
s_barrier
ds_read_b64_tr_b16 v[32:33], v7 offset:40960
v_add_f32 v109, s67, v109
v_mfma_f32_16x16x32_bf16 v[68:71], v[36:39], a[68:71], v[68:71]
ds_read_b64_tr_b16 v[34:35], v7 offset:41216
v_add_f32 v110, s66, v110
v_mfma_f32_16x16x32_bf16 v[72:75], v[36:39], a[72:75], v[72:75]
v_add_f32 v111, s67, v111
v_cvt_pk_bf16_f32 v216, v96, v97
v_mfma_f32_16x16x32_bf16 v[76:79], v[36:39], a[76:79], v[76:79]
s_add_u32 m0, s44, 49152
s_add_u32 s45, s48, 1769600
v_cvt_pk_bf16_f32 v217, v98, v99
v_mfma_f32_16x16x32_bf16 v[48:51], v[40:43], a[80:83], v[48:51]
ds_read_b64_tr_b16 v[36:37], v9 offset:40960
v_cvt_pk_bf16_f32 v218, v100, v101
v_mfma_f32_16x16x32_bf16 v[52:55], v[40:43], a[84:87], v[52:55]
ds_read_b64_tr_b16 v[38:39], v9 offset:41216
v_cvt_pk_bf16_f32 v219, v102, v103
v_mfma_f32_16x16x32_bf16 v[56:59], v[40:43], a[88:91], v[56:59]
buffer_load_dwordx4 v2, s[16:19], s45 offen lds
v_cvt_pk_bf16_f32 v220, v104, v105
v_mfma_f32_16x16x32_bf16 v[60:63], v[40:43], a[92:95], v[60:63]
s_add_u32 m0, s44, 53248
s_add_u32 s45, s48, 2064512
v_cvt_pk_bf16_f32 v221, v106, v107
v_mfma_f32_16x16x32_bf16 v[64:67], v[44:47], a[80:83], v[64:67]
ds_read_b64_tr_b16 v[40:41], v7 offset:45056
v_cvt_pk_bf16_f32 v222, v108, v109
v_mfma_f32_16x16x32_bf16 v[68:71], v[44:47], a[84:87], v[68:71]
ds_read_b64_tr_b16 v[42:43], v7 offset:45312
v_cvt_pk_bf16_f32 v223, v110, v111
v_mfma_f32_16x16x32_bf16 v[72:75], v[44:47], a[88:91], v[72:75]
buffer_load_dwordx4 v2, s[16:19], s45 offen lds
v_mfma_f32_16x16x32_bf16 v[224:227], v[192:195], v[200:203], 0
v_mfma_f32_16x16x32_bf16 v[76:79], v[44:47], a[92:95], v[76:79]
v_mfma_f32_16x16x32_bf16 v[228:231], v[192:195], v[208:211], 0
v_mfma_f32_16x16x32_bf16 v[232:235], v[216:219], v[200:203], 0
s_waitcnt lgkmcnt(4)
v_mfma_f32_16x16x32_bf16 v[48:51], v[32:35], a[96:99], v[48:51]
ds_read_b64_tr_b16 v[44:45], v9 offset:45056
v_mfma_f32_16x16x32_bf16 v[236:239], v[216:219], v[208:211], 0
v_mfma_f32_16x16x32_bf16 v[52:55], v[32:35], a[100:103], v[52:55]
ds_read_b64_tr_b16 v[46:47], v9 offset:45312
v_mfma_f32_16x16x32_bf16 v[224:227], v[196:199], v[204:207], v[224:227]
v_mfma_f32_16x16x32_bf16 v[56:59], v[32:35], a[104:107], v[56:59]
v_mfma_f32_16x16x32_bf16 v[228:231], v[196:199], v[212:215], v[228:231]
v_mfma_f32_16x16x32_bf16 v[232:235], v[220:223], v[204:207], v[232:235]
v_mfma_f32_16x16x32_bf16 v[60:63], v[32:35], a[108:111], v[60:63]
s_add_u32 m0, s44, 57344
s_add_u32 s45, s48, 2359424
v_mfma_f32_16x16x32_bf16 v[236:239], v[220:223], v[212:215], v[236:239]
s_waitcnt lgkmcnt(4)
v_mfma_f32_16x16x32_bf16 v[64:67], v[36:39], a[96:99], v[64:67]
ds_read_b64_tr_b16 v[32:33], v7 offset:49152
v_mfma_f32_16x16x32_bf16 v[80:83], v[216:219], v[28:31], 0
v_mfma_f32_16x16x32_bf16 v[68:71], v[36:39], a[100:103], v[68:71]
ds_read_b64_tr_b16 v[34:35], v7 offset:49408
v_mfma_f32_16x16x32_bf16 v[84:87], v[216:219], v[26:29], 0
v_mfma_f32_16x16x32_bf16 v[72:75], v[36:39], a[104:107], v[72:75]
buffer_load_dwordx4 v2, s[16:19], s45 offen lds
v_mfma_f32_16x16x32_bf16 v[88:91], v[220:223], v[28:31], 0
v_mfma_f32_16x16x32_bf16 v[76:79], v[36:39], a[108:111], v[76:79]
s_add_u32 m0, s44, 61440
s_add_u32 s45, s48, 2654336
v_mfma_f32_16x16x32_bf16 v[92:95], v[220:223], v[26:29], 0
s_waitcnt lgkmcnt(4)
v_mfma_f32_16x16x32_bf16 v[48:51], v[40:43], a[112:115], v[48:51]
ds_read_b64_tr_b16 v[36:37], v9 offset:49152
v_add_u32 v17, 73728, v21
v_mfma_f32_16x16x32_bf16 v[52:55], v[40:43], a[116:119], v[52:55]
ds_read_b64_tr_b16 v[38:39], v9 offset:49408
v_lshrrev_b32 v19, 4, v0
v_mfma_f32_16x16x32_bf16 v[56:59], v[40:43], a[120:123], v[56:59]
buffer_load_dwordx4 v2, s[16:19], s45 offen lds
v_lshlrev_b32 v19, 7, v19
v_mfma_f32_16x16x32_bf16 v[60:63], v[40:43], a[124:127], v[60:63]
v_sub_u32 v18, v17, v19
s_lshl_b32 s46, s3, 10
s_waitcnt lgkmcnt(4)
v_mfma_f32_16x16x32_bf16 v[64:67], v[44:47], a[112:115], v[64:67]
ds_read_b64_tr_b16 v[40:41], v7 offset:53248
v_add_u32 v19, s46, v23
v_mfma_f32_16x16x32_bf16 v[68:71], v[44:47], a[116:119], v[68:71]
ds_read_b64_tr_b16 v[42:43], v7 offset:53504
v_add_u32 v13, 65536, v21
v_mfma_f32_16x16x32_bf16 v[72:75], v[44:47], a[120:123], v[72:75]
v_add_u32 v14, 65536, v22
s_lshl_b32 s46, s7, 3
v_mfma_f32_16x16x32_bf16 v[76:79], v[44:47], a[124:127], v[76:79]
s_add_u32 m0, s44, 65536
s_add_u32 s45, s48, 2949248
v_add_u32 v15, s46, v13
s_waitcnt lgkmcnt(4)
v_mfma_f32_16x16x32_bf16 v[48:51], v[32:35], a[128:131], v[48:51]
ds_read_b64_tr_b16 v[44:45], v9 offset:53248
v_add_u32 v16, s46, v14
v_mfma_f32_16x16x32_bf16 v[52:55], v[32:35], a[132:135], v[52:55]
ds_read_b64_tr_b16 v[46:47], v9 offset:53504
ds_write_b128 v17, v[224:227]
v_mfma_f32_16x16x32_bf16 v[56:59], v[32:35], a[136:139], v[56:59]
buffer_load_dwordx4 v2, s[16:19], s45 offen lds
s_mov_b32 exec_lo, 0xff00ff00
s_mov_b32 exec_hi, 0xff00ff00
ds_write_b128 v18, v[228:231] offset:896
s_mov_b32 exec_lo, 0xffff0000
s_mov_b32 exec_hi, 0
ds_write_b128 v17, v[232:235] offset:1280
ds_write_b128 v17, v[236:239] offset:1536
s_mov_b64 exec, -1
v_mfma_f32_16x16x32_bf16 v[60:63], v[32:35], a[140:143], v[60:63]
s_add_u32 m0, s44, 69632
s_add_u32 s45, s48, 3244160
v_cvt_pk_bf16_f32 v178, v80, v81
s_waitcnt lgkmcnt(8)
v_mfma_f32_16x16x32_bf16 v[64:67], v[36:39], a[128:131], v[64:67]
ds_read_b64_tr_b16 v[32:33], v7 offset:57344
v_cvt_pk_bf16_f32 v179, v82, v83
v_mfma_f32_16x16x32_bf16 v[68:71], v[36:39], a[132:135], v[68:71]
ds_read_b64_tr_b16 v[34:35], v7 offset:57600
v_cvt_pk_bf16_f32 v182, v84, v85
v_mfma_f32_16x16x32_bf16 v[72:75], v[36:39], a[136:139], v[72:75]
buffer_load_dwordx4 v2, s[16:19], s45 offen lds
v_cvt_pk_bf16_f32 v183, v86, v87
v_mfma_f32_16x16x32_bf16 v[76:79], v[36:39], a[140:143], v[76:79]
v_cvt_pk_bf16_f32 v186, v88, v89
v_cvt_pk_bf16_f32 v187, v90, v91
s_waitcnt lgkmcnt(8)
v_mfma_f32_16x16x32_bf16 v[48:51], v[40:43], a[144:147], v[48:51]
ds_read_b64_tr_b16 v[36:37], v9 offset:57344
v_cvt_pk_bf16_f32 v190, v92, v93
v_mfma_f32_16x16x32_bf16 v[52:55], v[40:43], a[148:151], v[52:55]
ds_read_b64_tr_b16 v[38:39], v9 offset:57600
v_cvt_pk_bf16_f32 v191, v94, v95
v_mfma_f32_16x16x32_bf16 v[56:59], v[40:43], a[152:155], v[56:59]
s_add_u32 s88, s100, 4096
buffer_store_dwordx4 v[252:255], v23, s[36:39], s88 offen sc1
s_add_u32 s88, s100, 8192
buffer_store_dwordx4 v[252:255], v23, s[36:39], s88 offen sc1
v_mfma_f32_16x16x32_bf16 v[60:63], v[40:43], a[156:159], v[60:63]
s_add_u32 s88, s100, 12288
buffer_store_dwordx4 v[252:255], v23, s[36:39], s88 offen sc1
s_add_u32 s88, s100, 16384
buffer_store_dwordx4 v[252:255], v23, s[36:39], s88 offen sc1
s_waitcnt lgkmcnt(8)
v_mfma_f32_16x16x32_bf16 v[64:67], v[44:47], a[144:147], v[64:67]
ds_read_b64_tr_b16 v[40:41], v7 offset:61440
s_add_u32 s88, s100, 20480
buffer_store_dwordx4 v[252:255], v23, s[36:39], s88 offen sc1
v_mfma_f32_16x16x32_bf16 v[68:71], v[44:47], a[148:151], v[68:71]
ds_read_b64_tr_b16 v[42:43], v7 offset:61696
s_add_u32 s88, s100, 24576
buffer_store_dwordx4 v[252:255], v23, s[36:39], s88 offen sc1
v_mfma_f32_16x16x32_bf16 v[72:75], v[44:47], a[152:155], v[72:75]
s_add_u32 s88, s100, 28672
buffer_store_dwordx4 v[252:255], v23, s[36:39], s88 offen sc1
v_mfma_f32_16x16x32_bf16 v[76:79], v[44:47], a[156:159], v[76:79]
s_waitcnt lgkmcnt(4)
v_mfma_f32_16x16x32_bf16 v[48:51], v[32:35], a[160:163], v[48:51]
ds_read_b64_tr_b16 v[44:45], v9 offset:61440
s_add_u32 s88, s100, 32768
buffer_store_dwordx4 v[252:255], v23, s[36:39], s88 offen sc1
v_mfma_f32_16x16x32_bf16 v[52:55], v[32:35], a[164:167], v[52:55]
ds_read_b64_tr_b16 v[46:47], v9 offset:61696
v_mfma_f32_16x16x32_bf16 v[56:59], v[32:35], a[168:171], v[56:59]
v_mfma_f32_16x16x32_bf16 v[60:63], v[32:35], a[172:175], v[60:63]
s_waitcnt lgkmcnt(4)
v_mfma_f32_16x16x32_bf16 v[64:67], v[36:39], a[160:163], v[64:67]
s_waitcnt vmcnt(20) lgkmcnt(0)
s_barrier
ds_read_b64_tr_b16 v[32:33], v8 offset:0
v_mfma_f32_16x16x32_bf16 v[68:71], v[36:39], a[164:167], v[68:71]
ds_read_b64_tr_b16 v[34:35], v8 offset:256
v_mfma_f32_16x16x32_bf16 v[72:75], v[36:39], a[168:171], v[72:75]
v_mfma_f32_16x16x32_bf16 v[76:79], v[36:39], a[172:175], v[76:79]
s_add_u32 m0, s44, 90112
s_add_u32 s45, s48, 3539072
v_mfma_f32_16x16x32_bf16 v[48:51], v[40:43], a[176:179], v[48:51]
ds_read_b64_tr_b16 v[36:37], v10 offset:0
v_add_u32 v20, 73728, v19
v_mfma_f32_16x16x32_bf16 v[52:55], v[40:43], a[180:183], v[52:55]
ds_read_b64_tr_b16 v[38:39], v10 offset:256
ds_read_b128 v[192:195], v20
v_mfma_f32_16x16x32_bf16 v[56:59], v[40:43], a[184:187], v[56:59]
buffer_load_dwordx4 v2, s[16:19], s45 offen lds
ds_read_b128 v[196:199], v20 offset:4096
v_mfma_f32_16x16x32_bf16 v[60:63], v[40:43], a[188:191], v[60:63]
s_add_u32 m0, s44, 94208
s_add_u32 s45, s48, 3833984
v_mfma_f32_16x16x32_bf16 v[64:67], v[44:47], a[176:179], v[64:67]
ds_read_b64_tr_b16 v[40:41], v8 offset:4096
v_mfma_f32_16x16x32_bf16 v[68:71], v[44:47], a[180:183], v[68:71]
ds_read_b64_tr_b16 v[42:43], v8 offset:4352
v_mfma_f32_16x16x32_bf16 v[72:75], v[44:47], a[184:187], v[72:75]
buffer_load_dwordx4 v2, s[16:19], s45 offen lds
s_waitcnt lgkmcnt(2)
v_add_f32 v192, v196, v192
v_mfma_f32_16x16x32_bf16 v[76:79], v[44:47], a[188:191], v[76:79]
v_add_f32 v193, v197, v193
v_add_f32 v194, v198, v194
v_mfma_f32_16x16x32_bf16 v[48:51], v[32:35], a[192:195], v[48:51]
ds_read_b64_tr_b16 v[44:45], v10 offset:4096
v_add_f32 v195, v199, v195
v_mfma_f32_16x16x32_bf16 v[52:55], v[32:35], a[196:199], v[52:55]
ds_read_b64_tr_b16 v[46:47], v10 offset:4352
buffer_store_dwordx4 v[192:195], v19, s[36:39], s54 offen sc1
v_mfma_f32_16x16x32_bf16 v[56:59], v[32:35], a[200:203], v[56:59]
v_lshrrev_b32 v26, 4, v0
v_and_b32 v27, 15, v0
v_mfma_f32_16x16x32_bf16 v[60:63], v[32:35], a[204:207], v[60:63]
s_add_u32 m0, s44, 98304
s_add_u32 s45, s48, 4128896
v_lshlrev_b32 v26, 12, v26
v_mfma_f32_16x16x32_bf16 v[64:67], v[36:39], a[192:195], v[64:67]
ds_read_b64_tr_b16 v[32:33], v8 offset:8192
v_lshl_add_u32 v26, v27, 2, v26
v_mfma_f32_16x16x32_bf16 v[68:71], v[36:39], a[196:199], v[68:71]
ds_read_b64_tr_b16 v[34:35], v8 offset:8448
s_lshl_b32 s70, s4, 12
s_add_u32 s70, s70, 52428800
s_lshl_b32 s101, s5, 2
s_add_u32 s101, s101, s3
s_lshl_b32 s101, s101, 6
s_add_u32 s55, s55, s101
s_add_u32 s101, s101, s70
v_mfma_f32_16x16x32_bf16 v[72:75], v[36:39], a[200:203], v[72:75]
buffer_load_dwordx4 v2, s[16:19], s45 offen lds
s_mov_b64 exec, 0xffff
buffer_store_dword v252, v26, s[36:39], s101 offen sc1
s_mov_b64 exec, -1
v_mfma_f32_16x16x32_bf16 v[76:79], v[36:39], a[204:207], v[76:79]
s_add_u32 m0, s44, 102400
s_add_u32 s45, s48, 4423808
s_waitcnt lgkmcnt(4)
v_mfma_f32_16x16x32_bf16 v[48:51], v[40:43], a[208:211], v[48:51]
ds_read_b64_tr_b16 v[36:37], v10 offset:8192
v_mfma_f32_16x16x32_bf16 v[52:55], v[40:43], a[212:215], v[52:55]
ds_read_b64_tr_b16 v[38:39], v10 offset:8448
v_mfma_f32_16x16x32_bf16 v[56:59], v[40:43], a[216:219], v[56:59]
buffer_load_dwordx4 v2, s[16:19], s45 offen lds
v_mfma_f32_16x16x32_bf16 v[60:63], v[40:43], a[220:223], v[60:63]
s_waitcnt lgkmcnt(4)
v_mfma_f32_16x16x32_bf16 v[64:67], v[44:47], a[208:211], v[64:67]
ds_read_b64_tr_b16 v[40:41], v8 offset:12288
s_add_u32 s88, s100, 36864
buffer_store_dwordx4 v[252:255], v23, s[36:39], s88 offen sc1
v_mfma_f32_16x16x32_bf16 v[68:71], v[44:47], a[212:215], v[68:71]
ds_read_b64_tr_b16 v[42:43], v8 offset:12544
v_mfma_f32_16x16x32_bf16 v[72:75], v[44:47], a[216:219], v[72:75]
v_mfma_f32_16x16x32_bf16 v[76:79], v[44:47], a[220:223], v[76:79]
s_add_u32 m0, s44, 106496
s_add_u32 s45, s48, 4718720
s_waitcnt lgkmcnt(4)
v_mfma_f32_16x16x32_bf16 v[48:51], v[32:35], a[224:227], v[48:51]
ds_read_b64_tr_b16 v[44:45], v10 offset:12288
v_mfma_f32_16x16x32_bf16 v[52:55], v[32:35], a[228:231], v[52:55]
ds_read_b64_tr_b16 v[46:47], v10 offset:12544
v_mfma_f32_16x16x32_bf16 v[56:59], v[32:35], a[232:235], v[56:59]
buffer_load_dwordx4 v2, s[16:19], s45 offen lds
v_mfma_f32_16x16x32_bf16 v[60:63], v[32:35], a[236:239], v[60:63]
s_add_u32 m0, s44, 110592
s_add_u32 s45, s48, 5013632
s_waitcnt lgkmcnt(4)
v_mfma_f32_16x16x32_bf16 v[64:67], v[36:39], a[224:227], v[64:67]
ds_read_b64_tr_b16 v[32:33], v8 offset:16384
v_mfma_f32_16x16x32_bf16 v[68:71], v[36:39], a[228:231], v[68:71]
ds_read_b64_tr_b16 v[34:35], v8 offset:16640
v_mfma_f32_16x16x32_bf16 v[72:75], v[36:39], a[232:235], v[72:75]
buffer_load_dwordx4 v2, s[16:19], s45 offen lds
v_mfma_f32_16x16x32_bf16 v[76:79], v[36:39], a[236:239], v[76:79]
s_waitcnt lgkmcnt(4)
v_mfma_f32_16x16x32_bf16 v[48:51], v[40:43], a[240:243], v[48:51]
ds_read_b64_tr_b16 v[36:37], v10 offset:16384
v_mfma_f32_16x16x32_bf16 v[52:55], v[40:43], a[244:247], v[52:55]
ds_read_b64_tr_b16 v[38:39], v10 offset:16640
v_mfma_f32_16x16x32_bf16 v[56:59], v[40:43], a[248:251], v[56:59]
v_mfma_f32_16x16x32_bf16 v[60:63], v[40:43], a[252:255], v[60:63]
s_waitcnt lgkmcnt(4)
v_mfma_f32_16x16x32_bf16 v[64:67], v[44:47], a[240:243], v[64:67]
ds_read_b64_tr_b16 v[40:41], v8 offset:20480
v_mfma_f32_16x16x32_bf16 v[68:71], v[44:47], a[244:247], v[68:71]
ds_read_b64_tr_b16 v[42:43], v8 offset:20736
v_mfma_f32_16x16x32_bf16 v[72:75], v[44:47], a[248:251], v[72:75]
v_mfma_f32_16x16x32_bf16 v[76:79], v[44:47], a[252:255], v[76:79]
s_waitcnt lgkmcnt(4)
v_mfma_f32_16x16x32_bf16 v[48:51], v[32:35], v[144:147], v[48:51]
ds_read_b64_tr_b16 v[44:45], v10 offset:20480
v_mfma_f32_16x16x32_bf16 v[52:55], v[32:35], v[148:151], v[52:55]
ds_read_b64_tr_b16 v[46:47], v10 offset:20736
v_mfma_f32_16x16x32_bf16 v[56:59], v[32:35], v[152:155], v[56:59]
v_mfma_f32_16x16x32_bf16 v[60:63], v[32:35], v[156:159], v[60:63]
s_waitcnt lgkmcnt(4)
v_mfma_f32_16x16x32_bf16 v[64:67], v[36:39], v[144:147], v[64:67]
s_waitcnt vmcnt(23) lgkmcnt(0)
s_barrier
ds_read_b64_tr_b16 v[32:33], v8 offset:24576
v_mfma_f32_16x16x32_bf16 v[68:71], v[36:39], v[148:151], v[68:71]
ds_read_b64_tr_b16 v[34:35], v8 offset:24832
v_mfma_f32_16x16x32_bf16 v[72:75], v[36:39], v[152:155], v[72:75]
v_mfma_f32_16x16x32_bf16 v[76:79], v[36:39], v[156:159], v[76:79]
s_add_u32 m0, s44, 114688
s_add_u32 s45, s48, 128
v_mfma_f32_16x16x32_bf16 v[48:51], v[40:43], v[160:163], v[48:51]
ds_read_b64_tr_b16 v[36:37], v10 offset:24576
s_add_u32 s88, s100, 40960
buffer_store_dwordx4 v[252:255], v23, s[36:39], s88 offen sc1
v_mfma_f32_16x16x32_bf16 v[52:55], v[40:43], v[164:167], v[52:55]
ds_read_b64_tr_b16 v[38:39], v10 offset:24832
v_mfma_f32_16x16x32_bf16 v[56:59], v[40:43], v[168:171], v[56:59]
buffer_load_dwordx4 v2, s[20:23], s45 offen lds
v_mfma_f32_16x16x32_bf16 v[60:63], v[40:43], v[172:175], v[60:63]
s_add_u32 m0, s44, 118784
s_add_u32 s45, s48, 295040
v_mfma_f32_16x16x32_bf16 v[64:67], v[44:47], v[160:163], v[64:67]
ds_read_b64_tr_b16 v[40:41], v8 offset:28672
v_mfma_f32_16x16x32_bf16 v[68:71], v[44:47], v[164:167], v[68:71]
ds_read_b64_tr_b16 v[42:43], v8 offset:28928
v_mfma_f32_16x16x32_bf16 v[72:75], v[44:47], v[168:171], v[72:75]
buffer_load_dwordx4 v2, s[20:23], s45 offen lds
v_mfma_f32_16x16x32_bf16 v[76:79], v[44:47], v[172:175], v[76:79]
s_waitcnt lgkmcnt(4)
v_mfma_f32_16x16x32_bf16 v[80:83], v[32:35], a[0:3], 0
ds_read_b64_tr_b16 v[44:45], v10 offset:28672
v_mfma_f32_16x16x32_bf16 v[84:87], v[32:35], a[4:7], 0
ds_read_b64_tr_b16 v[46:47], v10 offset:28928
v_mfma_f32_16x16x32_bf16 v[88:91], v[32:35], a[8:11], 0
v_mfma_f32_16x16x32_bf16 v[92:95], v[32:35], a[12:15], 0
s_add_u32 m0, s44, 122880
s_add_u32 s45, s48, 589952
s_waitcnt lgkmcnt(4)
v_mfma_f32_16x16x32_bf16 v[96:99], v[36:39], a[0:3], 0
ds_read_b64_tr_b16 v[32:33], v8 offset:32768
s_lshl_b32 s46, s7, 13
v_mfma_f32_16x16x32_bf16 v[100:103], v[36:39], a[4:7], 0
ds_read_b64_tr_b16 v[34:35], v8 offset:33024
v_add_u32 v30, s46, v21
v_mfma_f32_16x16x32_bf16 v[104:107], v[36:39], a[8:11], 0
buffer_load_dwordx4 v2, s[20:23], s45 offen lds
v_add_u32 v31, s46, v22
v_mfma_f32_16x16x32_bf16 v[108:111], v[36:39], a[12:15], 0
s_add_u32 m0, s44, 126976
s_add_u32 s45, s48, 884864
v_max_f32 v112, 0, v112
s_waitcnt lgkmcnt(4)
v_mfma_f32_16x16x32_bf16 v[80:83], v[40:43], a[16:19], v[80:83]
ds_read_b64_tr_b16 v[36:37], v10 offset:32768
v_max_f32 v113, 0, v113
v_mfma_f32_16x16x32_bf16 v[84:87], v[40:43], a[20:23], v[84:87]
ds_read_b64_tr_b16 v[38:39], v10 offset:33024
v_max_f32 v114, 0, v114
v_mfma_f32_16x16x32_bf16 v[88:91], v[40:43], a[24:27], v[88:91]
buffer_load_dwordx4 v2, s[20:23], s45 offen lds
v_max_f32 v115, 0, v115
v_mfma_f32_16x16x32_bf16 v[92:95], v[40:43], a[28:31], v[92:95]
v_mul_f32 v112, v48, v112
v_mul_f32 v113, v49, v113
s_waitcnt lgkmcnt(4)
v_mfma_f32_16x16x32_bf16 v[96:99], v[44:47], a[16:19], v[96:99]
ds_read_b64_tr_b16 v[40:41], v8 offset:36864
v_mul_f32 v114, v50, v114
v_mfma_f32_16x16x32_bf16 v[100:103], v[44:47], a[20:23], v[100:103]
ds_read_b64_tr_b16 v[42:43], v8 offset:37120
v_mul_f32 v115, v51, v115
v_mfma_f32_16x16x32_bf16 v[104:107], v[44:47], a[24:27], v[104:107]
v_max_f32 v128, 0, v128
v_max_f32 v129, 0, v129
v_mfma_f32_16x16x32_bf16 v[108:111], v[44:47], a[28:31], v[108:111]
s_add_u32 m0, s44, 131072
s_add_u32 s45, s48, 1179776
v_max_f32 v130, 0, v130
s_waitcnt lgkmcnt(4)
v_mfma_f32_16x16x32_bf16 v[80:83], v[32:35], a[32:35], v[80:83]
ds_read_b64_tr_b16 v[44:45], v10 offset:36864
v_max_f32 v131, 0, v131
v_mfma_f32_16x16x32_bf16 v[84:87], v[32:35], a[36:39], v[84:87]
ds_read_b64_tr_b16 v[46:47], v10 offset:37120
v_mul_f32 v128, v64, v128
v_mfma_f32_16x16x32_bf16 v[88:91], v[32:35], a[40:43], v[88:91]
buffer_load_dwordx4 v2, s[20:23], s45 offen lds
v_mul_f32 v129, v65, v129
v_mfma_f32_16x16x32_bf16 v[92:95], v[32:35], a[44:47], v[92:95]
s_add_u32 m0, s44, 135168
s_add_u32 s45, s48, 1474688
v_mul_f32 v130, v66, v130
s_waitcnt lgkmcnt(4)
v_mfma_f32_16x16x32_bf16 v[96:99], v[36:39], a[32:35], v[96:99]
ds_read_b64_tr_b16 v[32:33], v8 offset:40960
v_mul_f32 v131, v67, v131
v_mfma_f32_16x16x32_bf16 v[100:103], v[36:39], a[36:39], v[100:103]
ds_read_b64_tr_b16 v[34:35], v8 offset:41216
v_cvt_pk_bf16_f32 v48, v112, v113
v_mfma_f32_16x16x32_bf16 v[104:107], v[36:39], a[40:43], v[104:107]
buffer_load_dwordx4 v2, s[20:23], s45 offen lds
v_cvt_pk_bf16_f32 v49, v114, v115
v_mfma_f32_16x16x32_bf16 v[108:111], v[36:39], a[44:47], v[108:111]
v_cvt_pk_bf16_f32 v50, v128, v129
v_cvt_pk_bf16_f32 v51, v130, v131
s_waitcnt lgkmcnt(4)
v_mfma_f32_16x16x32_bf16 v[80:83], v[40:43], a[48:51], v[80:83]
ds_read_b64_tr_b16 v[36:37], v10 offset:40960
ds_write_b128 v30, v[48:51] offset:0
v_mfma_f32_16x16x32_bf16 v[84:87], v[40:43], a[52:55], v[84:87]
ds_read_b64_tr_b16 v[38:39], v10 offset:41216
v_max_f32 v116, 0, v116
v_mfma_f32_16x16x32_bf16 v[88:91], v[40:43], a[56:59], v[88:91]
v_max_f32 v117, 0, v117
v_max_f32 v118, 0, v118
v_mfma_f32_16x16x32_bf16 v[92:95], v[40:43], a[60:63], v[92:95]
v_max_f32 v119, 0, v119
v_mul_f32 v116, v52, v116
s_waitcnt lgkmcnt(5)
v_mfma_f32_16x16x32_bf16 v[96:99], v[44:47], a[48:51], v[96:99]
ds_read_b64_tr_b16 v[40:41], v8 offset:45056
v_mul_f32 v117, v53, v117
v_mfma_f32_16x16x32_bf16 v[100:103], v[44:47], a[52:55], v[100:103]
ds_read_b64_tr_b16 v[42:43], v8 offset:45312
v_mul_f32 v118, v54, v118
v_mfma_f32_16x16x32_bf16 v[104:107], v[44:47], a[56:59], v[104:107]
v_mul_f32 v119, v55, v119
v_max_f32 v132, 0, v132
v_mfma_f32_16x16x32_bf16 v[108:111], v[44:47], a[60:63], v[108:111]
v_max_f32 v133, 0, v133
v_max_f32 v134, 0, v134
s_waitcnt lgkmcnt(5)
v_mfma_f32_16x16x32_bf16 v[80:83], v[32:35], a[64:67], v[80:83]
ds_read_b64_tr_b16 v[44:45], v10 offset:45056
v_max_f32 v135, 0, v135
v_mfma_f32_16x16x32_bf16 v[84:87], v[32:35], a[68:71], v[84:87]
ds_read_b64_tr_b16 v[46:47], v10 offset:45312
v_mul_f32 v132, v68, v132
v_mfma_f32_16x16x32_bf16 v[88:91], v[32:35], a[72:75], v[88:91]
v_mul_f32 v133, v69, v133
v_mul_f32 v134, v70, v134
v_mfma_f32_16x16x32_bf16 v[92:95], v[32:35], a[76:79], v[92:95]
v_mul_f32 v135, v71, v135
v_cvt_pk_bf16_f32 v52, v116, v117
s_waitcnt lgkmcnt(4)
v_mfma_f32_16x16x32_bf16 v[96:99], v[36:39], a[64:67], v[96:99]
s_waitcnt vmcnt(11) lgkmcnt(0)
s_barrier
ds_read_b64_tr_b16 v[32:33], v7 offset:0
v_cvt_pk_bf16_f32 v53, v118, v119
v_mfma_f32_16x16x32_bf16 v[100:103], v[36:39], a[68:71], v[100:103]
ds_read_b64_tr_b16 v[34:35], v7 offset:256
v_cvt_pk_bf16_f32 v54, v132, v133
v_mfma_f32_16x16x32_bf16 v[104:107], v[36:39], a[72:75], v[104:107]
v_cvt_pk_bf16_f32 v55, v134, v135
ds_write_b128 v30, v[52:55] offset:1024
v_mfma_f32_16x16x32_bf16 v[108:111], v[36:39], a[76:79], v[108:111]
s_add_u32 m0, s44, 139264
s_add_u32 s45, s48, 1769600
v_max_f32 v120, 0, v120
v_mfma_f32_16x16x32_bf16 v[80:83], v[40:43], a[80:83], v[80:83]
ds_read_b64_tr_b16 v[36:37], v9 offset:0
v_max_f32 v121, 0, v121
v_mfma_f32_16x16x32_bf16 v[84:87], v[40:43], a[84:87], v[84:87]
ds_read_b64_tr_b16 v[38:39], v9 offset:256
v_max_f32 v122, 0, v122
v_mfma_f32_16x16x32_bf16 v[88:91], v[40:43], a[88:91], v[88:91]
buffer_load_dwordx4 v2, s[20:23], s45 offen lds
v_max_f32 v123, 0, v123
v_mfma_f32_16x16x32_bf16 v[92:95], v[40:43], a[92:95], v[92:95]
s_add_u32 m0, s44, 143360
s_add_u32 s45, s48, 2064512
v_mul_f32 v120, v56, v120
v_mfma_f32_16x16x32_bf16 v[96:99], v[44:47], a[80:83], v[96:99]
ds_read_b64_tr_b16 v[40:41], v7 offset:4096
v_mul_f32 v121, v57, v121
v_mfma_f32_16x16x32_bf16 v[100:103], v[44:47], a[84:87], v[100:103]
ds_read_b64_tr_b16 v[42:43], v7 offset:4352
v_mul_f32 v122, v58, v122
v_mfma_f32_16x16x32_bf16 v[104:107], v[44:47], a[88:91], v[104:107]
buffer_load_dwordx4 v2, s[20:23], s45 offen lds
v_mul_f32 v123, v59, v123
v_mfma_f32_16x16x32_bf16 v[108:111], v[44:47], a[92:95], v[108:111]
v_max_f32 v136, 0, v136
v_max_f32 v137, 0, v137
s_waitcnt lgkmcnt(5)
v_mfma_f32_16x16x32_bf16 v[80:83], v[32:35], a[96:99], v[80:83]
ds_read_b64_tr_b16 v[44:45], v9 offset:4096
v_max_f32 v138, 0, v138
v_mfma_f32_16x16x32_bf16 v[84:87], v[32:35], a[100:103], v[84:87]
ds_read_b64_tr_b16 v[46:47], v9 offset:4352
v_max_f32 v139, 0, v139
v_mfma_f32_16x16x32_bf16 v[88:91], v[32:35], a[104:107], v[88:91]
v_mul_f32 v136, v72, v136
v_mul_f32 v137, v73, v137
v_mfma_f32_16x16x32_bf16 v[92:95], v[32:35], a[108:111], v[92:95]
s_add_u32 m0, s44, 147456
s_add_u32 s45, s48, 2359424
v_mul_f32 v138, v74, v138
s_waitcnt lgkmcnt(4)
v_mfma_f32_16x16x32_bf16 v[96:99], v[36:39], a[96:99], v[96:99]
ds_read_b64_tr_b16 v[32:33], v7 offset:8192
v_mul_f32 v139, v75, v139
v_mfma_f32_16x16x32_bf16 v[100:103], v[36:39], a[100:103], v[100:103]
ds_read_b64_tr_b16 v[34:35], v7 offset:8448
v_cvt_pk_bf16_f32 v56, v120, v121
v_mfma_f32_16x16x32_bf16 v[104:107], v[36:39], a[104:107], v[104:107]
buffer_load_dwordx4 v2, s[20:23], s45 offen lds
v_cvt_pk_bf16_f32 v57, v122, v123
v_mfma_f32_16x16x32_bf16 v[108:111], v[36:39], a[108:111], v[108:111]
s_add_u32 m0, s44, 151552
s_add_u32 s45, s48, 2654336
v_cvt_pk_bf16_f32 v58, v136, v137
s_waitcnt lgkmcnt(4)
v_mfma_f32_16x16x32_bf16 v[80:83], v[40:43], a[112:115], v[80:83]
ds_read_b64_tr_b16 v[36:37], v9 offset:8192
v_cvt_pk_bf16_f32 v59, v138, v139
v_mfma_f32_16x16x32_bf16 v[84:87], v[40:43], a[116:119], v[84:87]
ds_read_b64_tr_b16 v[38:39], v9 offset:8448
ds_write_b128 v31, v[56:59] offset:0
v_mfma_f32_16x16x32_bf16 v[88:91], v[40:43], a[120:123], v[88:91]
buffer_load_dwordx4 v2, s[20:23], s45 offen lds
v_max_f32 v124, 0, v124
v_mfma_f32_16x16x32_bf16 v[92:95], v[40:43], a[124:127], v[92:95]
v_max_f32 v125, 0, v125
v_max_f32 v126, 0, v126
s_waitcnt lgkmcnt(5)
v_mfma_f32_16x16x32_bf16 v[96:99], v[44:47], a[112:115], v[96:99]
ds_read_b64_tr_b16 v[40:41], v7 offset:12288
v_max_f32 v127, 0, v127
v_mfma_f32_16x16x32_bf16 v[100:103], v[44:47], a[116:119], v[100:103]
ds_read_b64_tr_b16 v[42:43], v7 offset:12544
v_mul_f32 v124, v60, v124
v_mfma_f32_16x16x32_bf16 v[104:107], v[44:47], a[120:123], v[104:107]
v_mul_f32 v125, v61, v125
v_mul_f32 v126, v62, v126
v_mfma_f32_16x16x32_bf16 v[108:111], v[44:47], a[124:127], v[108:111]
s_add_u32 m0, s44, 155648
s_add_u32 s45, s48, 2949248
v_mul_f32 v127, v63, v127
s_waitcnt lgkmcnt(5)
v_mfma_f32_16x16x32_bf16 v[80:83], v[32:35], a[128:131], v[80:83]
ds_read_b64_tr_b16 v[44:45], v9 offset:12288
v_max_f32 v140, 0, v140
v_mfma_f32_16x16x32_bf16 v[84:87], v[32:35], a[132:135], v[84:87]
ds_read_b64_tr_b16 v[46:47], v9 offset:12544
v_max_f32 v141, 0, v141
v_mfma_f32_16x16x32_bf16 v[88:91], v[32:35], a[136:139], v[88:91]
buffer_load_dwordx4 v2, s[20:23], s45 offen lds
v_max_f32 v142, 0, v142
v_mfma_f32_16x16x32_bf16 v[92:95], v[32:35], a[140:143], v[92:95]
s_add_u32 m0, s44, 159744
s_add_u32 s45, s48, 3244160
v_max_f32 v143, 0, v143
s_waitcnt lgkmcnt(5)
v_mfma_f32_16x16x32_bf16 v[96:99], v[36:39], a[128:131], v[96:99]
ds_read_b64_tr_b16 v[32:33], v7 offset:16384
v_mul_f32 v140, v76, v140
v_mfma_f32_16x16x32_bf16 v[100:103], v[36:39], a[132:135], v[100:103]
ds_read_b64_tr_b16 v[34:35], v7 offset:16640
v_mul_f32 v141, v77, v141
v_mfma_f32_16x16x32_bf16 v[104:107], v[36:39], a[136:139], v[104:107]
buffer_load_dwordx4 v2, s[20:23], s45 offen lds
v_mul_f32 v142, v78, v142
v_mfma_f32_16x16x32_bf16 v[108:111], v[36:39], a[140:143], v[108:111]
v_mul_f32 v143, v79, v143
v_cvt_pk_bf16_f32 v60, v124, v125
s_waitcnt lgkmcnt(4)
v_mfma_f32_16x16x32_bf16 v[80:83], v[40:43], a[144:147], v[80:83]
ds_read_b64_tr_b16 v[36:37], v9 offset:16384
v_cvt_pk_bf16_f32 v61, v126, v127
v_mfma_f32_16x16x32_bf16 v[84:87], v[40:43], a[148:151], v[84:87]
ds_read_b64_tr_b16 v[38:39], v9 offset:16640
v_cvt_pk_bf16_f32 v62, v140, v141
v_mfma_f32_16x16x32_bf16 v[88:91], v[40:43], a[152:155], v[88:91]
v_cvt_pk_bf16_f32 v63, v142, v143
ds_write_b128 v31, v[60:63] offset:1024
v_mfma_f32_16x16x32_bf16 v[92:95], v[40:43], a[156:159], v[92:95]
s_and_b32 s88, s5, 3
s_lshl_b32 s88, 1, s88
v_mov_b32 v192, s88
s_lshl_b32 s88, s4, 4
s_and_b32 s89, s5, 12
s_add_u32 s88, s88, s89
v_mov_b32 v193, s88
s_cmp_lg_u32 s3, 0
s_cbranch_scc1 L1_nf
s_mov_b64 exec, 1
buffer_atomic_or v192, v193, s[40:43], 0 offen
s_mov_b64 exec, -1
L1_nf:
s_waitcnt lgkmcnt(5)
v_mfma_f32_16x16x32_bf16 v[96:99], v[44:47], a[144:147], v[96:99]
ds_read_b64_tr_b16 v[40:41], v7 offset:20480
v_and_b32 v18, 3, v0
v_mfma_f32_16x16x32_bf16 v[100:103], v[44:47], a[148:151], v[100:103]
ds_read_b64_tr_b16 v[42:43], v7 offset:20736
s_cmp_eq_u32 s3, 0
s_cselect_b32 s71, 0x0f, 0
s_cselect_b32 s88, 0, 1024
s_lshl_b32 s89, s4, 4
s_add_u32 s88, s88, s89
v_lshl_add_u32 v18, v18, 2, s88
v_mfma_f32_16x16x32_bf16 v[104:107], v[44:47], a[152:155], v[104:107]
s_add_u32 s88, s100, 45056
buffer_store_dwordx4 v[252:255], v23, s[36:39], s88 offen sc1
s_add_u32 s88, s100, 49152
buffer_store_dwordx4 v[252:255], v23, s[36:39], s88 offen sc1
v_mfma_f32_16x16x32_bf16 v[108:111], v[44:47], a[156:159], v[108:111]
s_waitcnt lgkmcnt(5)
v_mfma_f32_16x16x32_bf16 v[80:83], v[32:35], a[160:163], v[80:83]
ds_read_b64_tr_b16 v[44:45], v9 offset:20480
s_add_u32 s88, s100, 53248
buffer_store_dwordx4 v[252:255], v23, s[36:39], s88 offen sc1
v_mfma_f32_16x16x32_bf16 v[84:87], v[32:35], a[164:167], v[84:87]
ds_read_b64_tr_b16 v[46:47], v9 offset:20736
v_mfma_f32_16x16x32_bf16 v[88:91], v[32:35], a[168:171], v[88:91]
v_mfma_f32_16x16x32_bf16 v[92:95], v[32:35], a[172:175], v[92:95]
s_waitcnt lgkmcnt(5)
v_mfma_f32_16x16x32_bf16 v[96:99], v[36:39], a[160:163], v[96:99]
s_waitcnt vmcnt(16) lgkmcnt(0)
s_barrier
ds_read_b64_tr_b16 v[32:33], v7 offset:40960
v_mfma_f32_16x16x32_bf16 v[100:103], v[36:39], a[164:167], v[100:103]
ds_read_b64_tr_b16 v[34:35], v7 offset:41216
v_mfma_f32_16x16x32_bf16 v[104:107], v[36:39], a[168:171], v[104:107]
v_mfma_f32_16x16x32_bf16 v[108:111], v[36:39], a[172:175], v[108:111]
s_add_u32 m0, s44, 49152
s_add_u32 s45, s48, 3539072
v_mfma_f32_16x16x32_bf16 v[80:83], v[40:43], a[176:179], v[80:83]
ds_read_b64_tr_b16 v[36:37], v9 offset:40960
v_mfma_f32_16x16x32_bf16 v[84:87], v[40:43], a[180:183], v[84:87]
ds_read_b64_tr_b16 v[38:39], v9 offset:41216
v_mfma_f32_16x16x32_bf16 v[88:91], v[40:43], a[184:187], v[88:91]
buffer_load_dwordx4 v2, s[20:23], s45 offen lds
v_mfma_f32_16x16x32_bf16 v[92:95], v[40:43], a[188:191], v[92:95]
s_add_u32 m0, s44, 53248
s_add_u32 s45, s48, 3833984
v_mfma_f32_16x16x32_bf16 v[96:99], v[44:47], a[176:179], v[96:99]
ds_read_b64_tr_b16 v[40:41], v7 offset:45056
v_mfma_f32_16x16x32_bf16 v[100:103], v[44:47], a[180:183], v[100:103]
ds_read_b64_tr_b16 v[42:43], v7 offset:45312
v_mfma_f32_16x16x32_bf16 v[104:107], v[44:47], a[184:187], v[104:107]
buffer_load_dwordx4 v2, s[20:23], s45 offen lds
v_mfma_f32_16x16x32_bf16 v[108:111], v[44:47], a[188:191], v[108:111]
s_waitcnt lgkmcnt(4)
v_mfma_f32_16x16x32_bf16 v[80:83], v[32:35], a[192:195], v[80:83]
ds_read_b64_tr_b16 v[44:45], v9 offset:45056
v_mfma_f32_16x16x32_bf16 v[84:87], v[32:35], a[196:199], v[84:87]
ds_read_b64_tr_b16 v[46:47], v9 offset:45312
v_mfma_f32_16x16x32_bf16 v[88:91], v[32:35], a[200:203], v[88:91]
v_mfma_f32_16x16x32_bf16 v[92:95], v[32:35], a[204:207], v[92:95]
s_add_u32 m0, s44, 57344
s_add_u32 s45, s48, 4128896
s_waitcnt lgkmcnt(4)
v_mfma_f32_16x16x32_bf16 v[96:99], v[36:39], a[192:195], v[96:99]
ds_read_b64_tr_b16 v[32:33], v7 offset:49152
v_mfma_f32_16x16x32_bf16 v[100:103], v[36:39], a[196:199], v[100:103]
ds_read_b64_tr_b16 v[34:35], v7 offset:49408
v_mfma_f32_16x16x32_bf16 v[104:107], v[36:39], a[200:203], v[104:107]
buffer_load_dwordx4 v2, s[20:23], s45 offen lds
v_mfma_f32_16x16x32_bf16 v[108:111], v[36:39], a[204:207], v[108:111]
s_add_u32 m0, s44, 61440
s_add_u32 s45, s48, 4423808
s_waitcnt lgkmcnt(4)
v_mfma_f32_16x16x32_bf16 v[80:83], v[40:43], a[208:211], v[80:83]
ds_read_b64_tr_b16 v[36:37], v9 offset:49152
v_mfma_f32_16x16x32_bf16 v[84:87], v[40:43], a[212:215], v[84:87]
ds_read_b64_tr_b16 v[38:39], v9 offset:49408
v_mfma_f32_16x16x32_bf16 v[88:91], v[40:43], a[216:219], v[88:91]
buffer_load_dwordx4 v2, s[20:23], s45 offen lds
v_mfma_f32_16x16x32_bf16 v[92:95], v[40:43], a[220:223], v[92:95]
s_waitcnt lgkmcnt(4)
v_mfma_f32_16x16x32_bf16 v[96:99], v[44:47], a[208:211], v[96:99]
ds_read_b64_tr_b16 v[40:41], v7 offset:53248
s_add_u32 s88, s100, 57344
buffer_store_dwordx4 v[252:255], v23, s[36:39], s88 offen sc1
v_mfma_f32_16x16x32_bf16 v[100:103], v[44:47], a[212:215], v[100:103]
ds_read_b64_tr_b16 v[42:43], v7 offset:53504
v_mfma_f32_16x16x32_bf16 v[104:107], v[44:47], a[216:219], v[104:107]
v_mfma_f32_16x16x32_bf16 v[108:111], v[44:47], a[220:223], v[108:111]
s_add_u32 m0, s44, 65536
s_add_u32 s45, s48, 4718720
s_waitcnt lgkmcnt(4)
v_mfma_f32_16x16x32_bf16 v[80:83], v[32:35], a[224:227], v[80:83]
ds_read_b64_tr_b16 v[44:45], v9 offset:53248
v_mfma_f32_16x16x32_bf16 v[84:87], v[32:35], a[228:231], v[84:87]
ds_read_b64_tr_b16 v[46:47], v9 offset:53504
v_mfma_f32_16x16x32_bf16 v[88:91], v[32:35], a[232:235], v[88:91]
buffer_load_dwordx4 v2, s[20:23], s45 offen lds
v_mfma_f32_16x16x32_bf16 v[92:95], v[32:35], a[236:239], v[92:95]
s_add_u32 m0, s44, 69632
s_add_u32 s45, s48, 5013632
s_waitcnt lgkmcnt(4)
v_mfma_f32_16x16x32_bf16 v[96:99], v[36:39], a[224:227], v[96:99]
ds_read_b64_tr_b16 v[32:33], v7 offset:57344
v_mfma_f32_16x16x32_bf16 v[100:103], v[36:39], a[228:231], v[100:103]
ds_read_b64_tr_b16 v[34:35], v7 offset:57600
v_mfma_f32_16x16x32_bf16 v[104:107], v[36:39], a[232:235], v[104:107]
buffer_load_dwordx4 v2, s[20:23], s45 offen lds
v_mfma_f32_16x16x32_bf16 v[108:111], v[36:39], a[236:239], v[108:111]
s_waitcnt lgkmcnt(4)
v_mfma_f32_16x16x32_bf16 v[80:83], v[40:43], a[240:243], v[80:83]
ds_read_b64_tr_b16 v[36:37], v9 offset:57344
v_mfma_f32_16x16x32_bf16 v[84:87], v[40:43], a[244:247], v[84:87]
ds_read_b64_tr_b16 v[38:39], v9 offset:57600
v_mfma_f32_16x16x32_bf16 v[88:91], v[40:43], a[248:251], v[88:91]
v_mfma_f32_16x16x32_bf16 v[92:95], v[40:43], a[252:255], v[92:95]
s_waitcnt lgkmcnt(4)
v_mfma_f32_16x16x32_bf16 v[96:99], v[44:47], a[240:243], v[96:99]
ds_read_b64_tr_b16 v[40:41], v7 offset:61440
v_mfma_f32_16x16x32_bf16 v[100:103], v[44:47], a[244:247], v[100:103]
ds_read_b64_tr_b16 v[42:43], v7 offset:61696
v_mfma_f32_16x16x32_bf16 v[104:107], v[44:47], a[248:251], v[104:107]
v_mfma_f32_16x16x32_bf16 v[108:111], v[44:47], a[252:255], v[108:111]
s_waitcnt lgkmcnt(4)
v_mfma_f32_16x16x32_bf16 v[80:83], v[32:35], v[144:147], v[80:83]
ds_read_b64_tr_b16 v[44:45], v9 offset:61440
v_mfma_f32_16x16x32_bf16 v[84:87], v[32:35], v[148:151], v[84:87]
ds_read_b64_tr_b16 v[46:47], v9 offset:61696
v_mfma_f32_16x16x32_bf16 v[88:91], v[32:35], v[152:155], v[88:91]
v_mfma_f32_16x16x32_bf16 v[92:95], v[32:35], v[156:159], v[92:95]
s_waitcnt lgkmcnt(4)
v_mfma_f32_16x16x32_bf16 v[96:99], v[36:39], v[144:147], v[96:99]
s_waitcnt vmcnt(16) lgkmcnt(0)
s_barrier
ds_read_b64_tr_b16 v[32:33], v8 offset:0
v_mfma_f32_16x16x32_bf16 v[100:103], v[36:39], v[148:151], v[100:103]
ds_read_b64_tr_b16 v[34:35], v8 offset:256
v_mfma_f32_16x16x32_bf16 v[104:107], v[36:39], v[152:155], v[104:107]
v_mfma_f32_16x16x32_bf16 v[108:111], v[36:39], v[156:159], v[108:111]
s_add_u32 m0, s44, 90112
s_add_u32 s45, s48, 256
v_mfma_f32_16x16x32_bf16 v[80:83], v[40:43], v[160:163], v[80:83]
ds_read_b64_tr_b16 v[36:37], v10 offset:0
s_add_u32 s88, s100, 61440
buffer_store_dwordx4 v[252:255], v23, s[36:39], s88 offen sc1
v_mfma_f32_16x16x32_bf16 v[84:87], v[40:43], v[164:167], v[84:87]
ds_read_b64_tr_b16 v[38:39], v10 offset:256
v_mfma_f32_16x16x32_bf16 v[88:91], v[40:43], v[168:171], v[88:91]
buffer_load_dwordx4 v2, s[16:19], s45 offen lds
v_mfma_f32_16x16x32_bf16 v[92:95], v[40:43], v[172:175], v[92:95]
s_add_u32 m0, s44, 94208
s_add_u32 s45, s48, 295168
v_mfma_f32_16x16x32_bf16 v[96:99], v[44:47], v[160:163], v[96:99]
ds_read_b64_tr_b16 v[40:41], v8 offset:4096
v_mfma_f32_16x16x32_bf16 v[100:103], v[44:47], v[164:167], v[100:103]
ds_read_b64_tr_b16 v[42:43], v8 offset:4352
v_mfma_f32_16x16x32_bf16 v[104:107], v[44:47], v[168:171], v[104:107]
buffer_load_dwordx4 v2, s[16:19], s45 offen lds
v_mfma_f32_16x16x32_bf16 v[108:111], v[44:47], v[172:175], v[108:111]
s_waitcnt lgkmcnt(4)
v_mfma_f32_16x16x32_bf16 v[112:115], v[32:35], a[0:3], 0
ds_read_b64_tr_b16 v[44:45], v10 offset:4096
v_mfma_f32_16x16x32_bf16 v[116:119], v[32:35], a[4:7], 0
ds_read_b64_tr_b16 v[46:47], v10 offset:4352
v_mfma_f32_16x16x32_bf16 v[120:123], v[32:35], a[8:11], 0
v_mfma_f32_16x16x32_bf16 v[124:127], v[32:35], a[12:15], 0
s_add_u32 m0, s44, 98304
s_add_u32 s45, s48, 590080
s_waitcnt lgkmcnt(4)
v_mfma_f32_16x16x32_bf16 v[128:131], v[36:39], a[0:3], 0
ds_read_b64_tr_b16 v[32:33], v8 offset:8192
v_mfma_f32_16x16x32_bf16 v[132:135], v[36:39], a[4:7], 0
ds_read_b64_tr_b16 v[34:35], v8 offset:8448
v_mfma_f32_16x16x32_bf16 v[136:139], v[36:39], a[8:11], 0
buffer_load_dwordx4 v2, s[16:19], s45 offen lds
v_mfma_f32_16x16x32_bf16 v[140:143], v[36:39], a[12:15], 0
s_add_u32 m0, s44, 102400
s_add_u32 s45, s48, 884992
s_waitcnt lgkmcnt(4)
v_mfma_f32_16x16x32_bf16 v[112:115], v[40:43], a[16:19], v[112:115]
ds_read_b64_tr_b16 v[36:37], v10 offset:8192
v_mfma_f32_16x16x32_bf16 v[116:119], v[40:43], a[20:23], v[116:119]
ds_read_b64_tr_b16 v[38:39], v10 offset:8448
v_mfma_f32_16x16x32_bf16 v[120:123], v[40:43], a[24:27], v[120:123]
buffer_load_dwordx4 v2, s[16:19], s45 offen lds
v_mfma_f32_16x16x32_bf16 v[124:127], v[40:43], a[28:31], v[124:127]
s_waitcnt lgkmcnt(4)
v_mfma_f32_16x16x32_bf16 v[128:131], v[44:47], a[16:19], v[128:131]
ds_read_b64_tr_b16 v[40:41], v8 offset:12288
v_mfma_f32_16x16x32_bf16 v[132:135], v[44:47], a[20:23], v[132:135]
ds_read_b64_tr_b16 v[42:43], v8 offset:12544
v_mfma_f32_16x16x32_bf16 v[136:139], v[44:47], a[24:27], v[136:139]
v_mfma_f32_16x16x32_bf16 v[140:143], v[44:47], a[28:31], v[140:143]
s_add_u32 m0, s44, 106496
s_add_u32 s45, s48, 1179904
s_waitcnt lgkmcnt(4)
v_mfma_f32_16x16x32_bf16 v[112:115], v[32:35], a[32:35], v[112:115]
ds_read_b64_tr_b16 v[44:45], v10 offset:12288
v_mfma_f32_16x16x32_bf16 v[116:119], v[32:35], a[36:39], v[116:119]
ds_read_b64_tr_b16 v[46:47], v10 offset:12544
v_mfma_f32_16x16x32_bf16 v[120:123], v[32:35], a[40:43], v[120:123]
buffer_load_dwordx4 v2, s[16:19], s45 offen lds
v_mfma_f32_16x16x32_bf16 v[124:127], v[32:35], a[44:47], v[124:127]
s_add_u32 m0, s44, 110592
s_add_u32 s45, s48, 1474816
s_waitcnt lgkmcnt(4)
v_mfma_f32_16x16x32_bf16 v[128:131], v[36:39], a[32:35], v[128:131]
ds_read_b64_tr_b16 v[32:33], v8 offset:16384
v_mfma_f32_16x16x32_bf16 v[132:135], v[36:39], a[36:39], v[132:135]
ds_read_b64_tr_b16 v[34:35], v8 offset:16640
v_mfma_f32_16x16x32_bf16 v[136:139], v[36:39], a[40:43], v[136:139]
buffer_load_dwordx4 v2, s[16:19], s45 offen lds
v_mfma_f32_16x16x32_bf16 v[140:143], v[36:39], a[44:47], v[140:143]
s_waitcnt lgkmcnt(4)
v_mfma_f32_16x16x32_bf16 v[112:115], v[40:43], a[48:51], v[112:115]
ds_read_b64_tr_b16 v[36:37], v10 offset:16384
s_add_u32 s88, s100, 65536
buffer_store_dwordx4 v[252:255], v23, s[36:39], s88 offen sc1
v_mfma_f32_16x16x32_bf16 v[116:119], v[40:43], a[52:55], v[116:119]
ds_read_b64_tr_b16 v[38:39], v10 offset:16640
v_mfma_f32_16x16x32_bf16 v[120:123], v[40:43], a[56:59], v[120:123]
v_mfma_f32_16x16x32_bf16 v[124:127], v[40:43], a[60:63], v[124:127]
s_waitcnt lgkmcnt(4)
v_mfma_f32_16x16x32_bf16 v[128:131], v[44:47], a[48:51], v[128:131]
ds_read_b64_tr_b16 v[40:41], v8 offset:20480
v_mfma_f32_16x16x32_bf16 v[132:135], v[44:47], a[52:55], v[132:135]
ds_read_b64_tr_b16 v[42:43], v8 offset:20736
v_mfma_f32_16x16x32_bf16 v[136:139], v[44:47], a[56:59], v[136:139]
v_mfma_f32_16x16x32_bf16 v[140:143], v[44:47], a[60:63], v[140:143]
s_waitcnt lgkmcnt(4)
v_mfma_f32_16x16x32_bf16 v[112:115], v[32:35], a[64:67], v[112:115]
ds_read_b64_tr_b16 v[44:45], v10 offset:20480
v_mfma_f32_16x16x32_bf16 v[116:119], v[32:35], a[68:71], v[116:119]
ds_read_b64_tr_b16 v[46:47], v10 offset:20736
v_mfma_f32_16x16x32_bf16 v[120:123], v[32:35], a[72:75], v[120:123]
v_mfma_f32_16x16x32_bf16 v[124:127], v[32:35], a[76:79], v[124:127]
s_waitcnt lgkmcnt(4)
v_mfma_f32_16x16x32_bf16 v[128:131], v[36:39], a[64:67], v[128:131]
s_waitcnt vmcnt(18) lgkmcnt(0)
s_barrier
ds_read_b64_tr_b16 v[32:33], v8 offset:24576
v_mfma_f32_16x16x32_bf16 v[132:135], v[36:39], a[68:71], v[132:135]
ds_read_b64_tr_b16 v[34:35], v8 offset:24832
v_mfma_f32_16x16x32_bf16 v[136:139], v[36:39], a[72:75], v[136:139]
v_mfma_f32_16x16x32_bf16 v[140:143], v[36:39], a[76:79], v[140:143]
s_add_u32 m0, s44, 114688
s_add_u32 s45, s48, 1769728
v_mfma_f32_16x16x32_bf16 v[112:115], v[40:43], a[80:83], v[112:115]
ds_read_b64_tr_b16 v[36:37], v10 offset:24576
v_mfma_f32_16x16x32_bf16 v[116:119], v[40:43], a[84:87], v[116:119]
ds_read_b64_tr_b16 v[38:39], v10 offset:24832
v_mfma_f32_16x16x32_bf16 v[120:123], v[40:43], a[88:91], v[120:123]
buffer_load_dwordx4 v2, s[16:19], s45 offen lds
v_mfma_f32_16x16x32_bf16 v[124:127], v[40:43], a[92:95], v[124:127]
s_add_u32 m0, s44, 118784
s_add_u32 s45, s48, 2064640
v_mfma_f32_16x16x32_bf16 v[128:131], v[44:47], a[80:83], v[128:131]
ds_read_b64_tr_b16 v[40:41], v8 offset:28672
v_mfma_f32_16x16x32_bf16 v[132:135], v[44:47], a[84:87], v[132:135]
ds_read_b64_tr_b16 v[42:43], v8 offset:28928
v_mfma_f32_16x16x32_bf16 v[136:139], v[44:47], a[88:91], v[136:139]
buffer_load_dwordx4 v2, s[16:19], s45 offen lds
v_mfma_f32_16x16x32_bf16 v[140:143], v[44:47], a[92:95], v[140:143]
s_waitcnt lgkmcnt(4)
v_mfma_f32_16x16x32_bf16 v[112:115], v[32:35], a[96:99], v[112:115]
ds_read_b64_tr_b16 v[44:45], v10 offset:28672
v_mfma_f32_16x16x32_bf16 v[116:119], v[32:35], a[100:103], v[116:119]
ds_read_b64_tr_b16 v[46:47], v10 offset:28928
v_mfma_f32_16x16x32_bf16 v[120:123], v[32:35], a[104:107], v[120:123]
v_mfma_f32_16x16x32_bf16 v[124:127], v[32:35], a[108:111], v[124:127]
s_add_u32 m0, s44, 122880
s_add_u32 s45, s48, 2359552
s_waitcnt lgkmcnt(4)
v_mfma_f32_16x16x32_bf16 v[128:131], v[36:39], a[96:99], v[128:131]
ds_read_b64_tr_b16 v[32:33], v8 offset:32768
s_add_u32 s88, s100, 69632
buffer_store_dwordx4 v[252:255], v23, s[36:39], s88 offen sc1
v_mfma_f32_16x16x32_bf16 v[132:135], v[36:39], a[100:103], v[132:135]
ds_read_b64_tr_b16 v[34:35], v8 offset:33024
v_mfma_f32_16x16x32_bf16 v[136:139], v[36:39], a[104:107], v[136:139]
buffer_load_dwordx4 v2, s[16:19], s45 offen lds
v_mfma_f32_16x16x32_bf16 v[140:143], v[36:39], a[108:111], v[140:143]
s_add_u32 m0, s44, 126976
s_add_u32 s45, s48, 2654464
s_waitcnt lgkmcnt(4)
v_mfma_f32_16x16x32_bf16 v[112:115], v[40:43], a[112:115], v[112:115]
ds_read_b64_tr_b16 v[36:37], v10 offset:32768
v_mfma_f32_16x16x32_bf16 v[116:119], v[40:43], a[116:119], v[116:119]
ds_read_b64_tr_b16 v[38:39], v10 offset:33024
v_mfma_f32_16x16x32_bf16 v[120:123], v[40:43], a[120:123], v[120:123]
buffer_load_dwordx4 v2, s[16:19], s45 offen lds
v_mfma_f32_16x16x32_bf16 v[124:127], v[40:43], a[124:127], v[124:127]
s_waitcnt lgkmcnt(4)
v_mfma_f32_16x16x32_bf16 v[128:131], v[44:47], a[112:115], v[128:131]
ds_read_b64_tr_b16 v[40:41], v8 offset:36864
v_mfma_f32_16x16x32_bf16 v[132:135], v[44:47], a[116:119], v[132:135]
ds_read_b64_tr_b16 v[42:43], v8 offset:37120
v_mfma_f32_16x16x32_bf16 v[136:139], v[44:47], a[120:123], v[136:139]
v_mfma_f32_16x16x32_bf16 v[140:143], v[44:47], a[124:127], v[140:143]
s_add_u32 m0, s44, 131072
s_add_u32 s45, s48, 2949376
s_waitcnt lgkmcnt(4)
v_mfma_f32_16x16x32_bf16 v[112:115], v[32:35], a[128:131], v[112:115]
ds_read_b64_tr_b16 v[44:45], v10 offset:36864
v_mfma_f32_16x16x32_bf16 v[116:119], v[32:35], a[132:135], v[116:119]
ds_read_b64_tr_b16 v[46:47], v10 offset:37120
v_mfma_f32_16x16x32_bf16 v[120:123], v[32:35], a[136:139], v[120:123]
buffer_load_dwordx4 v2, s[16:19], s45 offen lds
v_mfma_f32_16x16x32_bf16 v[124:127], v[32:35], a[140:143], v[124:127]
s_add_u32 m0, s44, 135168
s_add_u32 s45, s48, 3244288
s_waitcnt lgkmcnt(4)
v_mfma_f32_16x16x32_bf16 v[128:131], v[36:39], a[128:131], v[128:131]
ds_read_b64_tr_b16 v[32:33], v8 offset:40960
v_mfma_f32_16x16x32_bf16 v[132:135], v[36:39], a[132:135], v[132:135]
ds_read_b64_tr_b16 v[34:35], v8 offset:41216
v_mfma_f32_16x16x32_bf16 v[136:139], v[36:39], a[136:139], v[136:139]
buffer_load_dwordx4 v2, s[16:19], s45 offen lds
v_mfma_f32_16x16x32_bf16 v[140:143], v[36:39], a[140:143], v[140:143]
s_waitcnt lgkmcnt(4)
v_mfma_f32_16x16x32_bf16 v[112:115], v[40:43], a[144:147], v[112:115]
ds_read_b64_tr_b16 v[36:37], v10 offset:40960
v_mfma_f32_16x16x32_bf16 v[116:119], v[40:43], a[148:151], v[116:119]
ds_read_b64_tr_b16 v[38:39], v10 offset:41216
v_mfma_f32_16x16x32_bf16 v[120:123], v[40:43], a[152:155], v[120:123]
v_mfma_f32_16x16x32_bf16 v[124:127], v[40:43], a[156:159], v[124:127]
s_waitcnt lgkmcnt(4)
v_mfma_f32_16x16x32_bf16 v[128:131], v[44:47], a[144:147], v[128:131]
ds_read_b64_tr_b16 v[40:41], v8 offset:45056
v_mfma_f32_16x16x32_bf16 v[132:135], v[44:47], a[148:151], v[132:135]
ds_read_b64_tr_b16 v[42:43], v8 offset:45312
v_mfma_f32_16x16x32_bf16 v[136:139], v[44:47], a[152:155], v[136:139]
v_mfma_f32_16x16x32_bf16 v[140:143], v[44:47], a[156:159], v[140:143]
s_waitcnt lgkmcnt(4)
v_mfma_f32_16x16x32_bf16 v[112:115], v[32:35], a[160:163], v[112:115]
ds_read_b64_tr_b16 v[44:45], v10 offset:45056
s_add_u32 s88, s100, 73728
buffer_store_dwordx4 v[252:255], v23, s[36:39], s88 offen sc1
v_mfma_f32_16x16x32_bf16 v[116:119], v[32:35], a[164:167], v[116:119]
ds_read_b64_tr_b16 v[46:47], v10 offset:45312
v_mfma_f32_16x16x32_bf16 v[120:123], v[32:35], a[168:171], v[120:123]
v_mfma_f32_16x16x32_bf16 v[124:127], v[32:35], a[172:175], v[124:127]
s_waitcnt lgkmcnt(4)
v_mfma_f32_16x16x32_bf16 v[128:131], v[36:39], a[160:163], v[128:131]
s_waitcnt vmcnt(16) lgkmcnt(0)
s_barrier
ds_read_b64_tr_b16 v[32:33], v7 offset:0
v_mfma_f32_16x16x32_bf16 v[132:135], v[36:39], a[164:167], v[132:135]
ds_read_b64_tr_b16 v[34:35], v7 offset:256
v_mfma_f32_16x16x32_bf16 v[136:139], v[36:39], a[168:171], v[136:139]
v_mfma_f32_16x16x32_bf16 v[140:143], v[36:39], a[172:175], v[140:143]
s_add_u32 m0, s44, 139264
s_add_u32 s45, s48, 3539200
v_mfma_f32_16x16x32_bf16 v[112:115], v[40:43], a[176:179], v[112:115]
ds_read_b64_tr_b16 v[36:37], v9 offset:0
v_mfma_f32_16x16x32_bf16 v[116:119], v[40:43], a[180:183], v[116:119]
ds_read_b64_tr_b16 v[38:39], v9 offset:256
v_mfma_f32_16x16x32_bf16 v[120:123], v[40:43], a[184:187], v[120:123]
buffer_load_dwordx4 v2, s[16:19], s45 offen lds
v_mfma_f32_16x16x32_bf16 v[124:127], v[40:43], a[188:191], v[124:127]
s_add_u32 m0, s44, 143360
s_add_u32 s45, s48, 3834112
v_mfma_f32_16x16x32_bf16 v[128:131], v[44:47], a[176:179], v[128:131]
ds_read_b64_tr_b16 v[40:41], v7 offset:4096
v_mfma_f32_16x16x32_bf16 v[132:135], v[44:47], a[180:183], v[132:135]
ds_read_b64_tr_b16 v[42:43], v7 offset:4352
v_mfma_f32_16x16x32_bf16 v[136:139], v[44:47], a[184:187], v[136:139]
buffer_load_dwordx4 v2, s[16:19], s45 offen lds
v_mfma_f32_16x16x32_bf16 v[140:143], v[44:47], a[188:191], v[140:143]
s_waitcnt lgkmcnt(4)
v_mfma_f32_16x16x32_bf16 v[112:115], v[32:35], a[192:195], v[112:115]
ds_read_b64_tr_b16 v[44:45], v9 offset:4096
v_mfma_f32_16x16x32_bf16 v[116:119], v[32:35], a[196:199], v[116:119]
ds_read_b64_tr_b16 v[46:47], v9 offset:4352
v_mfma_f32_16x16x32_bf16 v[120:123], v[32:35], a[200:203], v[120:123]
v_mfma_f32_16x16x32_bf16 v[124:127], v[32:35], a[204:207], v[124:127]
s_add_u32 m0, s44, 147456
s_add_u32 s45, s48, 4129024
s_waitcnt lgkmcnt(4)
v_mfma_f32_16x16x32_bf16 v[128:131], v[36:39], a[192:195], v[128:131]
ds_read_b64_tr_b16 v[32:33], v7 offset:8192
v_mfma_f32_16x16x32_bf16 v[132:135], v[36:39], a[196:199], v[132:135]
ds_read_b64_tr_b16 v[34:35], v7 offset:8448
v_mfma_f32_16x16x32_bf16 v[136:139], v[36:39], a[200:203], v[136:139]
buffer_load_dwordx4 v2, s[16:19], s45 offen lds
v_mfma_f32_16x16x32_bf16 v[140:143], v[36:39], a[204:207], v[140:143]
s_add_u32 m0, s44, 151552
s_add_u32 s45, s48, 4423936
s_waitcnt lgkmcnt(4)
v_mfma_f32_16x16x32_bf16 v[112:115], v[40:43], a[208:211], v[112:115]
ds_read_b64_tr_b16 v[36:37], v9 offset:8192
v_mfma_f32_16x16x32_bf16 v[116:119], v[40:43], a[212:215], v[116:119]
ds_read_b64_tr_b16 v[38:39], v9 offset:8448
v_mfma_f32_16x16x32_bf16 v[120:123], v[40:43], a[216:219], v[120:123]
buffer_load_dwordx4 v2, s[16:19], s45 offen lds
v_mfma_f32_16x16x32_bf16 v[124:127], v[40:43], a[220:223], v[124:127]
s_waitcnt lgkmcnt(4)
v_mfma_f32_16x16x32_bf16 v[128:131], v[44:47], a[208:211], v[128:131]
ds_read_b64_tr_b16 v[40:41], v7 offset:12288
s_add_u32 s88, s100, 77824
buffer_store_dwordx4 v[252:255], v23, s[36:39], s88 offen sc1
v_mfma_f32_16x16x32_bf16 v[132:135], v[44:47], a[212:215], v[132:135]
ds_read_b64_tr_b16 v[42:43], v7 offset:12544
v_mfma_f32_16x16x32_bf16 v[136:139], v[44:47], a[216:219], v[136:139]
v_mfma_f32_16x16x32_bf16 v[140:143], v[44:47], a[220:223], v[140:143]
s_add_u32 m0, s44, 155648
s_add_u32 s45, s48, 4718848
s_waitcnt lgkmcnt(4)
v_mfma_f32_16x16x32_bf16 v[112:115], v[32:35], a[224:227], v[112:115]
ds_read_b64_tr_b16 v[44:45], v9 offset:12288
v_mfma_f32_16x16x32_bf16 v[116:119], v[32:35], a[228:231], v[116:119]
ds_read_b64_tr_b16 v[46:47], v9 offset:12544
v_mfma_f32_16x16x32_bf16 v[120:123], v[32:35], a[232:235], v[120:123]
buffer_load_dwordx4 v2, s[16:19], s45 offen lds
v_mfma_f32_16x16x32_bf16 v[124:127], v[32:35], a[236:239], v[124:127]
s_add_u32 m0, s44, 159744
s_add_u32 s45, s48, 5013760
s_waitcnt lgkmcnt(4)
v_mfma_f32_16x16x32_bf16 v[128:131], v[36:39], a[224:227], v[128:131]
ds_read_b64_tr_b16 v[32:33], v7 offset:16384
v_mfma_f32_16x16x32_bf16 v[132:135], v[36:39], a[228:231], v[132:135]
ds_read_b64_tr_b16 v[34:35], v7 offset:16640
v_mfma_f32_16x16x32_bf16 v[136:139], v[36:39], a[232:235], v[136:139]
buffer_load_dwordx4 v2, s[16:19], s45 offen lds
v_mfma_f32_16x16x32_bf16 v[140:143], v[36:39], a[236:239], v[140:143]
s_waitcnt lgkmcnt(4)
v_mfma_f32_16x16x32_bf16 v[112:115], v[40:43], a[240:243], v[112:115]
ds_read_b64_tr_b16 v[36:37], v9 offset:16384
v_mfma_f32_16x16x32_bf16 v[116:119], v[40:43], a[244:247], v[116:119]
ds_read_b64_tr_b16 v[38:39], v9 offset:16640
v_mfma_f32_16x16x32_bf16 v[120:123], v[40:43], a[248:251], v[120:123]
v_mfma_f32_16x16x32_bf16 v[124:127], v[40:43], a[252:255], v[124:127]
s_waitcnt lgkmcnt(4)
v_mfma_f32_16x16x32_bf16 v[128:131], v[44:47], a[240:243], v[128:131]
ds_read_b64_tr_b16 v[40:41], v7 offset:20480
v_mfma_f32_16x16x32_bf16 v[132:135], v[44:47], a[244:247], v[132:135]
ds_read_b64_tr_b16 v[42:43], v7 offset:20736
v_mfma_f32_16x16x32_bf16 v[136:139], v[44:47], a[248:251], v[136:139]
v_mfma_f32_16x16x32_bf16 v[140:143], v[44:47], a[252:255], v[140:143]
s_waitcnt lgkmcnt(4)
v_mfma_f32_16x16x32_bf16 v[112:115], v[32:35], v[144:147], v[112:115]
ds_read_b64_tr_b16 v[44:45], v9 offset:20480
v_mfma_f32_16x16x32_bf16 v[116:119], v[32:35], v[148:151], v[116:119]
ds_read_b64_tr_b16 v[46:47], v9 offset:20736
v_mfma_f32_16x16x32_bf16 v[120:123], v[32:35], v[152:155], v[120:123]
v_mfma_f32_16x16x32_bf16 v[124:127], v[32:35], v[156:159], v[124:127]
s_waitcnt lgkmcnt(4)
v_mfma_f32_16x16x32_bf16 v[128:131], v[36:39], v[144:147], v[128:131]
s_waitcnt vmcnt(16) lgkmcnt(0)
s_barrier
ds_read_b64_tr_b16 v[32:33], v7 offset:40960
v_mfma_f32_16x16x32_bf16 v[132:135], v[36:39], v[148:151], v[132:135]
ds_read_b64_tr_b16 v[34:35], v7 offset:41216
v_mfma_f32_16x16x32_bf16 v[136:139], v[36:39], v[152:155], v[136:139]
v_mfma_f32_16x16x32_bf16 v[140:143], v[36:39], v[156:159], v[140:143]
s_add_u32 m0, s44, 49152
s_add_u32 s45, s48, 256
v_mfma_f32_16x16x32_bf16 v[112:115], v[40:43], v[160:163], v[112:115]
ds_read_b64_tr_b16 v[36:37], v9 offset:40960
s_add_u32 s88, s100, 81920
buffer_store_dwordx4 v[252:255], v23, s[36:39], s88 offen sc1
v_mfma_f32_16x16x32_bf16 v[116:119], v[40:43], v[164:167], v[116:119]
ds_read_b64_tr_b16 v[38:39], v9 offset:41216
v_mfma_f32_16x16x32_bf16 v[120:123], v[40:43], v[168:171], v[120:123]
buffer_load_dwordx4 v2, s[20:23], s45 offen lds
v_mfma_f32_16x16x32_bf16 v[124:127], v[40:43], v[172:175], v[124:127]
s_add_u32 m0, s44, 53248
s_add_u32 s45, s48, 295168
v_mfma_f32_16x16x32_bf16 v[128:131], v[44:47], v[160:163], v[128:131]
ds_read_b64_tr_b16 v[40:41], v7 offset:45056
v_mfma_f32_16x16x32_bf16 v[132:135], v[44:47], v[164:167], v[132:135]
ds_read_b64_tr_b16 v[42:43], v7 offset:45312
v_mfma_f32_16x16x32_bf16 v[136:139], v[44:47], v[168:171], v[136:139]
buffer_load_dwordx4 v2, s[20:23], s45 offen lds
v_mfma_f32_16x16x32_bf16 v[140:143], v[44:47], v[172:175], v[140:143]
s_waitcnt lgkmcnt(4)
v_mfma_f32_16x16x32_bf16 v[48:51], v[32:35], a[0:3], 0
ds_read_b64_tr_b16 v[44:45], v9 offset:45056
v_mfma_f32_16x16x32_bf16 v[52:55], v[32:35], a[4:7], 0
ds_read_b64_tr_b16 v[46:47], v9 offset:45312
v_mfma_f32_16x16x32_bf16 v[56:59], v[32:35], a[8:11], 0
v_mfma_f32_16x16x32_bf16 v[60:63], v[32:35], a[12:15], 0
s_add_u32 m0, s44, 57344
s_add_u32 s45, s48, 590080
s_waitcnt lgkmcnt(4)
v_mfma_f32_16x16x32_bf16 v[64:67], v[36:39], a[0:3], 0
ds_read_b64_tr_b16 v[32:33], v7 offset:49152
v_max_f32 v80, 0, v80
v_mfma_f32_16x16x32_bf16 v[68:71], v[36:39], a[4:7], 0
ds_read_b64_tr_b16 v[34:35], v7 offset:49408
v_max_f32 v81, 0, v81
v_mfma_f32_16x16x32_bf16 v[72:75], v[36:39], a[8:11], 0
buffer_load_dwordx4 v2, s[20:23], s45 offen lds
v_max_f32 v82, 0, v82
v_mfma_f32_16x16x32_bf16 v[76:79], v[36:39], a[12:15], 0
s_add_u32 m0, s44, 61440
s_add_u32 s45, s48, 884992
v_max_f32 v83, 0, v83
s_waitcnt lgkmcnt(4)
v_mfma_f32_16x16x32_bf16 v[48:51], v[40:43], a[16:19], v[48:51]
ds_read_b64_tr_b16 v[36:37], v9 offset:49152
v_mul_f32 v80, v112, v80
v_mfma_f32_16x16x32_bf16 v[52:55], v[40:43], a[20:23], v[52:55]
ds_read_b64_tr_b16 v[38:39], v9 offset:49408
v_mul_f32 v81, v113, v81
v_mfma_f32_16x16x32_bf16 v[56:59], v[40:43], a[24:27], v[56:59]
buffer_load_dwordx4 v2, s[20:23], s45 offen lds
v_mul_f32 v82, v114, v82
v_mfma_f32_16x16x32_bf16 v[60:63], v[40:43], a[28:31], v[60:63]
v_mul_f32 v83, v115, v83
v_max_f32 v96, 0, v96
s_waitcnt lgkmcnt(4)
v_mfma_f32_16x16x32_bf16 v[64:67], v[44:47], a[16:19], v[64:67]
ds_read_b64_tr_b16 v[40:41], v7 offset:53248
v_max_f32 v97, 0, v97
v_mfma_f32_16x16x32_bf16 v[68:71], v[44:47], a[20:23], v[68:71]
ds_read_b64_tr_b16 v[42:43], v7 offset:53504
v_max_f32 v98, 0, v98
v_mfma_f32_16x16x32_bf16 v[72:75], v[44:47], a[24:27], v[72:75]
v_max_f32 v99, 0, v99
v_mul_f32 v96, v128, v96
v_mfma_f32_16x16x32_bf16 v[76:79], v[44:47], a[28:31], v[76:79]
s_add_u32 m0, s44, 65536
s_add_u32 s45, s48, 1179904
v_mul_f32 v97, v129, v97
s_waitcnt lgkmcnt(4)
v_mfma_f32_16x16x32_bf16 v[48:51], v[32:35], a[32:35], v[48:51]
ds_read_b64_tr_b16 v[44:45], v9 offset:53248
v_mul_f32 v98, v130, v98
v_mfma_f32_16x16x32_bf16 v[52:55], v[32:35], a[36:39], v[52:55]
ds_read_b64_tr_b16 v[46:47], v9 offset:53504
v_mul_f32 v99, v131, v99
v_mfma_f32_16x16x32_bf16 v[56:59], v[32:35], a[40:43], v[56:59]
buffer_load_dwordx4 v2, s[20:23], s45 offen lds
v_cvt_pk_bf16_f32 v112, v80, v81
v_mfma_f32_16x16x32_bf16 v[60:63], v[32:35], a[44:47], v[60:63]
s_add_u32 m0, s44, 69632
s_add_u32 s45, s48, 1474816
v_cvt_pk_bf16_f32 v113, v82, v83
s_waitcnt lgkmcnt(4)
v_mfma_f32_16x16x32_bf16 v[64:67], v[36:39], a[32:35], v[64:67]
ds_read_b64_tr_b16 v[32:33], v7 offset:57344
v_cvt_pk_bf16_f32 v114, v96, v97
v_mfma_f32_16x16x32_bf16 v[68:71], v[36:39], a[36:39], v[68:71]
ds_read_b64_tr_b16 v[34:35], v7 offset:57600
v_cvt_pk_bf16_f32 v115, v98, v99
v_mfma_f32_16x16x32_bf16 v[72:75], v[36:39], a[40:43], v[72:75]
buffer_load_dwordx4 v2, s[20:23], s45 offen lds
ds_write_b128 v30, v[112:115] offset:16384
v_mfma_f32_16x16x32_bf16 v[76:79], v[36:39], a[44:47], v[76:79]
v_max_f32 v84, 0, v84
v_max_f32 v85, 0, v85
s_waitcnt lgkmcnt(5)
v_mfma_f32_16x16x32_bf16 v[48:51], v[40:43], a[48:51], v[48:51]
ds_read_b64_tr_b16 v[36:37], v9 offset:57344
v_max_f32 v86, 0, v86
v_mfma_f32_16x16x32_bf16 v[52:55], v[40:43], a[52:55], v[52:55]
ds_read_b64_tr_b16 v[38:39], v9 offset:57600
v_max_f32 v87, 0, v87
v_mfma_f32_16x16x32_bf16 v[56:59], v[40:43], a[56:59], v[56:59]
v_mul_f32 v84, v116, v84
v_mul_f32 v85, v117, v85
v_mfma_f32_16x16x32_bf16 v[60:63], v[40:43], a[60:63], v[60:63]
v_mul_f32 v86, v118, v86
v_mul_f32 v87, v119, v87
s_waitcnt lgkmcnt(5)
v_mfma_f32_16x16x32_bf16 v[64:67], v[44:47], a[48:51], v[64:67]
ds_read_b64_tr_b16 v[40:41], v7 offset:61440
buffer_load_dword v192, v18, s[40:43], 0 offen sc1
v_mfma_f32_16x16x32_bf16 v[68:71], v[44:47], a[52:55], v[68:71]
ds_read_b64_tr_b16 v[42:43], v7 offset:61696
v_max_f32 v100, 0, v100
v_mfma_f32_16x16x32_bf16 v[72:75], v[44:47], a[56:59], v[72:75]
v_max_f32 v101, 0, v101
v_max_f32 v102, 0, v102
v_mfma_f32_16x16x32_bf16 v[76:79], v[44:47], a[60:63], v[76:79]
v_max_f32 v103, 0, v103
v_mul_f32 v100, v132, v100
s_waitcnt lgkmcnt(5)
v_mfma_f32_16x16x32_bf16 v[48:51], v[32:35], a[64:67], v[48:51]
ds_read_b64_tr_b16 v[44:45], v9 offset:61440
v_mul_f32 v101, v133, v101
v_mfma_f32_16x16x32_bf16 v[52:55], v[32:35], a[68:71], v[52:55]
ds_read_b64_tr_b16 v[46:47], v9 offset:61696
v_mul_f32 v102, v134, v102
v_mfma_f32_16x16x32_bf16 v[56:59], v[32:35], a[72:75], v[56:59]
v_mul_f32 v103, v135, v103
v_cvt_pk_bf16_f32 v116, v84, v85
v_mfma_f32_16x16x32_bf16 v[60:63], v[32:35], a[76:79], v[60:63]
v_cvt_pk_bf16_f32 v117, v86, v87
v_cvt_pk_bf16_f32 v118, v100, v101
s_waitcnt lgkmcnt(4)
v_mfma_f32_16x16x32_bf16 v[64:67], v[36:39], a[64:67], v[64:67]
s_waitcnt vmcnt(16) lgkmcnt(0)
s_barrier
ds_read_b64_tr_b16 v[32:33], v8 offset:0
v_cvt_pk_bf16_f32 v119, v102, v103
v_mfma_f32_16x16x32_bf16 v[68:71], v[36:39], a[68:71], v[68:71]
ds_read_b64_tr_b16 v[34:35], v8 offset:256
ds_write_b128 v30, v[116:119] offset:17408
v_mfma_f32_16x16x32_bf16 v[72:75], v[36:39], a[72:75], v[72:75]
v_max_f32 v88, 0, v88
v_max_f32 v89, 0, v89
v_mfma_f32_16x16x32_bf16 v[76:79], v[36:39], a[76:79], v[76:79]
s_add_u32 m0, s44, 90112
s_add_u32 s45, s48, 1769728
v_max_f32 v90, 0, v90
v_mfma_f32_16x16x32_bf16 v[48:51], v[40:43], a[80:83], v[48:51]
ds_read_b64_tr_b16 v[36:37], v10 offset:0
v_max_f32 v91, 0, v91
v_mfma_f32_16x16x32_bf16 v[52:55], v[40:43], a[84:87], v[52:55]
ds_read_b64_tr_b16 v[38:39], v10 offset:256
v_mul_f32 v88, v120, v88
v_mfma_f32_16x16x32_bf16 v[56:59], v[40:43], a[88:91], v[56:59]
buffer_load_dwordx4 v2, s[20:23], s45 offen lds
v_mul_f32 v89, v121, v89
v_mfma_f32_16x16x32_bf16 v[60:63], v[40:43], a[92:95], v[60:63]
s_add_u32 m0, s44, 94208
s_add_u32 s45, s48, 2064640
v_mul_f32 v90, v122, v90
v_mfma_f32_16x16x32_bf16 v[64:67], v[44:47], a[80:83], v[64:67]
ds_read_b64_tr_b16 v[40:41], v8 offset:4096
v_mul_f32 v91, v123, v91
v_mfma_f32_16x16x32_bf16 v[68:71], v[44:47], a[84:87], v[68:71]
ds_read_b64_tr_b16 v[42:43], v8 offset:4352
v_max_f32 v104, 0, v104
v_mfma_f32_16x16x32_bf16 v[72:75], v[44:47], a[88:91], v[72:75]
buffer_load_dwordx4 v2, s[20:23], s45 offen lds
v_max_f32 v105, 0, v105
v_mfma_f32_16x16x32_bf16 v[76:79], v[44:47], a[92:95], v[76:79]
v_max_f32 v106, 0, v106
v_max_f32 v107, 0, v107
s_waitcnt lgkmcnt(5)
v_mfma_f32_16x16x32_bf16 v[48:51], v[32:35], a[96:99], v[48:51]
ds_read_b64_tr_b16 v[44:45], v10 offset:4096
v_mul_f32 v104, v136, v104
v_mfma_f32_16x16x32_bf16 v[52:55], v[32:35], a[100:103], v[52:55]
ds_read_b64_tr_b16 v[46:47], v10 offset:4352
v_mul_f32 v105, v137, v105
v_mfma_f32_16x16x32_bf16 v[56:59], v[32:35], a[104:107], v[56:59]
v_mul_f32 v106, v138, v106
v_mul_f32 v107, v139, v107
v_mfma_f32_16x16x32_bf16 v[60:63], v[32:35], a[108:111], v[60:63]
s_add_u32 m0, s44, 98304
s_add_u32 s45, s48, 2359552
v_cvt_pk_bf16_f32 v120, v88, v89
s_waitcnt lgkmcnt(4)
v_mfma_f32_16x16x32_bf16 v[64:67], v[36:39], a[96:99], v[64:67]
ds_read_b64_tr_b16 v[32:33], v8 offset:8192
v_cvt_pk_bf16_f32 v121, v90, v91
v_mfma_f32_16x16x32_bf16 v[68:71], v[36:39], a[100:103], v[68:71]
ds_read_b64_tr_b16 v[34:35], v8 offset:8448
v_cvt_pk_bf16_f32 v122, v104, v105
v_mfma_f32_16x16x32_bf16 v[72:75], v[36:39], a[104:107], v[72:75]
buffer_load_dwordx4 v2, s[20:23], s45 offen lds
v_cvt_pk_bf16_f32 v123, v106, v107
v_mfma_f32_16x16x32_bf16 v[76:79], v[36:39], a[108:111], v[76:79]
s_add_u32 m0, s44, 102400
s_add_u32 s45, s48, 2654464
ds_write_b128 v31, v[120:123] offset:16384
s_waitcnt lgkmcnt(5)
v_mfma_f32_16x16x32_bf16 v[48:51], v[40:43], a[112:115], v[48:51]
ds_read_b64_tr_b16 v[36:37], v10 offset:8192
v_max_f32 v92, 0, v92
v_mfma_f32_16x16x32_bf16 v[52:55], v[40:43], a[116:119], v[52:55]
ds_read_b64_tr_b16 v[38:39], v10 offset:8448
v_max_f32 v93, 0, v93
v_mfma_f32_16x16x32_bf16 v[56:59], v[40:43], a[120:123], v[56:59]
buffer_load_dwordx4 v2, s[20:23], s45 offen lds
v_max_f32 v94, 0, v94
v_mfma_f32_16x16x32_bf16 v[60:63], v[40:43], a[124:127], v[60:63]
v_max_f32 v95, 0, v95
v_mul_f32 v92, v124, v92
s_waitcnt lgkmcnt(5)
v_mfma_f32_16x16x32_bf16 v[64:67], v[44:47], a[112:115], v[64:67]
ds_read_b64_tr_b16 v[40:41], v8 offset:12288
v_mul_f32 v93, v125, v93
v_mfma_f32_16x16x32_bf16 v[68:71], v[44:47], a[116:119], v[68:71]
ds_read_b64_tr_b16 v[42:43], v8 offset:12544
v_mul_f32 v94, v126, v94
v_mfma_f32_16x16x32_bf16 v[72:75], v[44:47], a[120:123], v[72:75]
v_mul_f32 v95, v127, v95
v_max_f32 v108, 0, v108
v_mfma_f32_16x16x32_bf16 v[76:79], v[44:47], a[124:127], v[76:79]
s_add_u32 m0, s44, 106496
s_add_u32 s45, s48, 2949376
v_max_f32 v109, 0, v109
s_waitcnt lgkmcnt(5)
v_mfma_f32_16x16x32_bf16 v[48:51], v[32:35], a[128:131], v[48:51]
ds_read_b64_tr_b16 v[44:45], v10 offset:12288
v_max_f32 v110, 0, v110
v_mfma_f32_16x16x32_bf16 v[52:55], v[32:35], a[132:135], v[52:55]
ds_read_b64_tr_b16 v[46:47], v10 offset:12544
v_max_f32 v111, 0, v111
v_mfma_f32_16x16x32_bf16 v[56:59], v[32:35], a[136:139], v[56:59]
buffer_load_dwordx4 v2, s[20:23], s45 offen lds
v_mul_f32 v108, v140, v108
v_mfma_f32_16x16x32_bf16 v[60:63], v[32:35], a[140:143], v[60:63]
s_add_u32 m0, s44, 110592
s_add_u32 s45, s48, 3244288
v_mul_f32 v109, v141, v109
s_waitcnt lgkmcnt(4)
v_mfma_f32_16x16x32_bf16 v[64:67], v[36:39], a[128:131], v[64:67]
ds_read_b64_tr_b16 v[32:33], v8 offset:16384
v_mul_f32 v110, v142, v110
v_mfma_f32_16x16x32_bf16 v[68:71], v[36:39], a[132:135], v[68:71]
ds_read_b64_tr_b16 v[34:35], v8 offset:16640
v_mul_f32 v111, v143, v111
v_mfma_f32_16x16x32_bf16 v[72:75], v[36:39], a[136:139], v[72:75]
buffer_load_dwordx4 v2, s[20:23], s45 offen lds
v_cvt_pk_bf16_f32 v124, v92, v93
v_mfma_f32_16x16x32_bf16 v[76:79], v[36:39], a[140:143], v[76:79]
v_cvt_pk_bf16_f32 v125, v94, v95
v_cvt_pk_bf16_f32 v126, v108, v109
s_waitcnt lgkmcnt(4)
v_mfma_f32_16x16x32_bf16 v[48:51], v[40:43], a[144:147], v[48:51]
ds_read_b64_tr_b16 v[36:37], v10 offset:16384
v_cvt_pk_bf16_f32 v127, v110, v111
v_mfma_f32_16x16x32_bf16 v[52:55], v[40:43], a[148:151], v[52:55]
ds_read_b64_tr_b16 v[38:39], v10 offset:16640
ds_write_b128 v31, v[124:127] offset:17408
v_mfma_f32_16x16x32_bf16 v[56:59], v[40:43], a[152:155], v[56:59]
s_add_u32 s88, s100, 86016
buffer_store_dwordx4 v[252:255], v23, s[36:39], s88 offen sc1
s_add_u32 s88, s100, 90112
buffer_store_dwordx4 v[252:255], v23, s[36:39], s88 offen sc1
v_mfma_f32_16x16x32_bf16 v[60:63], v[40:43], a[156:159], v[60:63]
s_waitcnt lgkmcnt(5)
v_mfma_f32_16x16x32_bf16 v[64:67], v[44:47], a[144:147], v[64:67]
ds_read_b64_tr_b16 v[40:41], v8 offset:20480
v_mfma_f32_16x16x32_bf16 v[68:71], v[44:47], a[148:151], v[68:71]
ds_read_b64_tr_b16 v[42:43], v8 offset:20736
v_mfma_f32_16x16x32_bf16 v[72:75], v[44:47], a[152:155], v[72:75]
v_mfma_f32_16x16x32_bf16 v[76:79], v[44:47], a[156:159], v[76:79]
s_waitcnt lgkmcnt(5)
v_mfma_f32_16x16x32_bf16 v[48:51], v[32:35], a[160:163], v[48:51]
ds_read_b64_tr_b16 v[44:45], v10 offset:20480
s_add_u32 s88, s100, 94208
buffer_store_dwordx4 v[252:255], v23, s[36:39], s88 offen sc1
v_mfma_f32_16x16x32_bf16 v[52:55], v[32:35], a[164:167], v[52:55]
ds_read_b64_tr_b16 v[46:47], v10 offset:20736
v_mfma_f32_16x16x32_bf16 v[56:59], v[32:35], a[168:171], v[56:59]
v_mfma_f32_16x16x32_bf16 v[60:63], v[32:35], a[172:175], v[60:63]
s_waitcnt lgkmcnt(5)
v_mfma_f32_16x16x32_bf16 v[64:67], v[36:39], a[160:163], v[64:67]
s_waitcnt vmcnt(17) lgkmcnt(0)
s_barrier
ds_read_b64_tr_b16 v[32:33], v8 offset:24576
v_mfma_f32_16x16x32_bf16 v[68:71], v[36:39], a[164:167], v[68:71]
ds_read_b64_tr_b16 v[34:35], v8 offset:24832
v_mfma_f32_16x16x32_bf16 v[72:75], v[36:39], a[168:171], v[72:75]
v_mfma_f32_16x16x32_bf16 v[76:79], v[36:39], a[172:175], v[76:79]
s_add_u32 m0, s44, 114688
s_add_u32 s45, s48, 3539200
v_mfma_f32_16x16x32_bf16 v[48:51], v[40:43], a[176:179], v[48:51]
ds_read_b64_tr_b16 v[36:37], v10 offset:24576
v_mfma_f32_16x16x32_bf16 v[52:55], v[40:43], a[180:183], v[52:55]
ds_read_b64_tr_b16 v[38:39], v10 offset:24832
v_mfma_f32_16x16x32_bf16 v[56:59], v[40:43], a[184:187], v[56:59]
buffer_load_dwordx4 v2, s[20:23], s45 offen lds
v_mfma_f32_16x16x32_bf16 v[60:63], v[40:43], a[188:191], v[60:63]
s_add_u32 m0, s44, 118784
s_add_u32 s45, s48, 3834112
v_mfma_f32_16x16x32_bf16 v[64:67], v[44:47], a[176:179], v[64:67]
ds_read_b64_tr_b16 v[40:41], v8 offset:28672
v_mfma_f32_16x16x32_bf16 v[68:71], v[44:47], a[180:183], v[68:71]
ds_read_b64_tr_b16 v[42:43], v8 offset:28928
v_mfma_f32_16x16x32_bf16 v[72:75], v[44:47], a[184:187], v[72:75]
buffer_load_dwordx4 v2, s[20:23], s45 offen lds
v_mfma_f32_16x16x32_bf16 v[76:79], v[44:47], a[188:191], v[76:79]
s_waitcnt lgkmcnt(4)
v_mfma_f32_16x16x32_bf16 v[48:51], v[32:35], a[192:195], v[48:51]
ds_read_b64_tr_b16 v[44:45], v10 offset:28672
v_mfma_f32_16x16x32_bf16 v[52:55], v[32:35], a[196:199], v[52:55]
ds_read_b64_tr_b16 v[46:47], v10 offset:28928
v_mfma_f32_16x16x32_bf16 v[56:59], v[32:35], a[200:203], v[56:59]
v_mfma_f32_16x16x32_bf16 v[60:63], v[32:35], a[204:207], v[60:63]
s_add_u32 m0, s44, 122880
s_add_u32 s45, s48, 4129024
s_waitcnt lgkmcnt(4)
v_mfma_f32_16x16x32_bf16 v[64:67], v[36:39], a[192:195], v[64:67]
ds_read_b64_tr_b16 v[32:33], v8 offset:32768
v_mfma_f32_16x16x32_bf16 v[68:71], v[36:39], a[196:199], v[68:71]
ds_read_b64_tr_b16 v[34:35], v8 offset:33024
v_mfma_f32_16x16x32_bf16 v[72:75], v[36:39], a[200:203], v[72:75]
buffer_load_dwordx4 v2, s[20:23], s45 offen lds
v_mfma_f32_16x16x32_bf16 v[76:79], v[36:39], a[204:207], v[76:79]
s_add_u32 m0, s44, 126976
s_add_u32 s45, s48, 4423936
s_waitcnt lgkmcnt(4)
v_mfma_f32_16x16x32_bf16 v[48:51], v[40:43], a[208:211], v[48:51]
ds_read_b64_tr_b16 v[36:37], v10 offset:32768
v_mfma_f32_16x16x32_bf16 v[52:55], v[40:43], a[212:215], v[52:55]
ds_read_b64_tr_b16 v[38:39], v10 offset:33024
v_mfma_f32_16x16x32_bf16 v[56:59], v[40:43], a[216:219], v[56:59]
buffer_load_dwordx4 v2, s[20:23], s45 offen lds
v_mfma_f32_16x16x32_bf16 v[60:63], v[40:43], a[220:223], v[60:63]
s_waitcnt lgkmcnt(4)
v_mfma_f32_16x16x32_bf16 v[64:67], v[44:47], a[208:211], v[64:67]
ds_read_b64_tr_b16 v[40:41], v8 offset:36864
s_add_u32 s88, s100, 98304
buffer_store_dwordx4 v[252:255], v23, s[36:39], s88 offen sc1
v_mfma_f32_16x16x32_bf16 v[68:71], v[44:47], a[212:215], v[68:71]
ds_read_b64_tr_b16 v[42:43], v8 offset:37120
v_mfma_f32_16x16x32_bf16 v[72:75], v[44:47], a[216:219], v[72:75]
v_mfma_f32_16x16x32_bf16 v[76:79], v[44:47], a[220:223], v[76:79]
s_add_u32 m0, s44, 131072
s_add_u32 s45, s48, 4718848
s_waitcnt lgkmcnt(4)
v_mfma_f32_16x16x32_bf16 v[48:51], v[32:35], a[224:227], v[48:51]
ds_read_b64_tr_b16 v[44:45], v10 offset:36864
v_mfma_f32_16x16x32_bf16 v[52:55], v[32:35], a[228:231], v[52:55]
ds_read_b64_tr_b16 v[46:47], v10 offset:37120
v_mfma_f32_16x16x32_bf16 v[56:59], v[32:35], a[232:235], v[56:59]
buffer_load_dwordx4 v2, s[20:23], s45 offen lds
v_mfma_f32_16x16x32_bf16 v[60:63], v[32:35], a[236:239], v[60:63]
s_add_u32 m0, s44, 135168
s_add_u32 s45, s48, 5013760
s_waitcnt lgkmcnt(4)
v_mfma_f32_16x16x32_bf16 v[64:67], v[36:39], a[224:227], v[64:67]
ds_read_b64_tr_b16 v[32:33], v8 offset:40960
v_mfma_f32_16x16x32_bf16 v[68:71], v[36:39], a[228:231], v[68:71]
ds_read_b64_tr_b16 v[34:35], v8 offset:41216
v_mfma_f32_16x16x32_bf16 v[72:75], v[36:39], a[232:235], v[72:75]
buffer_load_dwordx4 v2, s[20:23], s45 offen lds
v_mfma_f32_16x16x32_bf16 v[76:79], v[36:39], a[236:239], v[76:79]
s_waitcnt lgkmcnt(4)
v_mfma_f32_16x16x32_bf16 v[48:51], v[40:43], a[240:243], v[48:51]
ds_read_b64_tr_b16 v[36:37], v10 offset:40960
s_waitcnt vmcnt(16)
v_and_b32 v192, 0x0f, v192
v_cmp_ne_u32 vcc, s71, v192
s_cbranch_vccnz L1_spin
L1_back:
v_mfma_f32_16x16x32_bf16 v[52:55], v[40:43], a[244:247], v[52:55]
ds_read_b64_tr_b16 v[38:39], v10 offset:41216
v_mfma_f32_16x16x32_bf16 v[56:59], v[40:43], a[248:251], v[56:59]
v_mfma_f32_16x16x32_bf16 v[60:63], v[40:43], a[252:255], v[60:63]
s_waitcnt lgkmcnt(4)
v_mfma_f32_16x16x32_bf16 v[64:67], v[44:47], a[240:243], v[64:67]
ds_read_b64_tr_b16 v[40:41], v8 offset:45056
v_mfma_f32_16x16x32_bf16 v[68:71], v[44:47], a[244:247], v[68:71]
ds_read_b64_tr_b16 v[42:43], v8 offset:45312
v_mfma_f32_16x16x32_bf16 v[72:75], v[44:47], a[248:251], v[72:75]
v_mfma_f32_16x16x32_bf16 v[76:79], v[44:47], a[252:255], v[76:79]
s_waitcnt lgkmcnt(4)
v_mfma_f32_16x16x32_bf16 v[48:51], v[32:35], v[144:147], v[48:51]
ds_read_b64_tr_b16 v[44:45], v10 offset:45056
v_mfma_f32_16x16x32_bf16 v[52:55], v[32:35], v[148:151], v[52:55]
ds_read_b64_tr_b16 v[46:47], v10 offset:45312
v_mfma_f32_16x16x32_bf16 v[56:59], v[32:35], v[152:155], v[56:59]
v_mfma_f32_16x16x32_bf16 v[60:63], v[32:35], v[156:159], v[60:63]
s_waitcnt lgkmcnt(4)
v_mfma_f32_16x16x32_bf16 v[64:67], v[36:39], v[144:147], v[64:67]
s_waitcnt lgkmcnt(0)
s_barrier
ds_read_b64_tr_b16 v[32:33], v7 offset:0
v_mfma_f32_16x16x32_bf16 v[68:71], v[36:39], v[148:151], v[68:71]
ds_read_b64_tr_b16 v[34:35], v7 offset:256
v_mfma_f32_16x16x32_bf16 v[72:75], v[36:39], v[152:155], v[72:75]
v_mfma_f32_16x16x32_bf16 v[76:79], v[36:39], v[156:159], v[76:79]
s_add_u32 m0, s44, 139264
s_add_u32 s45, s48, 384
v_mfma_f32_16x16x32_bf16 v[48:51], v[40:43], v[160:163], v[48:51]
ds_read_b64_tr_b16 v[36:37], v9 offset:0
s_add_u32 s88, s55, 0
buffer_load_dword v192, v26, s[36:39], s88 offen sc1
v_mfma_f32_16x16x32_bf16 v[52:55], v[40:43], v[164:167], v[52:55]
ds_read_b64_tr_b16 v[38:39], v9 offset:256
s_add_u32 s88, s55, 16384
buffer_load_dword v193, v26, s[36:39], s88 offen sc1
v_mfma_f32_16x16x32_bf16 v[56:59], v[40:43], v[168:171], v[56:59]
buffer_load_dwordx4 v2, s[16:19], s45 offen lds
s_add_u32 s88, s55, 32768
buffer_load_dword v194, v26, s[36:39], s88 offen sc1
v_mfma_f32_16x16x32_bf16 v[60:63], v[40:43], v[172:175], v[60:63]
s_add_u32 m0, s44, 143360
s_add_u32 s45, s48, 295296
s_add_u32 s88, s55, 49152
buffer_load_dword v195, v26, s[36:39], s88 offen sc1
v_mfma_f32_16x16x32_bf16 v[64:67], v[44:47], v[160:163], v[64:67]
ds_read_b64_tr_b16 v[40:41], v7 offset:4096
s_add_u32 s88, s100, 102400
buffer_store_dwordx4 v[252:255], v23, s[36:39], s88 offen sc1
v_mfma_f32_16x16x32_bf16 v[68:71], v[44:47], v[164:167], v[68:71]
ds_read_b64_tr_b16 v[42:43], v7 offset:4352
v_mfma_f32_16x16x32_bf16 v[72:75], v[44:47], v[168:171], v[72:75]
buffer_load_dwordx4 v2, s[16:19], s45 offen lds
v_mfma_f32_16x16x32_bf16 v[76:79], v[44:47], v[172:175], v[76:79]
s_waitcnt lgkmcnt(4)
v_mfma_f32_16x16x32_bf16 v[80:83], v[32:35], a[0:3], 0
ds_read_b64_tr_b16 v[44:45], v9 offset:4096
v_mfma_f32_16x16x32_bf16 v[84:87], v[32:35], a[4:7], 0
ds_read_b64_tr_b16 v[46:47], v9 offset:4352
v_mfma_f32_16x16x32_bf16 v[88:91], v[32:35], a[8:11], 0
v_mfma_f32_16x16x32_bf16 v[92:95], v[32:35], a[12:15], 0
s_add_u32 m0, s44, 147456
s_add_u32 s45, s48, 590208
s_waitcnt lgkmcnt(4)
v_mfma_f32_16x16x32_bf16 v[96:99], v[36:39], a[0:3], 0
ds_read_b64_tr_b16 v[32:33], v7 offset:8192
v_mfma_f32_16x16x32_bf16 v[100:103], v[36:39], a[4:7], 0
ds_read_b64_tr_b16 v[34:35], v7 offset:8448
v_mfma_f32_16x16x32_bf16 v[104:107], v[36:39], a[8:11], 0
buffer_load_dwordx4 v2, s[16:19], s45 offen lds
v_mfma_f32_16x16x32_bf16 v[108:111], v[36:39], a[12:15], 0
s_add_u32 m0, s44, 151552
s_add_u32 s45, s48, 885120
s_waitcnt lgkmcnt(4)
v_mfma_f32_16x16x32_bf16 v[80:83], v[40:43], a[16:19], v[80:83]
ds_read_b64_tr_b16 v[36:37], v9 offset:8192
v_mfma_f32_16x16x32_bf16 v[84:87], v[40:43], a[20:23], v[84:87]
ds_read_b64_tr_b16 v[38:39], v9 offset:8448
v_mfma_f32_16x16x32_bf16 v[88:91], v[40:43], a[24:27], v[88:91]
buffer_load_dwordx4 v2, s[16:19], s45 offen lds
v_mfma_f32_16x16x32_bf16 v[92:95], v[40:43], a[28:31], v[92:95]
s_waitcnt lgkmcnt(4)
v_mfma_f32_16x16x32_bf16 v[96:99], v[44:47], a[16:19], v[96:99]
ds_read_b64_tr_b16 v[40:41], v7 offset:12288
v_mfma_f32_16x16x32_bf16 v[100:103], v[44:47], a[20:23], v[100:103]
ds_read_b64_tr_b16 v[42:43], v7 offset:12544
v_mfma_f32_16x16x32_bf16 v[104:107], v[44:47], a[24:27], v[104:107]
v_mfma_f32_16x16x32_bf16 v[108:111], v[44:47], a[28:31], v[108:111]
s_add_u32 m0, s44, 155648
s_add_u32 s45, s48, 1180032
s_waitcnt lgkmcnt(4)
v_mfma_f32_16x16x32_bf16 v[80:83], v[32:35], a[32:35], v[80:83]
ds_read_b64_tr_b16 v[44:45], v9 offset:12288
v_mfma_f32_16x16x32_bf16 v[84:87], v[32:35], a[36:39], v[84:87]
ds_read_b64_tr_b16 v[46:47], v9 offset:12544
v_mfma_f32_16x16x32_bf16 v[88:91], v[32:35], a[40:43], v[88:91]
buffer_load_dwordx4 v2, s[16:19], s45 offen lds
v_mfma_f32_16x16x32_bf16 v[92:95], v[32:35], a[44:47], v[92:95]
s_add_u32 m0, s44, 159744
s_add_u32 s45, s48, 1474944
s_waitcnt lgkmcnt(4)
v_mfma_f32_16x16x32_bf16 v[96:99], v[36:39], a[32:35], v[96:99]
ds_read_b64_tr_b16 v[32:33], v7 offset:16384
v_mfma_f32_16x16x32_bf16 v[100:103], v[36:39], a[36:39], v[100:103]
ds_read_b64_tr_b16 v[34:35], v7 offset:16640
v_mfma_f32_16x16x32_bf16 v[104:107], v[36:39], a[40:43], v[104:107]
buffer_load_dwordx4 v2, s[16:19], s45 offen lds
v_mfma_f32_16x16x32_bf16 v[108:111], v[36:39], a[44:47], v[108:111]
s_waitcnt lgkmcnt(4)
v_mfma_f32_16x16x32_bf16 v[80:83], v[40:43], a[48:51], v[80:83]
ds_read_b64_tr_b16 v[36:37], v9 offset:16384
s_add_u32 s88, s100, 106496
buffer_store_dwordx4 v[252:255], v23, s[36:39], s88 offen sc1
v_mfma_f32_16x16x32_bf16 v[84:87], v[40:43], a[52:55], v[84:87]
ds_read_b64_tr_b16 v[38:39], v9 offset:16640
v_mfma_f32_16x16x32_bf16 v[88:91], v[40:43], a[56:59], v[88:91]
v_mfma_f32_16x16x32_bf16 v[92:95], v[40:43], a[60:63], v[92:95]
s_waitcnt lgkmcnt(4)
v_mfma_f32_16x16x32_bf16 v[96:99], v[44:47], a[48:51], v[96:99]
ds_read_b64_tr_b16 v[40:41], v7 offset:20480
v_mfma_f32_16x16x32_bf16 v[100:103], v[44:47], a[52:55], v[100:103]
ds_read_b64_tr_b16 v[42:43], v7 offset:20736
v_mfma_f32_16x16x32_bf16 v[104:107], v[44:47], a[56:59], v[104:107]
v_mfma_f32_16x16x32_bf16 v[108:111], v[44:47], a[60:63], v[108:111]
s_waitcnt lgkmcnt(4)
v_mfma_f32_16x16x32_bf16 v[80:83], v[32:35], a[64:67], v[80:83]
ds_read_b64_tr_b16 v[44:45], v9 offset:20480
v_mfma_f32_16x16x32_bf16 v[84:87], v[32:35], a[68:71], v[84:87]
ds_read_b64_tr_b16 v[46:47], v9 offset:20736
v_mfma_f32_16x16x32_bf16 v[88:91], v[32:35], a[72:75], v[88:91]
v_mfma_f32_16x16x32_bf16 v[92:95], v[32:35], a[76:79], v[92:95]
s_waitcnt lgkmcnt(4)
v_mfma_f32_16x16x32_bf16 v[96:99], v[36:39], a[64:67], v[96:99]
s_waitcnt vmcnt(22) lgkmcnt(0)
s_barrier
ds_read_b64_tr_b16 v[32:33], v7 offset:40960
v_mfma_f32_16x16x32_bf16 v[100:103], v[36:39], a[68:71], v[100:103]
ds_read_b64_tr_b16 v[34:35], v7 offset:41216
v_mfma_f32_16x16x32_bf16 v[104:107], v[36:39], a[72:75], v[104:107]
v_mfma_f32_16x16x32_bf16 v[108:111], v[36:39], a[76:79], v[108:111]
s_add_u32 m0, s44, 49152
s_add_u32 s45, s48, 1769856
v_mfma_f32_16x16x32_bf16 v[80:83], v[40:43], a[80:83], v[80:83]
ds_read_b64_tr_b16 v[36:37], v9 offset:40960
v_mfma_f32_16x16x32_bf16 v[84:87], v[40:43], a[84:87], v[84:87]
ds_read_b64_tr_b16 v[38:39], v9 offset:41216
v_mfma_f32_16x16x32_bf16 v[88:91], v[40:43], a[88:91], v[88:91]
buffer_load_dwordx4 v2, s[16:19], s45 offen lds
v_mfma_f32_16x16x32_bf16 v[92:95], v[40:43], a[92:95], v[92:95]
s_add_u32 m0, s44, 53248
s_add_u32 s45, s48, 2064768
v_mfma_f32_16x16x32_bf16 v[96:99], v[44:47], a[80:83], v[96:99]
ds_read_b64_tr_b16 v[40:41], v7 offset:45056
v_mfma_f32_16x16x32_bf16 v[100:103], v[44:47], a[84:87], v[100:103]
ds_read_b64_tr_b16 v[42:43], v7 offset:45312
v_mfma_f32_16x16x32_bf16 v[104:107], v[44:47], a[88:91], v[104:107]
buffer_load_dwordx4 v2, s[16:19], s45 offen lds
v_mfma_f32_16x16x32_bf16 v[108:111], v[44:47], a[92:95], v[108:111]
s_waitcnt lgkmcnt(4)
v_mfma_f32_16x16x32_bf16 v[80:83], v[32:35], a[96:99], v[80:83]
ds_read_b64_tr_b16 v[44:45], v9 offset:45056
v_mfma_f32_16x16x32_bf16 v[84:87], v[32:35], a[100:103], v[84:87]
ds_read_b64_tr_b16 v[46:47], v9 offset:45312
v_mfma_f32_16x16x32_bf16 v[88:91], v[32:35], a[104:107], v[88:91]
v_mfma_f32_16x16x32_bf16 v[92:95], v[32:35], a[108:111], v[92:95]
s_add_u32 m0, s44, 57344
s_add_u32 s45, s48, 2359680
s_waitcnt lgkmcnt(4)
v_mfma_f32_16x16x32_bf16 v[96:99], v[36:39], a[96:99], v[96:99]
ds_read_b64_tr_b16 v[32:33], v7 offset:49152
s_add_u32 s88, s100, 110592
buffer_store_dwordx4 v[252:255], v23, s[36:39], s88 offen sc1
v_mfma_f32_16x16x32_bf16 v[100:103], v[36:39], a[100:103], v[100:103]
ds_read_b64_tr_b16 v[34:35], v7 offset:49408
v_mfma_f32_16x16x32_bf16 v[104:107], v[36:39], a[104:107], v[104:107]
buffer_load_dwordx4 v2, s[16:19], s45 offen lds
v_mfma_f32_16x16x32_bf16 v[108:111], v[36:39], a[108:111], v[108:111]
s_add_u32 m0, s44, 61440
s_add_u32 s45, s48, 2654592
s_waitcnt lgkmcnt(4)
v_mfma_f32_16x16x32_bf16 v[80:83], v[40:43], a[112:115], v[80:83]
ds_read_b64_tr_b16 v[36:37], v9 offset:49152
v_mfma_f32_16x16x32_bf16 v[84:87], v[40:43], a[116:119], v[84:87]
ds_read_b64_tr_b16 v[38:39], v9 offset:49408
v_mfma_f32_16x16x32_bf16 v[88:91], v[40:43], a[120:123], v[88:91]
buffer_load_dwordx4 v2, s[16:19], s45 offen lds
v_mfma_f32_16x16x32_bf16 v[92:95], v[40:43], a[124:127], v[92:95]
s_waitcnt lgkmcnt(4)
v_mfma_f32_16x16x32_bf16 v[96:99], v[44:47], a[112:115], v[96:99]
ds_read_b64_tr_b16 v[40:41], v7 offset:53248
v_mfma_f32_16x16x32_bf16 v[100:103], v[44:47], a[116:119], v[100:103]
ds_read_b64_tr_b16 v[42:43], v7 offset:53504
v_mfma_f32_16x16x32_bf16 v[104:107], v[44:47], a[120:123], v[104:107]
v_mfma_f32_16x16x32_bf16 v[108:111], v[44:47], a[124:127], v[108:111]
s_add_u32 m0, s44, 65536
s_add_u32 s45, s48, 2949504
s_waitcnt lgkmcnt(4)
v_mfma_f32_16x16x32_bf16 v[80:83], v[32:35], a[128:131], v[80:83]
ds_read_b64_tr_b16 v[44:45], v9 offset:53248
v_mfma_f32_16x16x32_bf16 v[84:87], v[32:35], a[132:135], v[84:87]
ds_read_b64_tr_b16 v[46:47], v9 offset:53504
v_mfma_f32_16x16x32_bf16 v[88:91], v[32:35], a[136:139], v[88:91]
buffer_load_dwordx4 v2, s[16:19], s45 offen lds
v_mfma_f32_16x16x32_bf16 v[92:95], v[32:35], a[140:143], v[92:95]
s_add_u32 m0, s44, 69632
s_add_u32 s45, s48, 3244416
s_waitcnt lgkmcnt(4)
v_mfma_f32_16x16x32_bf16 v[96:99], v[36:39], a[128:131], v[96:99]
ds_read_b64_tr_b16 v[32:33], v7 offset:57344
v_mfma_f32_16x16x32_bf16 v[100:103], v[36:39], a[132:135], v[100:103]
ds_read_b64_tr_b16 v[34:35], v7 offset:57600
v_mfma_f32_16x16x32_bf16 v[104:107], v[36:39], a[136:139], v[104:107]
buffer_load_dwordx4 v2, s[16:19], s45 offen lds
v_mfma_f32_16x16x32_bf16 v[108:111], v[36:39], a[140:143], v[108:111]
s_waitcnt lgkmcnt(4)
v_mfma_f32_16x16x32_bf16 v[80:83], v[40:43], a[144:147], v[80:83]
ds_read_b64_tr_b16 v[36:37], v9 offset:57344
v_mfma_f32_16x16x32_bf16 v[84:87], v[40:43], a[148:151], v[84:87]
ds_read_b64_tr_b16 v[38:39], v9 offset:57600
v_mfma_f32_16x16x32_bf16 v[88:91], v[40:43], a[152:155], v[88:91]
v_mfma_f32_16x16x32_bf16 v[92:95], v[40:43], a[156:159], v[92:95]
s_waitcnt lgkmcnt(4)
v_mfma_f32_16x16x32_bf16 v[96:99], v[44:47], a[144:147], v[96:99]
ds_read_b64_tr_b16 v[40:41], v7 offset:61440
v_mfma_f32_16x16x32_bf16 v[100:103], v[44:47], a[148:151], v[100:103]
ds_read_b64_tr_b16 v[42:43], v7 offset:61696
v_mfma_f32_16x16x32_bf16 v[104:107], v[44:47], a[152:155], v[104:107]
v_mfma_f32_16x16x32_bf16 v[108:111], v[44:47], a[156:159], v[108:111]
s_waitcnt lgkmcnt(4)
v_mfma_f32_16x16x32_bf16 v[80:83], v[32:35], a[160:163], v[80:83]
ds_read_b64_tr_b16 v[44:45], v9 offset:61440
s_add_u32 s88, s100, 114688
buffer_store_dwordx4 v[252:255], v23, s[36:39], s88 offen sc1
v_mfma_f32_16x16x32_bf16 v[84:87], v[32:35], a[164:167], v[84:87]
ds_read_b64_tr_b16 v[46:47], v9 offset:61696
v_mfma_f32_16x16x32_bf16 v[88:91], v[32:35], a[168:171], v[88:91]
v_mfma_f32_16x16x32_bf16 v[92:95], v[32:35], a[172:175], v[92:95]
s_waitcnt lgkmcnt(4)
v_mfma_f32_16x16x32_bf16 v[96:99], v[36:39], a[160:163], v[96:99]
s_waitcnt vmcnt(20) lgkmcnt(0)
s_barrier
ds_read_b64_tr_b16 v[32:33], v8 offset:0
v_mfma_f32_16x16x32_bf16 v[100:103], v[36:39], a[164:167], v[100:103]
ds_read_b64_tr_b16 v[34:35], v8 offset:256
v_mfma_f32_16x16x32_bf16 v[104:107], v[36:39], a[168:171], v[104:107]
v_mfma_f32_16x16x32_bf16 v[108:111], v[36:39], a[172:175], v[108:111]
s_add_u32 m0, s44, 90112
s_add_u32 s45, s48, 3539328
v_mfma_f32_16x16x32_bf16 v[80:83], v[40:43], a[176:179], v[80:83]
ds_read_b64_tr_b16 v[36:37], v10 offset:0
s_waitcnt vmcnt(18)
v_add_f32 v192, v192, v193
v_mfma_f32_16x16x32_bf16 v[84:87], v[40:43], a[180:183], v[84:87]
ds_read_b64_tr_b16 v[38:39], v10 offset:256
s_waitcnt vmcnt(15)
v_add_f32 v194, v194, v195
v_mfma_f32_16x16x32_bf16 v[88:91], v[40:43], a[184:187], v[88:91]
buffer_load_dwordx4 v2, s[16:19], s45 offen lds
v_add_f32 v192, v192, v194
v_mfma_f32_16x16x32_bf16 v[92:95], v[40:43], a[188:191], v[92:95]
s_add_u32 m0, s44, 94208
s_add_u32 s45, s48, 3834240
v_mov_b32 v193, v192
v_mfma_f32_16x16x32_bf16 v[96:99], v[44:47], a[176:179], v[96:99]
ds_read_b64_tr_b16 v[40:41], v8 offset:4096
v_mfma_f32_16x16x32_bf16 v[100:103], v[44:47], a[180:183], v[100:103]
ds_read_b64_tr_b16 v[42:43], v8 offset:4352
v_mfma_f32_16x16x32_bf16 v[104:107], v[44:47], a[184:187], v[104:107]
buffer_load_dwordx4 v2, s[16:19], s45 offen lds
v_permlane16_swap_b32 v192, v193
v_mfma_f32_16x16x32_bf16 v[108:111], v[44:47], a[188:191], v[108:111]
v_add_f32 v192, v192, v193
s_waitcnt lgkmcnt(4)
v_mfma_f32_16x16x32_bf16 v[80:83], v[32:35], a[192:195], v[80:83]
ds_read_b64_tr_b16 v[44:45], v10 offset:4096
v_mov_b32 v193, v192
v_mfma_f32_16x16x32_bf16 v[84:87], v[32:35], a[196:199], v[84:87]
ds_read_b64_tr_b16 v[46:47], v10 offset:4352
v_mfma_f32_16x16x32_bf16 v[88:91], v[32:35], a[200:203], v[88:91]
v_permlane32_swap_b32 v192, v193
v_mfma_f32_16x16x32_bf16 v[92:95], v[32:35], a[204:207], v[92:95]
s_add_u32 m0, s44, 98304
s_add_u32 s45, s48, 4129152
s_waitcnt lgkmcnt(4)
v_mfma_f32_16x16x32_bf16 v[96:99], v[36:39], a[192:195], v[96:99]
ds_read_b64_tr_b16 v[32:33], v8 offset:8192
v_add_f32 v192, v192, v193
v_mfma_f32_16x16x32_bf16 v[100:103], v[36:39], a[196:199], v[100:103]
ds_read_b64_tr_b16 v[34:35], v8 offset:8448
v_min_u32 v192, -2, v192
v_mfma_f32_16x16x32_bf16 v[104:107], v[36:39], a[200:203], v[104:107]
buffer_load_dwordx4 v2, s[16:19], s45 offen lds
s_mov_b64 exec, 0xffff
buffer_store_dword v192, v26, s[36:39], s101 offen sc1
s_mov_b64 exec, -1
v_mfma_f32_16x16x32_bf16 v[108:111], v[36:39], a[204:207], v[108:111]
s_add_u32 m0, s44, 102400
s_add_u32 s45, s48, 4424064
s_waitcnt lgkmcnt(4)
v_mfma_f32_16x16x32_bf16 v[80:83], v[40:43], a[208:211], v[80:83]
ds_read_b64_tr_b16 v[36:37], v10 offset:8192
v_mfma_f32_16x16x32_bf16 v[84:87], v[40:43], a[212:215], v[84:87]
ds_read_b64_tr_b16 v[38:39], v10 offset:8448
v_mfma_f32_16x16x32_bf16 v[88:91], v[40:43], a[216:219], v[88:91]
buffer_load_dwordx4 v2, s[16:19], s45 offen lds
v_mfma_f32_16x16x32_bf16 v[92:95], v[40:43], a[220:223], v[92:95]
s_waitcnt lgkmcnt(4)
v_mfma_f32_16x16x32_bf16 v[96:99], v[44:47], a[208:211], v[96:99]
ds_read_b64_tr_b16 v[40:41], v8 offset:12288
s_add_u32 s88, s100, 118784
buffer_store_dwordx4 v[252:255], v23, s[36:39], s88 offen sc1
v_mfma_f32_16x16x32_bf16 v[100:103], v[44:47], a[212:215], v[100:103]
ds_read_b64_tr_b16 v[42:43], v8 offset:12544
v_mfma_f32_16x16x32_bf16 v[104:107], v[44:47], a[216:219], v[104:107]
v_mfma_f32_16x16x32_bf16 v[108:111], v[44:47], a[220:223], v[108:111]
s_add_u32 m0, s44, 106496
s_add_u32 s45, s48, 4718976
s_waitcnt lgkmcnt(4)
v_mfma_f32_16x16x32_bf16 v[80:83], v[32:35], a[224:227], v[80:83]
ds_read_b64_tr_b16 v[44:45], v10 offset:12288
v_mfma_f32_16x16x32_bf16 v[84:87], v[32:35], a[228:231], v[84:87]
ds_read_b64_tr_b16 v[46:47], v10 offset:12544
v_mfma_f32_16x16x32_bf16 v[88:91], v[32:35], a[232:235], v[88:91]
buffer_load_dwordx4 v2, s[16:19], s45 offen lds
v_mfma_f32_16x16x32_bf16 v[92:95], v[32:35], a[236:239], v[92:95]
s_add_u32 m0, s44, 110592
s_add_u32 s45, s48, 5013888
s_waitcnt lgkmcnt(4)
v_mfma_f32_16x16x32_bf16 v[96:99], v[36:39], a[224:227], v[96:99]
ds_read_b64_tr_b16 v[32:33], v8 offset:16384
v_mfma_f32_16x16x32_bf16 v[100:103], v[36:39], a[228:231], v[100:103]
ds_read_b64_tr_b16 v[34:35], v8 offset:16640
v_mfma_f32_16x16x32_bf16 v[104:107], v[36:39], a[232:235], v[104:107]
buffer_load_dwordx4 v2, s[16:19], s45 offen lds
v_mfma_f32_16x16x32_bf16 v[108:111], v[36:39], a[236:239], v[108:111]
s_waitcnt lgkmcnt(4)
v_mfma_f32_16x16x32_bf16 v[80:83], v[40:43], a[240:243], v[80:83]
ds_read_b64_tr_b16 v[36:37], v10 offset:16384
v_mfma_f32_16x16x32_bf16 v[84:87], v[40:43], a[244:247], v[84:87]
ds_read_b64_tr_b16 v[38:39], v10 offset:16640
v_mfma_f32_16x16x32_bf16 v[88:91], v[40:43], a[248:251], v[88:91]
v_mfma_f32_16x16x32_bf16 v[92:95], v[40:43], a[252:255], v[92:95]
s_waitcnt lgkmcnt(4)
v_mfma_f32_16x16x32_bf16 v[96:99], v[44:47], a[240:243], v[96:99]
ds_read_b64_tr_b16 v[40:41], v8 offset:20480
v_mfma_f32_16x16x32_bf16 v[100:103], v[44:47], a[244:247], v[100:103]
ds_read_b64_tr_b16 v[42:43], v8 offset:20736
v_mfma_f32_16x16x32_bf16 v[104:107], v[44:47], a[248:251], v[104:107]
v_mfma_f32_16x16x32_bf16 v[108:111], v[44:47], a[252:255], v[108:111]
s_waitcnt lgkmcnt(4)
v_mfma_f32_16x16x32_bf16 v[80:83], v[32:35], v[144:147], v[80:83]
ds_read_b64_tr_b16 v[44:45], v10 offset:20480
v_mfma_f32_16x16x32_bf16 v[84:87], v[32:35], v[148:151], v[84:87]
ds_read_b64_tr_b16 v[46:47], v10 offset:20736
v_mfma_f32_16x16x32_bf16 v[88:91], v[32:35], v[152:155], v[88:91]
v_mfma_f32_16x16x32_bf16 v[92:95], v[32:35], v[156:159], v[92:95]
s_waitcnt lgkmcnt(4)
v_mfma_f32_16x16x32_bf16 v[96:99], v[36:39], v[144:147], v[96:99]
s_waitcnt vmcnt(17) lgkmcnt(0)
s_barrier
ds_read_b64_tr_b16 v[32:33], v8 offset:24576
v_mfma_f32_16x16x32_bf16 v[100:103], v[36:39], v[148:151], v[100:103]
ds_read_b64_tr_b16 v[34:35], v8 offset:24832
v_mfma_f32_16x16x32_bf16 v[104:107], v[36:39], v[152:155], v[104:107]
v_mfma_f32_16x16x32_bf16 v[108:111], v[36:39], v[156:159], v[108:111]
s_add_u32 m0, s44, 114688
s_add_u32 s45, s48, 384
v_mfma_f32_16x16x32_bf16 v[80:83], v[40:43], v[160:163], v[80:83]
ds_read_b64_tr_b16 v[36:37], v10 offset:24576
s_add_u32 s88, s100, 122880
buffer_store_dwordx4 v[252:255], v23, s[36:39], s88 offen sc1
v_mfma_f32_16x16x32_bf16 v[84:87], v[40:43], v[164:167], v[84:87]
ds_read_b64_tr_b16 v[38:39], v10 offset:24832
v_mfma_f32_16x16x32_bf16 v[88:91], v[40:43], v[168:171], v[88:91]
buffer_load_dwordx4 v2, s[20:23], s45 offen lds
v_mfma_f32_16x16x32_bf16 v[92:95], v[40:43], v[172:175], v[92:95]
s_add_u32 m0, s44, 118784
s_add_u32 s45, s48, 295296
v_mfma_f32_16x16x32_bf16 v[96:99], v[44:47], v[160:163], v[96:99]
ds_read_b64_tr_b16 v[40:41], v8 offset:28672
v_mfma_f32_16x16x32_bf16 v[100:103], v[44:47], v[164:167], v[100:103]
ds_read_b64_tr_b16 v[42:43], v8 offset:28928
v_mfma_f32_16x16x32_bf16 v[104:107], v[44:47], v[168:171], v[104:107]
buffer_load_dwordx4 v2, s[20:23], s45 offen lds
v_mfma_f32_16x16x32_bf16 v[108:111], v[44:47], v[172:175], v[108:111]
s_waitcnt lgkmcnt(4)
v_mfma_f32_16x16x32_bf16 v[112:115], v[32:35], a[0:3], 0
ds_read_b64_tr_b16 v[44:45], v10 offset:28672
v_mfma_f32_16x16x32_bf16 v[116:119], v[32:35], a[4:7], 0
ds_read_b64_tr_b16 v[46:47], v10 offset:28928
v_mfma_f32_16x16x32_bf16 v[120:123], v[32:35], a[8:11], 0
v_mfma_f32_16x16x32_bf16 v[124:127], v[32:35], a[12:15], 0
s_add_u32 m0, s44, 122880
s_add_u32 s45, s48, 590208
s_waitcnt lgkmcnt(4)
v_mfma_f32_16x16x32_bf16 v[128:131], v[36:39], a[0:3], 0
ds_read_b64_tr_b16 v[32:33], v8 offset:32768
v_max_f32 v48, 0, v48
v_mfma_f32_16x16x32_bf16 v[132:135], v[36:39], a[4:7], 0
ds_read_b64_tr_b16 v[34:35], v8 offset:33024
v_max_f32 v49, 0, v49
v_mfma_f32_16x16x32_bf16 v[136:139], v[36:39], a[8:11], 0
buffer_load_dwordx4 v2, s[20:23], s45 offen lds
v_max_f32 v50, 0, v50
v_mfma_f32_16x16x32_bf16 v[140:143], v[36:39], a[12:15], 0
s_add_u32 m0, s44, 126976
s_add_u32 s45, s48, 885120
v_max_f32 v51, 0, v51
s_waitcnt lgkmcnt(4)
v_mfma_f32_16x16x32_bf16 v[112:115], v[40:43], a[16:19], v[112:115]
ds_read_b64_tr_b16 v[36:37], v10 offset:32768
v_mul_f32 v48, v80, v48
v_mfma_f32_16x16x32_bf16 v[116:119], v[40:43], a[20:23], v[116:119]
ds_read_b64_tr_b16 v[38:39], v10 offset:33024
v_mul_f32 v49, v81, v49
v_mfma_f32_16x16x32_bf16 v[120:123], v[40:43], a[24:27], v[120:123]
buffer_load_dwordx4 v2, s[20:23], s45 offen lds
v_mul_f32 v50, v82, v50
v_mfma_f32_16x16x32_bf16 v[124:127], v[40:43], a[28:31], v[124:127]
v_mul_f32 v51, v83, v51
v_max_f32 v64, 0, v64
s_waitcnt lgkmcnt(4)
v_mfma_f32_16x16x32_bf16 v[128:131], v[44:47], a[16:19], v[128:131]
ds_read_b64_tr_b16 v[40:41], v8 offset:36864
v_max_f32 v65, 0, v65
v_mfma_f32_16x16x32_bf16 v[132:135], v[44:47], a[20:23], v[132:135]
ds_read_b64_tr_b16 v[42:43], v8 offset:37120
v_max_f32 v66, 0, v66
v_mfma_f32_16x16x32_bf16 v[136:139], v[44:47], a[24:27], v[136:139]
v_max_f32 v67, 0, v67
v_mul_f32 v64, v96, v64
v_mfma_f32_16x16x32_bf16 v[140:143], v[44:47], a[28:31], v[140:143]
s_add_u32 m0, s44, 131072
s_add_u32 s45, s48, 1180032
v_mul_f32 v65, v97, v65
s_waitcnt lgkmcnt(4)
v_mfma_f32_16x16x32_bf16 v[112:115], v[32:35], a[32:35], v[112:115]
ds_read_b64_tr_b16 v[44:45], v10 offset:36864
v_mul_f32 v66, v98, v66
v_mfma_f32_16x16x32_bf16 v[116:119], v[32:35], a[36:39], v[116:119]
ds_read_b64_tr_b16 v[46:47], v10 offset:37120
v_mul_f32 v67, v99, v67
v_mfma_f32_16x16x32_bf16 v[120:123], v[32:35], a[40:43], v[120:123]
buffer_load_dwordx4 v2, s[20:23], s45 offen lds
v_cvt_pk_bf16_f32 v80, v48, v49
v_mfma_f32_16x16x32_bf16 v[124:127], v[32:35], a[44:47], v[124:127]
s_add_u32 m0, s44, 135168
s_add_u32 s45, s48, 1474944
v_cvt_pk_bf16_f32 v81, v50, v51
s_waitcnt lgkmcnt(4)
v_mfma_f32_16x16x32_bf16 v[128:131], v[36:39], a[32:35], v[128:131]
ds_read_b64_tr_b16 v[32:33], v8 offset:40960
v_cvt_pk_bf16_f32 v82, v64, v65
v_mfma_f32_16x16x32_bf16 v[132:135], v[36:39], a[36:39], v[132:135]
ds_read_b64_tr_b16 v[34:35], v8 offset:41216
v_cvt_pk_bf16_f32 v83, v66, v67
v_mfma_f32_16x16x32_bf16 v[136:139], v[36:39], a[40:43], v[136:139]
buffer_load_dwordx4 v2, s[20:23], s45 offen lds
ds_write_b128 v30, v[80:83] offset:32768
v_mfma_f32_16x16x32_bf16 v[140:143], v[36:39], a[44:47], v[140:143]
v_max_f32 v52, 0, v52
v_max_f32 v53, 0, v53
s_waitcnt lgkmcnt(5)
v_mfma_f32_16x16x32_bf16 v[112:115], v[40:43], a[48:51], v[112:115]
ds_read_b64_tr_b16 v[36:37], v10 offset:40960
v_max_f32 v54, 0, v54
v_mfma_f32_16x16x32_bf16 v[116:119], v[40:43], a[52:55], v[116:119]
ds_read_b64_tr_b16 v[38:39], v10 offset:41216
v_max_f32 v55, 0, v55
v_mfma_f32_16x16x32_bf16 v[120:123], v[40:43], a[56:59], v[120:123]
v_mul_f32 v52, v84, v52
v_mul_f32 v53, v85, v53
v_mfma_f32_16x16x32_bf16 v[124:127], v[40:43], a[60:63], v[124:127]
v_mul_f32 v54, v86, v54
v_mul_f32 v55, v87, v55
s_waitcnt lgkmcnt(5)
v_mfma_f32_16x16x32_bf16 v[128:131], v[44:47], a[48:51], v[128:131]
ds_read_b64_tr_b16 v[40:41], v8 offset:45056
v_max_f32 v68, 0, v68
v_mfma_f32_16x16x32_bf16 v[132:135], v[44:47], a[52:55], v[132:135]
ds_read_b64_tr_b16 v[42:43], v8 offset:45312
v_max_f32 v69, 0, v69
v_mfma_f32_16x16x32_bf16 v[136:139], v[44:47], a[56:59], v[136:139]
v_max_f32 v70, 0, v70
v_max_f32 v71, 0, v71
v_mfma_f32_16x16x32_bf16 v[140:143], v[44:47], a[60:63], v[140:143]
v_mul_f32 v68, v100, v68
v_mul_f32 v69, v101, v69
s_waitcnt lgkmcnt(5)
v_mfma_f32_16x16x32_bf16 v[112:115], v[32:35], a[64:67], v[112:115]
ds_read_b64_tr_b16 v[44:45], v10 offset:45056
v_mul_f32 v70, v102, v70
v_mfma_f32_16x16x32_bf16 v[116:119], v[32:35], a[68:71], v[116:119]
ds_read_b64_tr_b16 v[46:47], v10 offset:45312
v_mul_f32 v71, v103, v71
v_mfma_f32_16x16x32_bf16 v[120:123], v[32:35], a[72:75], v[120:123]
v_cvt_pk_bf16_f32 v84, v52, v53
v_cvt_pk_bf16_f32 v85, v54, v55
v_mfma_f32_16x16x32_bf16 v[124:127], v[32:35], a[76:79], v[124:127]
v_cvt_pk_bf16_f32 v86, v68, v69
v_cvt_pk_bf16_f32 v87, v70, v71
s_waitcnt lgkmcnt(4)
v_mfma_f32_16x16x32_bf16 v[128:131], v[36:39], a[64:67], v[128:131]
s_waitcnt vmcnt(16) lgkmcnt(0)
s_barrier
ds_read_b64_tr_b16 v[32:33], v7 offset:0
ds_write_b128 v30, v[84:87] offset:33792
v_mfma_f32_16x16x32_bf16 v[132:135], v[36:39], a[68:71], v[132:135]
ds_read_b64_tr_b16 v[34:35], v7 offset:256
v_max_f32 v56, 0, v56
v_mfma_f32_16x16x32_bf16 v[136:139], v[36:39], a[72:75], v[136:139]
v_max_f32 v57, 0, v57
v_max_f32 v58, 0, v58
v_mfma_f32_16x16x32_bf16 v[140:143], v[36:39], a[76:79], v[140:143]
s_add_u32 m0, s44, 139264
s_add_u32 s45, s48, 1769856
v_max_f32 v59, 0, v59
v_mfma_f32_16x16x32_bf16 v[112:115], v[40:43], a[80:83], v[112:115]
ds_read_b64_tr_b16 v[36:37], v9 offset:0
v_mul_f32 v56, v88, v56
v_mfma_f32_16x16x32_bf16 v[116:119], v[40:43], a[84:87], v[116:119]
ds_read_b64_tr_b16 v[38:39], v9 offset:256
v_mul_f32 v57, v89, v57
v_mfma_f32_16x16x32_bf16 v[120:123], v[40:43], a[88:91], v[120:123]
buffer_load_dwordx4 v2, s[20:23], s45 offen lds
v_mul_f32 v58, v90, v58
v_mfma_f32_16x16x32_bf16 v[124:127], v[40:43], a[92:95], v[124:127]
s_add_u32 m0, s44, 143360
s_add_u32 s45, s48, 2064768
v_mul_f32 v59, v91, v59
v_mfma_f32_16x16x32_bf16 v[128:131], v[44:47], a[80:83], v[128:131]
ds_read_b64_tr_b16 v[40:41], v7 offset:4096
v_max_f32 v72, 0, v72
v_mfma_f32_16x16x32_bf16 v[132:135], v[44:47], a[84:87], v[132:135]
ds_read_b64_tr_b16 v[42:43], v7 offset:4352
v_max_f32 v73, 0, v73
v_mfma_f32_16x16x32_bf16 v[136:139], v[44:47], a[88:91], v[136:139]
buffer_load_dwordx4 v2, s[20:23], s45 offen lds
v_max_f32 v74, 0, v74
v_mfma_f32_16x16x32_bf16 v[140:143], v[44:47], a[92:95], v[140:143]
v_max_f32 v75, 0, v75
v_mul_f32 v72, v104, v72
s_waitcnt lgkmcnt(4)
v_mfma_f32_16x16x32_bf16 v[112:115], v[32:35], a[96:99], v[112:115]
ds_read_b64_tr_b16 v[44:45], v9 offset:4096
v_mul_f32 v73, v105, v73
v_mfma_f32_16x16x32_bf16 v[116:119], v[32:35], a[100:103], v[116:119]
ds_read_b64_tr_b16 v[46:47], v9 offset:4352
v_mul_f32 v74, v106, v74
v_mfma_f32_16x16x32_bf16 v[120:123], v[32:35], a[104:107], v[120:123]
v_mul_f32 v75, v107, v75
v_cvt_pk_bf16_f32 v88, v56, v57
v_mfma_f32_16x16x32_bf16 v[124:127], v[32:35], a[108:111], v[124:127]
s_add_u32 m0, s44, 147456
s_add_u32 s45, s48, 2359680
v_cvt_pk_bf16_f32 v89, v58, v59
s_waitcnt lgkmcnt(4)
v_mfma_f32_16x16x32_bf16 v[128:131], v[36:39], a[96:99], v[128:131]
ds_read_b64_tr_b16 v[32:33], v7 offset:8192
v_cvt_pk_bf16_f32 v90, v72, v73
v_mfma_f32_16x16x32_bf16 v[132:135], v[36:39], a[100:103], v[132:135]
ds_read_b64_tr_b16 v[34:35], v7 offset:8448
v_cvt_pk_bf16_f32 v91, v74, v75
v_mfma_f32_16x16x32_bf16 v[136:139], v[36:39], a[104:107], v[136:139]
buffer_load_dwordx4 v2, s[20:23], s45 offen lds
ds_write_b128 v31, v[88:91] offset:32768
v_mfma_f32_16x16x32_bf16 v[140:143], v[36:39], a[108:111], v[140:143]
s_add_u32 m0, s44, 151552
s_add_u32 s45, s48, 2654592
v_max_f32 v60, 0, v60
s_waitcnt lgkmcnt(5)
v_mfma_f32_16x16x32_bf16 v[112:115], v[40:43], a[112:115], v[112:115]
ds_read_b64_tr_b16 v[36:37], v9 offset:8192
v_max_f32 v61, 0, v61
v_mfma_f32_16x16x32_bf16 v[116:119], v[40:43], a[116:119], v[116:119]
ds_read_b64_tr_b16 v[38:39], v9 offset:8448
v_max_f32 v62, 0, v62
v_mfma_f32_16x16x32_bf16 v[120:123], v[40:43], a[120:123], v[120:123]
buffer_load_dwordx4 v2, s[20:23], s45 offen lds
v_max_f32 v63, 0, v63
v_mfma_f32_16x16x32_bf16 v[124:127], v[40:43], a[124:127], v[124:127]
v_mul_f32 v60, v92, v60
v_mul_f32 v61, v93, v61
s_waitcnt lgkmcnt(5)
v_mfma_f32_16x16x32_bf16 v[128:131], v[44:47], a[112:115], v[128:131]
ds_read_b64_tr_b16 v[40:41], v7 offset:12288
v_mul_f32 v62, v94, v62
v_mfma_f32_16x16x32_bf16 v[132:135], v[44:47], a[116:119], v[132:135]
ds_read_b64_tr_b16 v[42:43], v7 offset:12544
v_mul_f32 v63, v95, v63
v_mfma_f32_16x16x32_bf16 v[136:139], v[44:47], a[120:123], v[136:139]
v_max_f32 v76, 0, v76
v_max_f32 v77, 0, v77
v_mfma_f32_16x16x32_bf16 v[140:143], v[44:47], a[124:127], v[140:143]
s_add_u32 m0, s44, 155648
s_add_u32 s45, s48, 2949504
v_max_f32 v78, 0, v78
s_waitcnt lgkmcnt(5)
v_mfma_f32_16x16x32_bf16 v[112:115], v[32:35], a[128:131], v[112:115]
ds_read_b64_tr_b16 v[44:45], v9 offset:12288
v_max_f32 v79, 0, v79
v_mfma_f32_16x16x32_bf16 v[116:119], v[32:35], a[132:135], v[116:119]
ds_read_b64_tr_b16 v[46:47], v9 offset:12544
v_mul_f32 v76, v108, v76
v_mfma_f32_16x16x32_bf16 v[120:123], v[32:35], a[136:139], v[120:123]
buffer_load_dwordx4 v2, s[20:23], s45 offen lds
v_mul_f32 v77, v109, v77
v_mfma_f32_16x16x32_bf16 v[124:127], v[32:35], a[140:143], v[124:127]
s_add_u32 m0, s44, 159744
s_add_u32 s45, s48, 3244416
v_mul_f32 v78, v110, v78
s_waitcnt lgkmcnt(4)
v_mfma_f32_16x16x32_bf16 v[128:131], v[36:39], a[128:131], v[128:131]
ds_read_b64_tr_b16 v[32:33], v7 offset:16384
v_mul_f32 v79, v111, v79
v_mfma_f32_16x16x32_bf16 v[132:135], v[36:39], a[132:135], v[132:135]
ds_read_b64_tr_b16 v[34:35], v7 offset:16640
v_cvt_pk_bf16_f32 v92, v60, v61
v_mfma_f32_16x16x32_bf16 v[136:139], v[36:39], a[136:139], v[136:139]
buffer_load_dwordx4 v2, s[20:23], s45 offen lds
v_cvt_pk_bf16_f32 v93, v62, v63
v_mfma_f32_16x16x32_bf16 v[140:143], v[36:39], a[140:143], v[140:143]
v_cvt_pk_bf16_f32 v94, v76, v77
v_cvt_pk_bf16_f32 v95, v78, v79
s_waitcnt lgkmcnt(4)
v_mfma_f32_16x16x32_bf16 v[112:115], v[40:43], a[144:147], v[112:115]
ds_read_b64_tr_b16 v[36:37], v9 offset:16384
ds_write_b128 v31, v[92:95] offset:33792
v_mfma_f32_16x16x32_bf16 v[116:119], v[40:43], a[148:151], v[116:119]
ds_read_b64_tr_b16 v[38:39], v9 offset:16640
s_add_u32 s88, s100, 126976
buffer_store_dwordx4 v[252:255], v23, s[36:39], s88 offen sc1
v_mfma_f32_16x16x32_bf16 v[120:123], v[40:43], a[152:155], v[120:123]
s_add_u32 s88, s100, 131072
buffer_store_dwordx4 v[252:255], v23, s[36:39], s88 offen sc1
v_mfma_f32_16x16x32_bf16 v[124:127], v[40:43], a[156:159], v[124:127]
s_waitcnt lgkmcnt(5)
v_mfma_f32_16x16x32_bf16 v[128:131], v[44:47], a[144:147], v[128:131]
ds_read_b64_tr_b16 v[40:41], v7 offset:20480
v_mfma_f32_16x16x32_bf16 v[132:135], v[44:47], a[148:151], v[132:135]
ds_read_b64_tr_b16 v[42:43], v7 offset:20736
v_mfma_f32_16x16x32_bf16 v[136:139], v[44:47], a[152:155], v[136:139]
v_mfma_f32_16x16x32_bf16 v[140:143], v[44:47], a[156:159], v[140:143]
s_waitcnt lgkmcnt(5)
v_mfma_f32_16x16x32_bf16 v[112:115], v[32:35], a[160:163], v[112:115]
ds_read_b64_tr_b16 v[44:45], v9 offset:20480
s_add_u32 s88, s100, 135168
buffer_store_dwordx4 v[252:255], v23, s[36:39], s88 offen sc1
v_mfma_f32_16x16x32_bf16 v[116:119], v[32:35], a[164:167], v[116:119]
ds_read_b64_tr_b16 v[46:47], v9 offset:20736
v_mfma_f32_16x16x32_bf16 v[120:123], v[32:35], a[168:171], v[120:123]
v_mfma_f32_16x16x32_bf16 v[124:127], v[32:35], a[172:175], v[124:127]
s_waitcnt lgkmcnt(4)
v_mfma_f32_16x16x32_bf16 v[128:131], v[36:39], a[160:163], v[128:131]
s_waitcnt vmcnt(16) lgkmcnt(0)
s_barrier
ds_read_b64_tr_b16 v[32:33], v7 offset:40960
v_mfma_f32_16x16x32_bf16 v[132:135], v[36:39], a[164:167], v[132:135]
ds_read_b64_tr_b16 v[34:35], v7 offset:41216
v_mfma_f32_16x16x32_bf16 v[136:139], v[36:39], a[168:171], v[136:139]
v_mfma_f32_16x16x32_bf16 v[140:143], v[36:39], a[172:175], v[140:143]
s_add_u32 m0, s44, 49152
s_add_u32 s45, s48, 3539328
v_mfma_f32_16x16x32_bf16 v[112:115], v[40:43], a[176:179], v[112:115]
ds_read_b64_tr_b16 v[36:37], v9 offset:40960
v_mfma_f32_16x16x32_bf16 v[116:119], v[40:43], a[180:183], v[116:119]
ds_read_b64_tr_b16 v[38:39], v9 offset:41216
v_mfma_f32_16x16x32_bf16 v[120:123], v[40:43], a[184:187], v[120:123]
buffer_load_dwordx4 v2, s[20:23], s45 offen lds
v_mfma_f32_16x16x32_bf16 v[124:127], v[40:43], a[188:191], v[124:127]
s_add_u32 m0, s44, 53248
s_add_u32 s45, s48, 3834240
v_mfma_f32_16x16x32_bf16 v[128:131], v[44:47], a[176:179], v[128:131]
ds_read_b64_tr_b16 v[40:41], v7 offset:45056
v_mfma_f32_16x16x32_bf16 v[132:135], v[44:47], a[180:183], v[132:135]
ds_read_b64_tr_b16 v[42:43], v7 offset:45312
v_mfma_f32_16x16x32_bf16 v[136:139], v[44:47], a[184:187], v[136:139]
buffer_load_dwordx4 v2, s[20:23], s45 offen lds
v_mfma_f32_16x16x32_bf16 v[140:143], v[44:47], a[188:191], v[140:143]
s_waitcnt lgkmcnt(4)
v_mfma_f32_16x16x32_bf16 v[112:115], v[32:35], a[192:195], v[112:115]
ds_read_b64_tr_b16 v[44:45], v9 offset:45056
v_mfma_f32_16x16x32_bf16 v[116:119], v[32:35], a[196:199], v[116:119]
ds_read_b64_tr_b16 v[46:47], v9 offset:45312
v_mfma_f32_16x16x32_bf16 v[120:123], v[32:35], a[200:203], v[120:123]
v_mfma_f32_16x16x32_bf16 v[124:127], v[32:35], a[204:207], v[124:127]
s_add_u32 m0, s44, 57344
s_add_u32 s45, s48, 4129152
s_waitcnt lgkmcnt(4)
v_mfma_f32_16x16x32_bf16 v[128:131], v[36:39], a[192:195], v[128:131]
ds_read_b64_tr_b16 v[32:33], v7 offset:49152
v_mfma_f32_16x16x32_bf16 v[132:135], v[36:39], a[196:199], v[132:135]
ds_read_b64_tr_b16 v[34:35], v7 offset:49408
v_mfma_f32_16x16x32_bf16 v[136:139], v[36:39], a[200:203], v[136:139]
buffer_load_dwordx4 v2, s[20:23], s45 offen lds
v_mfma_f32_16x16x32_bf16 v[140:143], v[36:39], a[204:207], v[140:143]
s_add_u32 m0, s44, 61440
s_add_u32 s45, s48, 4424064
s_waitcnt lgkmcnt(4)
v_mfma_f32_16x16x32_bf16 v[112:115], v[40:43], a[208:211], v[112:115]
ds_read_b64_tr_b16 v[36:37], v9 offset:49152
v_mfma_f32_16x16x32_bf16 v[116:119], v[40:43], a[212:215], v[116:119]
ds_read_b64_tr_b16 v[38:39], v9 offset:49408
v_mfma_f32_16x16x32_bf16 v[120:123], v[40:43], a[216:219], v[120:123]
buffer_load_dwordx4 v2, s[20:23], s45 offen lds
v_mfma_f32_16x16x32_bf16 v[124:127], v[40:43], a[220:223], v[124:127]
s_waitcnt lgkmcnt(4)
v_mfma_f32_16x16x32_bf16 v[128:131], v[44:47], a[208:211], v[128:131]
ds_read_b64_tr_b16 v[40:41], v7 offset:53248
s_add_u32 s88, s100, 139264
buffer_store_dwordx4 v[252:255], v23, s[36:39], s88 offen sc1
v_mfma_f32_16x16x32_bf16 v[132:135], v[44:47], a[212:215], v[132:135]
ds_read_b64_tr_b16 v[42:43], v7 offset:53504
v_mfma_f32_16x16x32_bf16 v[136:139], v[44:47], a[216:219], v[136:139]
v_mfma_f32_16x16x32_bf16 v[140:143], v[44:47], a[220:223], v[140:143]
s_add_u32 m0, s44, 65536
s_add_u32 s45, s48, 4718976
s_waitcnt lgkmcnt(4)
v_mfma_f32_16x16x32_bf16 v[112:115], v[32:35], a[224:227], v[112:115]
ds_read_b64_tr_b16 v[44:45], v9 offset:53248
v_mfma_f32_16x16x32_bf16 v[116:119], v[32:35], a[228:231], v[116:119]
ds_read_b64_tr_b16 v[46:47], v9 offset:53504
v_mfma_f32_16x16x32_bf16 v[120:123], v[32:35], a[232:235], v[120:123]
buffer_load_dwordx4 v2, s[20:23], s45 offen lds
v_mfma_f32_16x16x32_bf16 v[124:127], v[32:35], a[236:239], v[124:127]
s_add_u32 m0, s44, 69632
s_add_u32 s45, s48, 5013888
s_waitcnt lgkmcnt(4)
v_mfma_f32_16x16x32_bf16 v[128:131], v[36:39], a[224:227], v[128:131]
ds_read_b64_tr_b16 v[32:33], v7 offset:57344
v_mfma_f32_16x16x32_bf16 v[132:135], v[36:39], a[228:231], v[132:135]
ds_read_b64_tr_b16 v[34:35], v7 offset:57600
v_mfma_f32_16x16x32_bf16 v[136:139], v[36:39], a[232:235], v[136:139]
buffer_load_dwordx4 v2, s[20:23], s45 offen lds
v_mfma_f32_16x16x32_bf16 v[140:143], v[36:39], a[236:239], v[140:143]
s_waitcnt lgkmcnt(4)
v_mfma_f32_16x16x32_bf16 v[112:115], v[40:43], a[240:243], v[112:115]
ds_read_b64_tr_b16 v[36:37], v9 offset:57344
buffer_load_dwordx4 v[192:195], v19, s[36:39], s70 offen sc1
v_mfma_f32_16x16x32_bf16 v[116:119], v[40:43], a[244:247], v[116:119]
ds_read_b64_tr_b16 v[38:39], v9 offset:57600
v_mfma_f32_16x16x32_bf16 v[120:123], v[40:43], a[248:251], v[120:123]
v_mfma_f32_16x16x32_bf16 v[124:127], v[40:43], a[252:255], v[124:127]
s_waitcnt lgkmcnt(4)
v_mfma_f32_16x16x32_bf16 v[128:131], v[44:47], a[240:243], v[128:131]
ds_read_b64_tr_b16 v[40:41], v7 offset:61440
v_mfma_f32_16x16x32_bf16 v[132:135], v[44:47], a[244:247], v[132:135]
ds_read_b64_tr_b16 v[42:43], v7 offset:61696
v_mfma_f32_16x16x32_bf16 v[136:139], v[44:47], a[248:251], v[136:139]
v_mfma_f32_16x16x32_bf16 v[140:143], v[44:47], a[252:255], v[140:143]
s_waitcnt lgkmcnt(4)
v_mfma_f32_16x16x32_bf16 v[112:115], v[32:35], v[144:147], v[112:115]
ds_read_b64_tr_b16 v[44:45], v9 offset:61440
v_mfma_f32_16x16x32_bf16 v[116:119], v[32:35], v[148:151], v[116:119]
ds_read_b64_tr_b16 v[46:47], v9 offset:61696
v_mfma_f32_16x16x32_bf16 v[120:123], v[32:35], v[152:155], v[120:123]
v_mfma_f32_16x16x32_bf16 v[124:127], v[32:35], v[156:159], v[124:127]
s_waitcnt lgkmcnt(4)
v_mfma_f32_16x16x32_bf16 v[128:131], v[36:39], v[144:147], v[128:131]
s_waitcnt vmcnt(17) lgkmcnt(0)
s_barrier
ds_read_b64_tr_b16 v[32:33], v8 offset:0
v_mfma_f32_16x16x32_bf16 v[132:135], v[36:39], v[148:151], v[132:135]
ds_read_b64_tr_b16 v[34:35], v8 offset:256
v_mfma_f32_16x16x32_bf16 v[136:139], v[36:39], v[152:155], v[136:139]
v_mfma_f32_16x16x32_bf16 v[140:143], v[36:39], v[156:159], v[140:143]
s_add_u32 m0, s44, 90112
s_add_u32 s45, s49, 0
v_mfma_f32_16x16x32_bf16 v[112:115], v[40:43], v[160:163], v[112:115]
ds_read_b64_tr_b16 v[36:37], v10 offset:0
s_add_u32 s88, s100, 143360
buffer_store_dwordx4 v[252:255], v23, s[36:39], s88 offen sc1
v_mfma_f32_16x16x32_bf16 v[116:119], v[40:43], v[164:167], v[116:119]
ds_read_b64_tr_b16 v[38:39], v10 offset:256
v_mfma_f32_16x16x32_bf16 v[120:123], v[40:43], v[168:171], v[120:123]
buffer_load_dwordx4 v3, s[24:27], s45 offen lds
v_mfma_f32_16x16x32_bf16 v[124:127], v[40:43], v[172:175], v[124:127]
s_add_u32 m0, s44, 94208
s_add_u32 s45, s49, 294912
v_mfma_f32_16x16x32_bf16 v[128:131], v[44:47], v[160:163], v[128:131]
ds_read_b64_tr_b16 v[40:41], v8 offset:4096
v_mfma_f32_16x16x32_bf16 v[132:135], v[44:47], v[164:167], v[132:135]
ds_read_b64_tr_b16 v[42:43], v8 offset:4352
v_mfma_f32_16x16x32_bf16 v[136:139], v[44:47], v[168:171], v[136:139]
buffer_load_dwordx4 v3, s[24:27], s45 offen lds
v_mfma_f32_16x16x32_bf16 v[140:143], v[44:47], v[172:175], v[140:143]
s_waitcnt lgkmcnt(4)
v_mfma_f32_16x16x32_bf16 v[48:51], v[32:35], a[0:3], 0
ds_read_b64_tr_b16 v[44:45], v10 offset:4096
v_mfma_f32_16x16x32_bf16 v[52:55], v[32:35], a[4:7], 0
ds_read_b64_tr_b16 v[46:47], v10 offset:4352
v_mfma_f32_16x16x32_bf16 v[56:59], v[32:35], a[8:11], 0
v_mfma_f32_16x16x32_bf16 v[60:63], v[32:35], a[12:15], 0
s_add_u32 m0, s44, 98304
s_add_u32 s45, s49, 589824
s_waitcnt lgkmcnt(4)
v_mfma_f32_16x16x32_bf16 v[64:67], v[36:39], a[0:3], 0
ds_read_b64_tr_b16 v[32:33], v8 offset:8192
v_mfma_f32_16x16x32_bf16 v[68:71], v[36:39], a[4:7], 0
ds_read_b64_tr_b16 v[34:35], v8 offset:8448
v_mfma_f32_16x16x32_bf16 v[72:75], v[36:39], a[8:11], 0
buffer_load_dwordx4 v3, s[24:27], s45 offen lds
v_mfma_f32_16x16x32_bf16 v[76:79], v[36:39], a[12:15], 0
s_add_u32 m0, s44, 102400
s_add_u32 s45, s49, 884736
s_waitcnt lgkmcnt(4)
v_mfma_f32_16x16x32_bf16 v[48:51], v[40:43], a[16:19], v[48:51]
ds_read_b64_tr_b16 v[36:37], v10 offset:8192
v_mfma_f32_16x16x32_bf16 v[52:55], v[40:43], a[20:23], v[52:55]
ds_read_b64_tr_b16 v[38:39], v10 offset:8448
v_mfma_f32_16x16x32_bf16 v[56:59], v[40:43], a[24:27], v[56:59]
buffer_load_dwordx4 v3, s[24:27], s45 offen lds
v_mfma_f32_16x16x32_bf16 v[60:63], v[40:43], a[28:31], v[60:63]
s_waitcnt lgkmcnt(4)
v_mfma_f32_16x16x32_bf16 v[64:67], v[44:47], a[16:19], v[64:67]
ds_read_b64_tr_b16 v[40:41], v8 offset:12288
v_mfma_f32_16x16x32_bf16 v[68:71], v[44:47], a[20:23], v[68:71]
ds_read_b64_tr_b16 v[42:43], v8 offset:12544
v_mfma_f32_16x16x32_bf16 v[72:75], v[44:47], a[24:27], v[72:75]
v_mfma_f32_16x16x32_bf16 v[76:79], v[44:47], a[28:31], v[76:79]
s_add_u32 m0, s44, 106496
s_add_u32 s45, s49, 1179648
s_waitcnt lgkmcnt(4)
v_mfma_f32_16x16x32_bf16 v[48:51], v[32:35], a[32:35], v[48:51]
ds_read_b64_tr_b16 v[44:45], v10 offset:12288
v_mfma_f32_16x16x32_bf16 v[52:55], v[32:35], a[36:39], v[52:55]
ds_read_b64_tr_b16 v[46:47], v10 offset:12544
v_mfma_f32_16x16x32_bf16 v[56:59], v[32:35], a[40:43], v[56:59]
buffer_load_dwordx4 v3, s[24:27], s45 offen lds
v_mfma_f32_16x16x32_bf16 v[60:63], v[32:35], a[44:47], v[60:63]
s_add_u32 m0, s44, 110592
s_add_u32 s45, s49, 1474560
s_waitcnt lgkmcnt(4)
v_mfma_f32_16x16x32_bf16 v[64:67], v[36:39], a[32:35], v[64:67]
ds_read_b64_tr_b16 v[32:33], v8 offset:16384
v_mfma_f32_16x16x32_bf16 v[68:71], v[36:39], a[36:39], v[68:71]
ds_read_b64_tr_b16 v[34:35], v8 offset:16640
v_mfma_f32_16x16x32_bf16 v[72:75], v[36:39], a[40:43], v[72:75]
buffer_load_dwordx4 v3, s[24:27], s45 offen lds
v_mfma_f32_16x16x32_bf16 v[76:79], v[36:39], a[44:47], v[76:79]
s_waitcnt lgkmcnt(4)
v_mfma_f32_16x16x32_bf16 v[48:51], v[40:43], a[48:51], v[48:51]
ds_read_b64_tr_b16 v[36:37], v10 offset:16384
v_mfma_f32_16x16x32_bf16 v[52:55], v[40:43], a[52:55], v[52:55]
ds_read_b64_tr_b16 v[38:39], v10 offset:16640
v_mfma_f32_16x16x32_bf16 v[56:59], v[40:43], a[56:59], v[56:59]
v_mfma_f32_16x16x32_bf16 v[60:63], v[40:43], a[60:63], v[60:63]
s_waitcnt lgkmcnt(4)
v_mfma_f32_16x16x32_bf16 v[64:67], v[44:47], a[48:51], v[64:67]
ds_read_b64_tr_b16 v[40:41], v8 offset:20480
v_mfma_f32_16x16x32_bf16 v[68:71], v[44:47], a[52:55], v[68:71]
ds_read_b64_tr_b16 v[42:43], v8 offset:20736
v_mfma_f32_16x16x32_bf16 v[72:75], v[44:47], a[56:59], v[72:75]
v_mfma_f32_16x16x32_bf16 v[76:79], v[44:47], a[60:63], v[76:79]
s_waitcnt lgkmcnt(4)
v_mfma_f32_16x16x32_bf16 v[48:51], v[32:35], a[64:67], v[48:51]
ds_read_b64_tr_b16 v[44:45], v10 offset:20480
v_mfma_f32_16x16x32_bf16 v[52:55], v[32:35], a[68:71], v[52:55]
ds_read_b64_tr_b16 v[46:47], v10 offset:20736
v_mfma_f32_16x16x32_bf16 v[56:59], v[32:35], a[72:75], v[56:59]
v_mfma_f32_16x16x32_bf16 v[60:63], v[32:35], a[76:79], v[60:63]
s_waitcnt lgkmcnt(4)
v_mfma_f32_16x16x32_bf16 v[64:67], v[36:39], a[64:67], v[64:67]
s_waitcnt vmcnt(18) lgkmcnt(0)
s_barrier
ds_read_b64_tr_b16 v[32:33], v8 offset:24576
v_mfma_f32_16x16x32_bf16 v[68:71], v[36:39], a[68:71], v[68:71]
ds_read_b64_tr_b16 v[34:35], v8 offset:24832
v_mfma_f32_16x16x32_bf16 v[72:75], v[36:39], a[72:75], v[72:75]
v_mfma_f32_16x16x32_bf16 v[76:79], v[36:39], a[76:79], v[76:79]
s_add_u32 m0, s44, 114688
s_add_u32 s45, s49, 1769472
v_mfma_f32_16x16x32_bf16 v[48:51], v[40:43], a[80:83], v[48:51]
ds_read_b64_tr_b16 v[36:37], v10 offset:24576
s_lshl_b32 s46, s7, 11
v_mfma_f32_16x16x32_bf16 v[52:55], v[40:43], a[84:87], v[52:55]
ds_read_b64_tr_b16 v[38:39], v10 offset:24832
s_add_u32 s46, s46, 86016
v_mfma_f32_16x16x32_bf16 v[56:59], v[40:43], a[88:91], v[56:59]
buffer_load_dwordx4 v3, s[24:27], s45 offen lds
v_add_u32 v26, s46, v23
v_mfma_f32_16x16x32_bf16 v[60:63], v[40:43], a[92:95], v[60:63]
s_add_u32 m0, s44, 118784
s_add_u32 s45, s49, 2064384
v_and_b32 v27, 255, v23
v_mfma_f32_16x16x32_bf16 v[64:67], v[44:47], a[80:83], v[64:67]
ds_read_b64_tr_b16 v[40:41], v8 offset:28672
v_add_u32 v27, s46, v27
v_mfma_f32_16x16x32_bf16 v[68:71], v[44:47], a[84:87], v[68:71]
ds_read_b64_tr_b16 v[42:43], v8 offset:28928
v_and_b32 v29, 1, v0
v_mfma_f32_16x16x32_bf16 v[72:75], v[44:47], a[88:91], v[72:75]
buffer_load_dwordx4 v3, s[24:27], s45 offen lds
s_lshl_b32 s47, s7, 1
v_mfma_f32_16x16x32_bf16 v[76:79], v[44:47], a[92:95], v[76:79]
v_add_u32 v29, s47, v29
v_and_b32 v28, 3, v0
s_waitcnt lgkmcnt(4)
v_mfma_f32_16x16x32_bf16 v[48:51], v[32:35], a[96:99], v[48:51]
ds_read_b64_tr_b16 v[44:45], v10 offset:28672
v_cmp_eq_u32 vcc, 3, v28
v_mfma_f32_16x16x32_bf16 v[52:55], v[32:35], a[100:103], v[52:55]
ds_read_b64_tr_b16 v[46:47], v10 offset:28928
v_cndmask_b32 v29, v29, 4, vcc
v_mfma_f32_16x16x32_bf16 v[56:59], v[32:35], a[104:107], v[56:59]
v_lshlrev_b32 v29, 4, v29
v_add_u32 v29, s46, v29
v_mfma_f32_16x16x32_bf16 v[60:63], v[32:35], a[108:111], v[60:63]
s_add_u32 m0, s44, 122880
s_add_u32 s45, s49, 2359296
v_lshrrev_b32 v28, 4, v0
s_waitcnt lgkmcnt(4)
v_mfma_f32_16x16x32_bf16 v[64:67], v[36:39], a[96:99], v[64:67]
ds_read_b64_tr_b16 v[32:33], v8 offset:32768
v_lshl_add_u32 v28, v28, 7, v29
v_mfma_f32_16x16x32_bf16 v[68:71], v[36:39], a[100:103], v[68:71]
ds_read_b64_tr_b16 v[34:35], v8 offset:33024
v_mfma_f32_16x16x32_bf16 v[72:75], v[36:39], a[104:107], v[72:75]
buffer_load_dwordx4 v3, s[24:27], s45 offen lds
v_mfma_f32_16x16x32_bf16 v[76:79], v[36:39], a[108:111], v[76:79]
s_add_u32 m0, s44, 126976
s_add_u32 s45, s49, 2654208
s_waitcnt lgkmcnt(4)
v_mfma_f32_16x16x32_bf16 v[48:51], v[40:43], a[112:115], v[48:51]
ds_read_b64_tr_b16 v[36:37], v10 offset:32768
v_mfma_f32_16x16x32_bf16 v[52:55], v[40:43], a[116:119], v[52:55]
ds_read_b64_tr_b16 v[38:39], v10 offset:33024
v_mfma_f32_16x16x32_bf16 v[56:59], v[40:43], a[120:123], v[56:59]
buffer_load_dwordx4 v3, s[24:27], s45 offen lds
v_mfma_f32_16x16x32_bf16 v[60:63], v[40:43], a[124:127], v[60:63]
s_waitcnt lgkmcnt(4)
v_mfma_f32_16x16x32_bf16 v[64:67], v[44:47], a[112:115], v[64:67]
ds_read_b64_tr_b16 v[40:41], v8 offset:36864
v_mfma_f32_16x16x32_bf16 v[68:71], v[44:47], a[116:119], v[68:71]
ds_read_b64_tr_b16 v[42:43], v8 offset:37120
v_mfma_f32_16x16x32_bf16 v[72:75], v[44:47], a[120:123], v[72:75]
v_mfma_f32_16x16x32_bf16 v[76:79], v[44:47], a[124:127], v[76:79]
s_add_u32 m0, s44, 131072
s_add_u32 s45, s49, 2949120
s_waitcnt lgkmcnt(4)
v_mfma_f32_16x16x32_bf16 v[48:51], v[32:35], a[128:131], v[48:51]
ds_read_b64_tr_b16 v[44:45], v10 offset:36864
v_mfma_f32_16x16x32_bf16 v[52:55], v[32:35], a[132:135], v[52:55]
ds_read_b64_tr_b16 v[46:47], v10 offset:37120
v_mfma_f32_16x16x32_bf16 v[56:59], v[32:35], a[136:139], v[56:59]
buffer_load_dwordx4 v3, s[24:27], s45 offen lds
v_mfma_f32_16x16x32_bf16 v[60:63], v[32:35], a[140:143], v[60:63]
s_add_u32 m0, s44, 135168
s_add_u32 s45, s49, 3244032
s_waitcnt lgkmcnt(4)
v_mfma_f32_16x16x32_bf16 v[64:67], v[36:39], a[128:131], v[64:67]
ds_read_b64_tr_b16 v[32:33], v8 offset:40960
s_waitcnt vmcnt(12)
v_max3_u32 v196, v192, v193, v194
v_max_u32 v196, v196, v195
v_cmp_eq_u32 vcc, -1, v196
s_cbranch_vccnz L1_h2
L1_h2b:
v_mfma_f32_16x16x32_bf16 v[68:71], v[36:39], a[132:135], v[68:71]
ds_read_b64_tr_b16 v[34:35], v8 offset:41216
ds_write_b128 v20, v[192:195] offset:12288
v_mfma_f32_16x16x32_bf16 v[72:75], v[36:39], a[136:139], v[72:75]
buffer_load_dwordx4 v3, s[24:27], s45 offen lds
v_mfma_f32_16x16x32_bf16 v[76:79], v[36:39], a[140:143], v[76:79]
s_waitcnt lgkmcnt(5)
v_mfma_f32_16x16x32_bf16 v[48:51], v[40:43], a[144:147], v[48:51]
ds_read_b64_tr_b16 v[36:37], v10 offset:40960
v_mfma_f32_16x16x32_bf16 v[52:55], v[40:43], a[148:151], v[52:55]
ds_read_b64_tr_b16 v[38:39], v10 offset:41216
v_mfma_f32_16x16x32_bf16 v[56:59], v[40:43], a[152:155], v[56:59]
v_mfma_f32_16x16x32_bf16 v[60:63], v[40:43], a[156:159], v[60:63]
s_waitcnt lgkmcnt(5)
v_mfma_f32_16x16x32_bf16 v[64:67], v[44:47], a[144:147], v[64:67]
ds_read_b64_tr_b16 v[40:41], v8 offset:45056
v_mfma_f32_16x16x32_bf16 v[68:71], v[44:47], a[148:151], v[68:71]
ds_read_b64_tr_b16 v[42:43], v8 offset:45312
v_mfma_f32_16x16x32_bf16 v[72:75], v[44:47], a[152:155], v[72:75]
v_mfma_f32_16x16x32_bf16 v[76:79], v[44:47], a[156:159], v[76:79]
s_waitcnt lgkmcnt(5)
v_mfma_f32_16x16x32_bf16 v[48:51], v[32:35], a[160:163], v[48:51]
ds_read_b64_tr_b16 v[44:45], v10 offset:45056
v_mfma_f32_16x16x32_bf16 v[52:55], v[32:35], a[164:167], v[52:55]
ds_read_b64_tr_b16 v[46:47], v10 offset:45312
v_mfma_f32_16x16x32_bf16 v[56:59], v[32:35], a[168:171], v[56:59]
v_mfma_f32_16x16x32_bf16 v[60:63], v[32:35], a[172:175], v[60:63]
s_waitcnt lgkmcnt(4)
v_mfma_f32_16x16x32_bf16 v[64:67], v[36:39], a[160:163], v[64:67]
s_waitcnt lgkmcnt(0)
s_barrier
ds_read_b64_tr_b16 v[32:33], v7 offset:0
v_mfma_f32_16x16x32_bf16 v[68:71], v[36:39], a[164:167], v[68:71]
ds_read_b64_tr_b16 v[34:35], v7 offset:256
v_mfma_f32_16x16x32_bf16 v[72:75], v[36:39], a[168:171], v[72:75]
v_mfma_f32_16x16x32_bf16 v[76:79], v[36:39], a[172:175], v[76:79]
s_add_u32 m0, s44, 139264
s_add_u32 s45, s49, 3538944
v_mfma_f32_16x16x32_bf16 v[48:51], v[40:43], a[176:179], v[48:51]
ds_read_b64_tr_b16 v[36:37], v9 offset:0
ds_read_b128 v[196:199], v26
v_mfma_f32_16x16x32_bf16 v[52:55], v[40:43], a[180:183], v[52:55]
ds_read_b64_tr_b16 v[38:39], v9 offset:256
ds_read_b128 v[200:203], v27 offset:1536
v_mfma_f32_16x16x32_bf16 v[56:59], v[40:43], a[184:187], v[56:59]
buffer_load_dwordx4 v3, s[24:27], s45 offen lds
ds_read_b128 v[204:207], v28 offset:1024
v_mfma_f32_16x16x32_bf16 v[60:63], v[40:43], a[188:191], v[60:63]
s_add_u32 m0, s44, 143360
s_add_u32 s45, s49, 3833856
ds_read_b128 v[208:211], v29 offset:1920
v_mfma_f32_16x16x32_bf16 v[64:67], v[44:47], a[176:179], v[64:67]
ds_read_b64_tr_b16 v[40:41], v7 offset:4096
v_and_b32 v18, 15, v0
v_mfma_f32_16x16x32_bf16 v[68:71], v[44:47], a[180:183], v[68:71]
ds_read_b64_tr_b16 v[42:43], v7 offset:4352
v_lshlrev_b32 v18, 3, v18
v_mfma_f32_16x16x32_bf16 v[72:75], v[44:47], a[184:187], v[72:75]
buffer_load_dwordx4 v3, s[24:27], s45 offen lds
s_lshl_b32 s46, s3, 8
v_mfma_f32_16x16x32_bf16 v[76:79], v[44:47], a[188:191], v[76:79]
s_add_u32 s46, s46, 81920
v_add_u32 v17, s46, v18
s_waitcnt lgkmcnt(8)
v_mfma_f32_16x16x32_bf16 v[48:51], v[32:35], a[192:195], v[48:51]
ds_read_b64_tr_b16 v[44:45], v9 offset:4096
s_xor_b32 s46, s46, 256
v_mfma_f32_16x16x32_bf16 v[52:55], v[32:35], a[196:199], v[52:55]
ds_read_b64_tr_b16 v[46:47], v9 offset:4352
v_add_u32 v18, s46, v18
v_mfma_f32_16x16x32_bf16 v[56:59], v[32:35], a[200:203], v[56:59]
s_lshl_b32 s47, s7, 2
s_waitcnt lgkmcnt(8)
v_cvt_pk_bf16_f32 v212, v196, v197
v_mfma_f32_16x16x32_bf16 v[60:63], v[32:35], a[204:207], v[60:63]
s_add_u32 m0, s44, 147456
s_add_u32 s45, s49, 4128768
v_cvt_pk_bf16_f32 v213, v198, v199
s_waitcnt lgkmcnt(7)
v_mfma_f32_16x16x32_bf16 v[64:67], v[36:39], a[192:195], v[64:67]
ds_read_b64_tr_b16 v[32:33], v7 offset:8192
s_waitcnt lgkmcnt(7)
v_cvt_pk_bf16_f32 v214, v200, v201
v_mfma_f32_16x16x32_bf16 v[68:71], v[36:39], a[196:199], v[68:71]
ds_read_b64_tr_b16 v[34:35], v7 offset:8448
v_cvt_pk_bf16_f32 v215, v202, v203
v_mfma_f32_16x16x32_bf16 v[72:75], v[36:39], a[200:203], v[72:75]
buffer_load_dwordx4 v3, s[24:27], s45 offen lds
s_waitcnt lgkmcnt(7)
v_cvt_pk_bf16_f32 v216, v204, v205
v_mfma_f32_16x16x32_bf16 v[76:79], v[36:39], a[204:207], v[76:79]
s_add_u32 m0, s44, 151552
s_add_u32 s45, s49, 4423680
v_cvt_pk_bf16_f32 v217, v206, v207
s_waitcnt lgkmcnt(4)
v_mfma_f32_16x16x32_bf16 v[48:51], v[40:43], a[208:211], v[48:51]
ds_read_b64_tr_b16 v[36:37], v9 offset:8192
v_cvt_pk_bf16_f32 v218, v208, v209
v_mfma_f32_16x16x32_bf16 v[52:55], v[40:43], a[212:215], v[52:55]
ds_read_b64_tr_b16 v[38:39], v9 offset:8448
v_cvt_pk_bf16_f32 v219, v210, v211
v_mfma_f32_16x16x32_bf16 v[56:59], v[40:43], a[216:219], v[56:59]
buffer_load_dwordx4 v3, s[24:27], s45 offen lds
v_add_u32 v26, s47, v17
v_mfma_f32_16x16x32_bf16 v[60:63], v[40:43], a[220:223], v[60:63]
v_add_u32 v27, s47, v18
v_cndmask_b32 v214, 0, v214, s[56:57]
s_waitcnt lgkmcnt(4)
v_mfma_f32_16x16x32_bf16 v[64:67], v[44:47], a[208:211], v[64:67]
ds_read_b64_tr_b16 v[40:41], v7 offset:12288
v_cndmask_b32 v215, 0, v215, s[58:59]
v_mfma_f32_16x16x32_bf16 v[68:71], v[44:47], a[212:215], v[68:71]
ds_read_b64_tr_b16 v[42:43], v7 offset:12544
v_cndmask_b32 v218, 0, v218, s[56:57]
v_mfma_f32_16x16x32_bf16 v[72:75], v[44:47], a[216:219], v[72:75]
v_cndmask_b32 v219, 0, v219, s[58:59]
s_nop 1
v_mfma_f32_16x16x32_bf16 v[236:239], v[216:219], v[176:179], 0
v_mfma_f32_16x16x32_bf16 v[76:79], v[44:47], a[220:223], v[76:79]
s_add_u32 m0, s44, 155648
s_add_u32 s45, s49, 4718592
v_mfma_f32_16x16x32_bf16 v[220:223], v[212:215], v[176:179], 0
s_waitcnt lgkmcnt(4)
v_mfma_f32_16x16x32_bf16 v[48:51], v[32:35], a[224:227], v[48:51]
ds_read_b64_tr_b16 v[44:45], v9 offset:12288
v_mfma_f32_16x16x32_bf16 v[240:243], v[216:219], v[180:183], 0
v_mfma_f32_16x16x32_bf16 v[52:55], v[32:35], a[228:231], v[52:55]
ds_read_b64_tr_b16 v[46:47], v9 offset:12544
v_mfma_f32_16x16x32_bf16 v[224:227], v[212:215], v[180:183], 0
v_mfma_f32_16x16x32_bf16 v[56:59], v[32:35], a[232:235], v[56:59]
buffer_load_dwordx4 v3, s[24:27], s45 offen lds
v_mfma_f32_16x16x32_bf16 v[244:247], v[216:219], v[184:187], 0
v_mfma_f32_16x16x32_bf16 v[60:63], v[32:35], a[236:239], v[60:63]
s_add_u32 m0, s44, 159744
s_add_u32 s45, s49, 5013504
v_mfma_f32_16x16x32_bf16 v[228:231], v[212:215], v[184:187], 0
s_waitcnt lgkmcnt(4)
v_mfma_f32_16x16x32_bf16 v[64:67], v[36:39], a[224:227], v[64:67]
ds_read_b64_tr_b16 v[32:33], v7 offset:16384
v_mfma_f32_16x16x32_bf16 v[248:251], v[216:219], v[188:191], 0
v_mfma_f32_16x16x32_bf16 v[68:71], v[36:39], a[228:231], v[68:71]
ds_read_b64_tr_b16 v[34:35], v7 offset:16640
v_mfma_f32_16x16x32_bf16 v[232:235], v[212:215], v[188:191], 0
v_mfma_f32_16x16x32_bf16 v[72:75], v[36:39], a[232:235], v[72:75]
buffer_load_dwordx4 v3, s[24:27], s45 offen lds
v_mfma_f32_16x16x32_bf16 v[76:79], v[36:39], a[236:239], v[76:79]
s_waitcnt lgkmcnt(4)
v_mfma_f32_16x16x32_bf16 v[48:51], v[40:43], a[240:243], v[48:51]
ds_read_b64_tr_b16 v[36:37], v9 offset:16384
v_add_f32 v192, s66, v239
v_mfma_f32_16x16x32_bf16 v[52:55], v[40:43], a[244:247], v[52:55]
ds_read_b64_tr_b16 v[38:39], v9 offset:16640
v_add_f32 v193, s66, v243
v_mfma_f32_16x16x32_bf16 v[56:59], v[40:43], a[248:251], v[56:59]
v_add_f32 v194, s66, v247
v_add_f32 v195, s66, v251
v_mfma_f32_16x16x32_bf16 v[60:63], v[40:43], a[252:255], v[60:63]
v_rcp_f32 v192, v192
s_waitcnt lgkmcnt(4)
v_mfma_f32_16x16x32_bf16 v[64:67], v[44:47], a[240:243], v[64:67]
ds_read_b64_tr_b16 v[40:41], v7 offset:20480
v_mfma_f32_16x16x32_bf16 v[68:71], v[44:47], a[244:247], v[68:71]
ds_read_b64_tr_b16 v[42:43], v7 offset:20736
v_rcp_f32 v193, v193
v_mfma_f32_16x16x32_bf16 v[72:75], v[44:47], a[248:251], v[72:75]
v_rcp_f32 v194, v194
v_mfma_f32_16x16x32_bf16 v[76:79], v[44:47], a[252:255], v[76:79]
v_rcp_f32 v195, v195
s_waitcnt lgkmcnt(4)
v_mfma_f32_16x16x32_bf16 v[48:51], v[32:35], v[144:147], v[48:51]
ds_read_b64_tr_b16 v[44:45], v9 offset:20480
v_mfma_f32_16x16x32_bf16 v[52:55], v[32:35], v[148:151], v[52:55]
ds_read_b64_tr_b16 v[46:47], v9 offset:20736
v_mul_f32 v220, v220, v192
v_mfma_f32_16x16x32_bf16 v[56:59], v[32:35], v[152:155], v[56:59]
v_mul_f32 v221, v221, v192
v_mul_f32 v222, v222, v192
v_mfma_f32_16x16x32_bf16 v[60:63], v[32:35], v[156:159], v[60:63]
v_mul_f32 v223, v223, v192
v_mul_f32 v236, v236, v192
s_waitcnt lgkmcnt(4)
v_mfma_f32_16x16x32_bf16 v[64:67], v[36:39], v[144:147], v[64:67]
s_waitcnt vmcnt(12) lgkmcnt(0)
s_barrier
ds_read_b64_tr_b16 v[32:33], v11 offset:40960
v_mul_f32 v237, v237, v192
v_mfma_f32_16x16x32_bf16 v[68:71], v[36:39], v[148:151], v[68:71]
ds_read_b64_tr_b16 v[34:35], v11 offset:41216
v_cvt_pk_bf16_f32 v220, v220, v221
v_mfma_f32_16x16x32_bf16 v[72:75], v[36:39], v[152:155], v[72:75]
v_cvt_pk_bf16_f32 v221, v222, v223
v_cvt_pk_bf16_f32 v236, v236, v237
v_mfma_f32_16x16x32_bf16 v[76:79], v[36:39], v[156:159], v[76:79]
ds_write_b64 v15, v[220:221] offset:8192
ds_write_b32 v26, v236 offset:0
v_mfma_f32_16x16x32_bf16 v[48:51], v[40:43], v[160:163], v[48:51]
ds_read_b64_tr_b16 v[36:37], v11 offset:43008
v_mul_f32 v224, v224, v193
v_mfma_f32_16x16x32_bf16 v[52:55], v[40:43], v[164:167], v[52:55]
ds_read_b64_tr_b16 v[38:39], v11 offset:43264
v_mul_f32 v225, v225, v193
v_mfma_f32_16x16x32_bf16 v[56:59], v[40:43], v[168:171], v[56:59]
v_mul_f32 v226, v226, v193
v_mul_f32 v227, v227, v193
v_mfma_f32_16x16x32_bf16 v[60:63], v[40:43], v[172:175], v[60:63]
v_mul_f32 v240, v240, v193
v_mul_f32 v241, v241, v193
v_mfma_f32_16x16x32_bf16 v[64:67], v[44:47], v[160:163], v[64:67]
ds_read_b64_tr_b16 v[40:41], v11 offset:45056
v_cvt_pk_bf16_f32 v224, v224, v225
v_mfma_f32_16x16x32_bf16 v[68:71], v[44:47], v[164:167], v[68:71]
ds_read_b64_tr_b16 v[42:43], v11 offset:45312
v_cvt_pk_bf16_f32 v225, v226, v227
v_mfma_f32_16x16x32_bf16 v[72:75], v[44:47], v[168:171], v[72:75]
v_cvt_pk_bf16_f32 v240, v240, v241
ds_write_b64 v15, v[224:225] offset:9216
v_mfma_f32_16x16x32_bf16 v[76:79], v[44:47], v[172:175], v[76:79]
ds_write_b32 v26, v240 offset:128
v_mul_f32 v228, v228, v194
s_waitcnt lgkmcnt(8)
v_mfma_f32_16x16x32_bf16 v[80:83], v[32:35], a[0:3], 0
ds_read_b64_tr_b16 v[44:45], v11 offset:47104
v_mul_f32 v229, v229, v194
v_mfma_f32_16x16x32_bf16 v[84:87], v[32:35], a[4:7], 0
ds_read_b64_tr_b16 v[46:47], v11 offset:47360
v_mul_f32 v230, v230, v194
v_mfma_f32_16x16x32_bf16 v[88:91], v[32:35], a[8:11], 0
v_mul_f32 v231, v231, v194
v_mul_f32 v244, v244, v194
v_mfma_f32_16x16x32_bf16 v[92:95], v[32:35], a[12:15], 0
v_mul_f32 v245, v245, v194
v_cvt_pk_bf16_f32 v228, v228, v229
s_waitcnt lgkmcnt(6)
v_mfma_f32_16x16x32_bf16 v[96:99], v[36:39], a[0:3], 0
ds_read_b64_tr_b16 v[32:33], v11 offset:49152
v_cvt_pk_bf16_f32 v229, v230, v231
v_mfma_f32_16x16x32_bf16 v[100:103], v[36:39], a[4:7], 0
ds_read_b64_tr_b16 v[34:35], v11 offset:49408
v_cvt_pk_bf16_f32 v244, v244, v245
v_mfma_f32_16x16x32_bf16 v[104:107], v[36:39], a[8:11], 0
ds_write_b64 v16, v[228:229] offset:8192
ds_write_b32 v27, v244 offset:0
v_mfma_f32_16x16x32_bf16 v[108:111], v[36:39], a[12:15], 0
v_mul_f32 v232, v232, v195
v_mul_f32 v233, v233, v195
s_waitcnt lgkmcnt(8)
v_mfma_f32_16x16x32_bf16 v[80:83], v[40:43], a[16:19], v[80:83]
ds_read_b64_tr_b16 v[36:37], v11 offset:51200
v_mul_f32 v234, v234, v195
v_mfma_f32_16x16x32_bf16 v[84:87], v[40:43], a[20:23], v[84:87]
ds_read_b64_tr_b16 v[38:39], v11 offset:51456
v_mul_f32 v235, v235, v195
v_mfma_f32_16x16x32_bf16 v[88:91], v[40:43], a[24:27], v[88:91]
v_mul_f32 v248, v248, v195
v_mul_f32 v249, v249, v195
v_mfma_f32_16x16x32_bf16 v[92:95], v[40:43], a[28:31], v[92:95]
v_cvt_pk_bf16_f32 v232, v232, v233
v_cvt_pk_bf16_f32 v233, v234, v235
s_waitcnt lgkmcnt(6)
v_mfma_f32_16x16x32_bf16 v[96:99], v[44:47], a[16:19], v[96:99]
ds_read_b64_tr_b16 v[40:41], v11 offset:53248
v_cvt_pk_bf16_f32 v248, v248, v249
v_mfma_f32_16x16x32_bf16 v[100:103], v[44:47], a[20:23], v[100:103]
ds_read_b64_tr_b16 v[42:43], v11 offset:53504
ds_write_b64 v16, v[232:233] offset:9216
v_mfma_f32_16x16x32_bf16 v[104:107], v[44:47], a[24:27], v[104:107]
ds_write_b32 v27, v248 offset:128
v_max_f32 v112, 0, v112
v_mfma_f32_16x16x32_bf16 v[108:111], v[44:47], a[28:31], v[108:111]
v_max_f32 v113, 0, v113
v_max_f32 v114, 0, v114
s_waitcnt lgkmcnt(8)
v_mfma_f32_16x16x32_bf16 v[80:83], v[32:35], a[32:35], v[80:83]
ds_read_b64_tr_b16 v[44:45], v11 offset:55296
v_max_f32 v115, 0, v115
v_mul_f32 v112, v48, v112
v_mfma_f32_16x16x32_bf16 v[84:87], v[32:35], a[36:39], v[84:87]
ds_read_b64_tr_b16 v[46:47], v11 offset:55552
v_mul_f32 v113, v49, v113
v_mul_f32 v114, v50, v114
v_mfma_f32_16x16x32_bf16 v[88:91], v[32:35], a[40:43], v[88:91]
v_mul_f32 v115, v51, v115
v_max_f32 v128, 0, v128
v_max_f32 v129, 0, v129
v_mfma_f32_16x16x32_bf16 v[92:95], v[32:35], a[44:47], v[92:95]
v_max_f32 v130, 0, v130
v_max_f32 v131, 0, v131
v_mul_f32 v128, v64, v128
s_waitcnt lgkmcnt(6)
v_mfma_f32_16x16x32_bf16 v[96:99], v[36:39], a[32:35], v[96:99]
ds_read_b64_tr_b16 v[32:33], v11 offset:57344
v_mul_f32 v129, v65, v129
v_mfma_f32_16x16x32_bf16 v[100:103], v[36:39], a[36:39], v[100:103]
ds_read_b64_tr_b16 v[34:35], v11 offset:57600
v_mul_f32 v130, v66, v130
v_mfma_f32_16x16x32_bf16 v[104:107], v[36:39], a[40:43], v[104:107]
v_mul_f32 v131, v67, v131
v_cvt_pk_bf16_f32 v48, v112, v113
v_mfma_f32_16x16x32_bf16 v[108:111], v[36:39], a[44:47], v[108:111]
v_cvt_pk_bf16_f32 v49, v114, v115
v_cvt_pk_bf16_f32 v50, v128, v129
s_waitcnt lgkmcnt(6)
v_mfma_f32_16x16x32_bf16 v[80:83], v[40:43], a[48:51], v[80:83]
ds_read_b64_tr_b16 v[36:37], v11 offset:59392
v_cvt_pk_bf16_f32 v51, v130, v131
v_mfma_f32_16x16x32_bf16 v[84:87], v[40:43], a[52:55], v[84:87]
ds_read_b64_tr_b16 v[38:39], v11 offset:59648
ds_write_b128 v30, v[48:51] offset:49152
v_mfma_f32_16x16x32_bf16 v[88:91], v[40:43], a[56:59], v[88:91]
v_max_f32 v116, 0, v116
v_max_f32 v117, 0, v117
v_mfma_f32_16x16x32_bf16 v[92:95], v[40:43], a[60:63], v[92:95]
v_max_f32 v118, 0, v118
v_max_f32 v119, 0, v119
s_waitcnt lgkmcnt(5)
v_mfma_f32_16x16x32_bf16 v[96:99], v[44:47], a[48:51], v[96:99]
ds_read_b64_tr_b16 v[40:41], v11 offset:61440
v_mul_f32 v116, v52, v116
v_mfma_f32_16x16x32_bf16 v[100:103], v[44:47], a[52:55], v[100:103]
ds_read_b64_tr_b16 v[42:43], v11 offset:61696
v_mul_f32 v117, v53, v117
v_mfma_f32_16x16x32_bf16 v[104:107], v[44:47], a[56:59], v[104:107]
v_mul_f32 v118, v54, v118
v_mul_f32 v119, v55, v119
v_mfma_f32_16x16x32_bf16 v[108:111], v[44:47], a[60:63], v[108:111]
v_max_f32 v132, 0, v132
v_max_f32 v133, 0, v133
s_waitcnt lgkmcnt(5)
v_mfma_f32_16x16x32_bf16 v[80:83], v[32:35], a[64:67], v[80:83]
ds_read_b64_tr_b16 v[44:45], v11 offset:63488
v_max_f32 v134, 0, v134
v_mfma_f32_16x16x32_bf16 v[84:87], v[32:35], a[68:71], v[84:87]
ds_read_b64_tr_b16 v[46:47], v11 offset:63744
v_max_f32 v135, 0, v135
v_mfma_f32_16x16x32_bf16 v[88:91], v[32:35], a[72:75], v[88:91]
v_mul_f32 v132, v68, v132
v_mul_f32 v133, v69, v133
v_mfma_f32_16x16x32_bf16 v[92:95], v[32:35], a[76:79], v[92:95]
v_mul_f32 v134, v70, v134
v_mul_f32 v135, v71, v135
s_waitcnt lgkmcnt(5)
v_mfma_f32_16x16x32_bf16 v[96:99], v[36:39], a[64:67], v[96:99]
s_waitcnt vmcnt(6) lgkmcnt(0)
s_barrier
ds_read_b64_tr_b16 v[32:33], v12 offset:0
v_cvt_pk_bf16_f32 v52, v116, v117
v_mfma_f32_16x16x32_bf16 v[100:103], v[36:39], a[68:71], v[100:103]
ds_read_b64_tr_b16 v[34:35], v12 offset:256
v_cvt_pk_bf16_f32 v53, v118, v119
v_mfma_f32_16x16x32_bf16 v[104:107], v[36:39], a[72:75], v[104:107]
v_cvt_pk_bf16_f32 v54, v132, v133
v_cvt_pk_bf16_f32 v55, v134, v135
v_mfma_f32_16x16x32_bf16 v[108:111], v[36:39], a[76:79], v[108:111]
s_add_u32 m0, s44, 90112
s_add_u32 s45, s50, 0
ds_write_b128 v30, v[52:55] offset:50176
v_mfma_f32_16x16x32_bf16 v[80:83], v[40:43], a[80:83], v[80:83]
ds_read_b64_tr_b16 v[36:37], v12 offset:2048
v_max_f32 v120, 0, v120
v_mfma_f32_16x16x32_bf16 v[84:87], v[40:43], a[84:87], v[84:87]
ds_read_b64_tr_b16 v[38:39], v12 offset:2304
v_max_f32 v121, 0, v121
v_mfma_f32_16x16x32_bf16 v[88:91], v[40:43], a[88:91], v[88:91]
buffer_load_dwordx4 v4, s[28:31], s45 offen lds
v_max_f32 v122, 0, v122
v_mfma_f32_16x16x32_bf16 v[92:95], v[40:43], a[92:95], v[92:95]
s_add_u32 m0, s44, 94208
s_add_u32 s45, s50, 36864
v_max_f32 v123, 0, v123
v_mfma_f32_16x16x32_bf16 v[96:99], v[44:47], a[80:83], v[96:99]
ds_read_b64_tr_b16 v[40:41], v12 offset:4096
v_mul_f32 v120, v56, v120
v_mfma_f32_16x16x32_bf16 v[100:103], v[44:47], a[84:87], v[100:103]
ds_read_b64_tr_b16 v[42:43], v12 offset:4352
v_mul_f32 v121, v57, v121
v_mfma_f32_16x16x32_bf16 v[104:107], v[44:47], a[88:91], v[104:107]
buffer_load_dwordx4 v4, s[28:31], s45 offen lds
v_mul_f32 v122, v58, v122
v_mfma_f32_16x16x32_bf16 v[108:111], v[44:47], a[92:95], v[108:111]
v_mul_f32 v123, v59, v123
v_max_f32 v136, 0, v136
s_waitcnt lgkmcnt(5)
v_mfma_f32_16x16x32_bf16 v[80:83], v[32:35], a[96:99], v[80:83]
ds_read_b64_tr_b16 v[44:45], v12 offset:6144
v_max_f32 v137, 0, v137
v_mfma_f32_16x16x32_bf16 v[84:87], v[32:35], a[100:103], v[84:87]
ds_read_b64_tr_b16 v[46:47], v12 offset:6400
v_max_f32 v138, 0, v138
v_mfma_f32_16x16x32_bf16 v[88:91], v[32:35], a[104:107], v[88:91]
v_max_f32 v139, 0, v139
v_mul_f32 v136, v72, v136
v_mfma_f32_16x16x32_bf16 v[92:95], v[32:35], a[108:111], v[92:95]
s_add_u32 m0, s44, 98304
s_add_u32 s45, s50, 73728
v_mul_f32 v137, v73, v137
s_waitcnt lgkmcnt(4)
v_mfma_f32_16x16x32_bf16 v[96:99], v[36:39], a[96:99], v[96:99]
ds_read_b64_tr_b16 v[32:33], v12 offset:8192
v_mul_f32 v138, v74, v138
v_mfma_f32_16x16x32_bf16 v[100:103], v[36:39], a[100:103], v[100:103]
ds_read_b64_tr_b16 v[34:35], v12 offset:8448
v_mul_f32 v139, v75, v139
v_mfma_f32_16x16x32_bf16 v[104:107], v[36:39], a[104:107], v[104:107]
buffer_load_dwordx4 v4, s[28:31], s45 offen lds
v_cvt_pk_bf16_f32 v56, v120, v121
v_mfma_f32_16x16x32_bf16 v[108:111], v[36:39], a[108:111], v[108:111]
s_add_u32 m0, s44, 102400
s_add_u32 s45, s50, 110592
v_cvt_pk_bf16_f32 v57, v122, v123
s_waitcnt lgkmcnt(4)
v_mfma_f32_16x16x32_bf16 v[80:83], v[40:43], a[112:115], v[80:83]
ds_read_b64_tr_b16 v[36:37], v12 offset:10240
v_cvt_pk_bf16_f32 v58, v136, v137
v_mfma_f32_16x16x32_bf16 v[84:87], v[40:43], a[116:119], v[84:87]
ds_read_b64_tr_b16 v[38:39], v12 offset:10496
v_cvt_pk_bf16_f32 v59, v138, v139
v_mfma_f32_16x16x32_bf16 v[88:91], v[40:43], a[120:123], v[88:91]
buffer_load_dwordx4 v4, s[28:31], s45 offen lds
ds_write_b128 v31, v[56:59] offset:49152
v_mfma_f32_16x16x32_bf16 v[92:95], v[40:43], a[124:127], v[92:95]
v_max_f32 v124, 0, v124
v_max_f32 v125, 0, v125
s_waitcnt lgkmcnt(5)
v_mfma_f32_16x16x32_bf16 v[96:99], v[44:47], a[112:115], v[96:99]
ds_read_b64_tr_b16 v[40:41], v12 offset:12288
v_max_f32 v126, 0, v126
v_mfma_f32_16x16x32_bf16 v[100:103], v[44:47], a[116:119], v[100:103]
ds_read_b64_tr_b16 v[42:43], v12 offset:12544
v_max_f32 v127, 0, v127
v_mfma_f32_16x16x32_bf16 v[104:107], v[44:47], a[120:123], v[104:107]
v_mul_f32 v124, v60, v124
v_mul_f32 v125, v61, v125
v_mfma_f32_16x16x32_bf16 v[108:111], v[44:47], a[124:127], v[108:111]
s_add_u32 m0, s44, 106496
s_add_u32 s45, s50, 147456
v_mul_f32 v126, v62, v126
s_waitcnt lgkmcnt(5)
v_mfma_f32_16x16x32_bf16 v[80:83], v[32:35], a[128:131], v[80:83]
ds_read_b64_tr_b16 v[44:45], v12 offset:14336
v_mul_f32 v127, v63, v127
v_mfma_f32_16x16x32_bf16 v[84:87], v[32:35], a[132:135], v[84:87]
ds_read_b64_tr_b16 v[46:47], v12 offset:14592
v_max_f32 v140, 0, v140
v_mfma_f32_16x16x32_bf16 v[88:91], v[32:35], a[136:139], v[88:91]
buffer_load_dwordx4 v4, s[28:31], s45 offen lds
v_max_f32 v141, 0, v141
v_mfma_f32_16x16x32_bf16 v[92:95], v[32:35], a[140:143], v[92:95]
s_add_u32 m0, s44, 110592
s_add_u32 s45, s50, 184320
v_max_f32 v142, 0, v142
s_waitcnt lgkmcnt(5)
v_mfma_f32_16x16x32_bf16 v[96:99], v[36:39], a[128:131], v[96:99]
ds_read_b64_tr_b16 v[32:33], v12 offset:16384
v_max_f32 v143, 0, v143
v_mfma_f32_16x16x32_bf16 v[100:103], v[36:39], a[132:135], v[100:103]
ds_read_b64_tr_b16 v[34:35], v12 offset:16640
v_mul_f32 v140, v76, v140
v_mfma_f32_16x16x32_bf16 v[104:107], v[36:39], a[136:139], v[104:107]
buffer_load_dwordx4 v4, s[28:31], s45 offen lds
v_mul_f32 v141, v77, v141
v_mfma_f32_16x16x32_bf16 v[108:111], v[36:39], a[140:143], v[108:111]
v_mul_f32 v142, v78, v142
v_mul_f32 v143, v79, v143
s_waitcnt lgkmcnt(4)
v_mfma_f32_16x16x32_bf16 v[80:83], v[40:43], a[144:147], v[80:83]
ds_read_b64_tr_b16 v[36:37], v12 offset:18432
v_cvt_pk_bf16_f32 v60, v124, v125
v_mfma_f32_16x16x32_bf16 v[84:87], v[40:43], a[148:151], v[84:87]
ds_read_b64_tr_b16 v[38:39], v12 offset:18688
v_cvt_pk_bf16_f32 v61, v126, v127
v_mfma_f32_16x16x32_bf16 v[88:91], v[40:43], a[152:155], v[88:91]
v_cvt_pk_bf16_f32 v62, v140, v141
v_cvt_pk_bf16_f32 v63, v142, v143
v_mfma_f32_16x16x32_bf16 v[92:95], v[40:43], a[156:159], v[92:95]
ds_write_b128 v31, v[60:63] offset:50176
s_and_b32 s88, s5, 3
s_lshl_b32 s88, 16, s88
v_mov_b32 v252, s88
s_lshl_b32 s88, s4, 4
s_and_b32 s89, s5, 12
s_add_u32 s88, s88, s89
v_mov_b32 v253, s88
s_waitcnt lgkmcnt(5)
v_mfma_f32_16x16x32_bf16 v[96:99], v[44:47], a[144:147], v[96:99]
ds_read_b64_tr_b16 v[40:41], v12 offset:20480
s_cmp_lg_u32 s3, 0
s_cbranch_scc1 L1_f1
s_mov_b64 exec, 1
buffer_atomic_or v252, v253, s[40:43], 0 offen
s_mov_b64 exec, -1
L1_f1:
v_mfma_f32_16x16x32_bf16 v[100:103], v[44:47], a[148:151], v[100:103]
ds_read_b64_tr_b16 v[42:43], v12 offset:20736
v_mfma_f32_16x16x32_bf16 v[104:107], v[44:47], a[152:155], v[104:107]
v_mfma_f32_16x16x32_bf16 v[108:111], v[44:47], a[156:159], v[108:111]
s_waitcnt lgkmcnt(5)
v_mfma_f32_16x16x32_bf16 v[80:83], v[32:35], a[160:163], v[80:83]
ds_read_b64_tr_b16 v[44:45], v12 offset:22528
v_mfma_f32_16x16x32_bf16 v[84:87], v[32:35], a[164:167], v[84:87]
ds_read_b64_tr_b16 v[46:47], v12 offset:22784
v_mfma_f32_16x16x32_bf16 v[88:91], v[32:35], a[168:171], v[88:91]
v_mfma_f32_16x16x32_bf16 v[92:95], v[32:35], a[172:175], v[92:95]
s_waitcnt lgkmcnt(5)
v_mfma_f32_16x16x32_bf16 v[96:99], v[36:39], a[160:163], v[96:99]
s_waitcnt vmcnt(6) lgkmcnt(0)
s_barrier
ds_read_b64_tr_b16 v[32:33], v12 offset:24576
v_mfma_f32_16x16x32_bf16 v[100:103], v[36:39], a[164:167], v[100:103]
ds_read_b64_tr_b16 v[34:35], v12 offset:24832
v_mfma_f32_16x16x32_bf16 v[104:107], v[36:39], a[168:171], v[104:107]
v_mfma_f32_16x16x32_bf16 v[108:111], v[36:39], a[172:175], v[108:111]
s_add_u32 m0, s44, 114688
s_add_u32 s45, s50, 221184
v_mfma_f32_16x16x32_bf16 v[80:83], v[40:43], a[176:179], v[80:83]
ds_read_b64_tr_b16 v[36:37], v12 offset:26624
ds_read_b128 a[0:3], v21 offset:0
v_mfma_f32_16x16x32_bf16 v[84:87], v[40:43], a[180:183], v[84:87]
ds_read_b64_tr_b16 v[38:39], v12 offset:26880
ds_read_b128 a[4:7], v21 offset:1024
v_mfma_f32_16x16x32_bf16 v[88:91], v[40:43], a[184:187], v[88:91]
buffer_load_dwordx4 v4, s[28:31], s45 offen lds
ds_read_b128 a[8:11], v22 offset:0
v_mfma_f32_16x16x32_bf16 v[92:95], v[40:43], a[188:191], v[92:95]
s_add_u32 m0, s44, 118784
s_add_u32 s45, s50, 258048
ds_read_b128 a[12:15], v22 offset:1024
v_mfma_f32_16x16x32_bf16 v[96:99], v[44:47], a[176:179], v[96:99]
ds_read_b64_tr_b16 v[40:41], v12 offset:28672
ds_read_b128 a[16:19], v21 offset:8192
v_mfma_f32_16x16x32_bf16 v[100:103], v[44:47], a[180:183], v[100:103]
ds_read_b64_tr_b16 v[42:43], v12 offset:28928
ds_read_b128 a[20:23], v21 offset:9216
v_mfma_f32_16x16x32_bf16 v[104:107], v[44:47], a[184:187], v[104:107]
buffer_load_dwordx4 v4, s[28:31], s45 offen lds
ds_read_b128 a[24:27], v22 offset:8192
v_mfma_f32_16x16x32_bf16 v[108:111], v[44:47], a[188:191], v[108:111]
ds_read_b128 a[28:31], v22 offset:9216
ds_read_b128 a[32:35], v21 offset:16384
s_waitcnt lgkmcnt(13)
v_mfma_f32_16x16x32_bf16 v[80:83], v[32:35], a[192:195], v[80:83]
ds_read_b64_tr_b16 v[44:45], v12 offset:30720
ds_read_b128 a[36:39], v21 offset:17408
v_mfma_f32_16x16x32_bf16 v[84:87], v[32:35], a[196:199], v[84:87]
ds_read_b64_tr_b16 v[46:47], v12 offset:30976
ds_read_b128 a[40:43], v22 offset:16384
v_mfma_f32_16x16x32_bf16 v[88:91], v[32:35], a[200:203], v[88:91]
ds_read_b128 a[44:47], v22 offset:17408
ds_read_b128 a[48:51], v21 offset:24576
v_mfma_f32_16x16x32_bf16 v[92:95], v[32:35], a[204:207], v[92:95]
s_add_u32 m0, s44, 122880
s_add_u32 s45, s51, 0
ds_read_b128 a[52:55], v21 offset:25600
s_waitcnt lgkmcnt(15)
v_mfma_f32_16x16x32_bf16 v[96:99], v[36:39], a[192:195], v[96:99]
ds_read_b64_tr_b16 v[32:33], v12 offset:32768
ds_read_b128 a[56:59], v22 offset:24576
v_mfma_f32_16x16x32_bf16 v[100:103], v[36:39], a[196:199], v[100:103]
ds_read_b64_tr_b16 v[34:35], v12 offset:33024
ds_read_b128 a[60:63], v22 offset:25600
v_mfma_f32_16x16x32_bf16 v[104:107], v[36:39], a[200:203], v[104:107]
buffer_load_dwordx4 v4, s[28:31], s45 offen lds
ds_read_b128 a[64:67], v21 offset:32768
v_mfma_f32_16x16x32_bf16 v[108:111], v[36:39], a[204:207], v[108:111]
s_add_u32 m0, s44, 126976
s_add_u32 s45, s52, 0
ds_read_b128 a[68:71], v21 offset:33792
s_waitcnt lgkmcnt(15)
v_mfma_f32_16x16x32_bf16 v[80:83], v[40:43], a[208:211], v[80:83]
ds_read_b64_tr_b16 v[36:37], v12 offset:34816
ds_read_b128 a[72:75], v22 offset:32768
v_mfma_f32_16x16x32_bf16 v[84:87], v[40:43], a[212:215], v[84:87]
ds_read_b64_tr_b16 v[38:39], v12 offset:35072
ds_read_b128 a[76:79], v22 offset:33792
v_mfma_f32_16x16x32_bf16 v[88:91], v[40:43], a[216:219], v[88:91]
buffer_load_dwordx4 v5, s[32:35], s45 offen lds
ds_read_b128 a[80:83], v21 offset:40960
v_mfma_f32_16x16x32_bf16 v[92:95], v[40:43], a[220:223], v[92:95]
ds_read_b128 a[84:87], v21 offset:41984
ds_read_b128 a[88:91], v22 offset:40960
s_waitcnt lgkmcnt(15)
v_mfma_f32_16x16x32_bf16 v[96:99], v[44:47], a[208:211], v[96:99]
ds_read_b64_tr_b16 v[40:41], v12 offset:36864
ds_read_b128 a[92:95], v22 offset:41984
v_mfma_f32_16x16x32_bf16 v[100:103], v[44:47], a[212:215], v[100:103]
ds_read_b64_tr_b16 v[42:43], v12 offset:37120
ds_read_b128 a[96:99], v21 offset:49152
v_mfma_f32_16x16x32_bf16 v[104:107], v[44:47], a[216:219], v[104:107]
ds_read_b128 a[100:103], v21 offset:50176
ds_read_b128 a[104:107], v22 offset:49152
v_mfma_f32_16x16x32_bf16 v[108:111], v[44:47], a[220:223], v[108:111]
s_add_u32 m0, s44, 131072
s_add_u32 s45, s52, 0
ds_read_b128 a[108:111], v22 offset:50176
s_waitcnt lgkmcnt(15)
v_mfma_f32_16x16x32_bf16 v[80:83], v[32:35], a[224:227], v[80:83]
ds_read_b64_tr_b16 v[44:45], v12 offset:38912
ds_read_b128 a[112:115], v21 offset:57344
v_mfma_f32_16x16x32_bf16 v[84:87], v[32:35], a[228:231], v[84:87]
ds_read_b64_tr_b16 v[46:47], v12 offset:39168
ds_read_b128 a[116:119], v21 offset:58368
v_mfma_f32_16x16x32_bf16 v[88:91], v[32:35], a[232:235], v[88:91]
buffer_load_dwordx4 v6, s[32:35], s45 offen lds
ds_read_b128 a[120:123], v22 offset:57344
v_mfma_f32_16x16x32_bf16 v[92:95], v[32:35], a[236:239], v[92:95]
ds_read_b128 a[124:127], v22 offset:58368
s_mul_i32 s46, s3, 36864
s_waitcnt lgkmcnt(15)
v_mfma_f32_16x16x32_bf16 v[96:99], v[36:39], a[224:227], v[96:99]
ds_read_b64_tr_b16 v[32:33], v12 offset:40960
s_lshl_b32 s47, s7, 10
v_mfma_f32_16x16x32_bf16 v[100:103], v[36:39], a[228:231], v[100:103]
ds_read_b64_tr_b16 v[34:35], v12 offset:41216
s_add_u32 s46, s46, s47
v_mfma_f32_16x16x32_bf16 v[104:107], v[36:39], a[232:235], v[104:107]
v_add_u32 v1, s46, v23
s_xor_b32 s46, s3, 1
v_mfma_f32_16x16x32_bf16 v[108:111], v[36:39], a[236:239], v[108:111]
s_mul_i32 s46, s46, 36864
s_add_u32 s46, s46, s47
s_waitcnt lgkmcnt(12)
v_mfma_f32_16x16x32_bf16 v[80:83], v[40:43], a[240:243], v[80:83]
ds_read_b64_tr_b16 v[36:37], v12 offset:43008
v_add_u32 v2, s46, v23
v_mfma_f32_16x16x32_bf16 v[84:87], v[40:43], a[244:247], v[84:87]
ds_read_b64_tr_b16 v[38:39], v12 offset:43264
v_mfma_f32_16x16x32_bf16 v[88:91], v[40:43], a[248:251], v[88:91]
v_mfma_f32_16x16x32_bf16 v[92:95], v[40:43], a[252:255], v[92:95]
s_waitcnt lgkmcnt(7)
v_mfma_f32_16x16x32_bf16 v[96:99], v[44:47], a[240:243], v[96:99]
ds_read_b64_tr_b16 v[40:41], v12 offset:45056
v_mfma_f32_16x16x32_bf16 v[100:103], v[44:47], a[244:247], v[100:103]
ds_read_b64_tr_b16 v[42:43], v12 offset:45312
v_mfma_f32_16x16x32_bf16 v[104:107], v[44:47], a[248:251], v[104:107]
v_mfma_f32_16x16x32_bf16 v[108:111], v[44:47], a[252:255], v[108:111]
s_waitcnt lgkmcnt(4)
v_mfma_f32_16x16x32_bf16 v[80:83], v[32:35], v[144:147], v[80:83]
ds_read_b64_tr_b16 v[44:45], v12 offset:47104
v_mfma_f32_16x16x32_bf16 v[84:87], v[32:35], v[148:151], v[84:87]
ds_read_b64_tr_b16 v[46:47], v12 offset:47360
v_mfma_f32_16x16x32_bf16 v[88:91], v[32:35], v[152:155], v[88:91]
v_mfma_f32_16x16x32_bf16 v[92:95], v[32:35], v[156:159], v[92:95]
s_waitcnt lgkmcnt(4)
v_mfma_f32_16x16x32_bf16 v[96:99], v[36:39], v[144:147], v[96:99]
s_waitcnt vmcnt(5) lgkmcnt(0)
s_barrier
ds_read_b64_tr_b16 v[32:33], v7 offset:40960
v_mfma_f32_16x16x32_bf16 v[100:103], v[36:39], v[148:151], v[100:103]
ds_read_b64_tr_b16 v[34:35], v7 offset:41216
v_mfma_f32_16x16x32_bf16 v[104:107], v[36:39], v[152:155], v[104:107]
v_mfma_f32_16x16x32_bf16 v[108:111], v[36:39], v[156:159], v[108:111]
s_add_u32 m0, s44, 139264
s_add_u32 s45, s50, 128
v_mfma_f32_16x16x32_bf16 v[80:83], v[40:43], v[160:163], v[80:83]
ds_read_b64_tr_b16 v[36:37], v9 offset:40960
v_mfma_f32_16x16x32_bf16 v[84:87], v[40:43], v[164:167], v[84:87]
ds_read_b64_tr_b16 v[38:39], v9 offset:41216
v_mfma_f32_16x16x32_bf16 v[88:91], v[40:43], v[168:171], v[88:91]
buffer_load_dwordx4 v4, s[28:31], s45 offen lds
v_mfma_f32_16x16x32_bf16 v[92:95], v[40:43], v[172:175], v[92:95]
s_add_u32 m0, s44, 143360
s_add_u32 s45, s50, 36992
v_mfma_f32_16x16x32_bf16 v[96:99], v[44:47], v[160:163], v[96:99]
ds_read_b64_tr_b16 v[40:41], v7 offset:45056
v_mfma_f32_16x16x32_bf16 v[100:103], v[44:47], v[164:167], v[100:103]
ds_read_b64_tr_b16 v[42:43], v7 offset:45312
v_mfma_f32_16x16x32_bf16 v[104:107], v[44:47], v[168:171], v[104:107]
buffer_load_dwordx4 v4, s[28:31], s45 offen lds
v_mfma_f32_16x16x32_bf16 v[108:111], v[44:47], v[172:175], v[108:111]
s_waitcnt lgkmcnt(4)
v_mfma_f32_16x16x32_bf16 v[112:115], v[32:35], a[0:3], 0
ds_read_b64_tr_b16 v[44:45], v9 offset:45056
v_mfma_f32_16x16x32_bf16 v[116:119], v[32:35], a[4:7], 0
ds_read_b64_tr_b16 v[46:47], v9 offset:45312
v_mfma_f32_16x16x32_bf16 v[120:123], v[32:35], a[8:11], 0
v_mfma_f32_16x16x32_bf16 v[124:127], v[32:35], a[12:15], 0
s_add_u32 m0, s44, 147456
s_add_u32 s45, s50, 73856
s_waitcnt lgkmcnt(4)
v_mfma_f32_16x16x32_bf16 v[128:131], v[36:39], a[0:3], 0
ds_read_b64_tr_b16 v[32:33], v7 offset:49152
v_subrev_u32 v11, 49152, v7
v_subrev_u32 v12, 49152, v9
v_mfma_f32_16x16x32_bf16 v[132:135], v[36:39], a[4:7], 0
ds_read_b64_tr_b16 v[34:35], v7 offset:49408
v_subrev_u32 v3, 49152, v24
v_max_f32 v80, 0, v80
v_mfma_f32_16x16x32_bf16 v[136:139], v[36:39], a[8:11], 0
buffer_load_dwordx4 v4, s[28:31], s45 offen lds
v_max_f32 v81, 0, v81
v_max_f32 v82, 0, v82
v_mfma_f32_16x16x32_bf16 v[140:143], v[36:39], a[12:15], 0
s_add_u32 m0, s44, 151552
s_add_u32 s45, s50, 110720
v_max_f32 v83, 0, v83
v_mul_f32 v80, v96, v80
s_waitcnt lgkmcnt(4)
v_mfma_f32_16x16x32_bf16 v[112:115], v[40:43], a[16:19], v[112:115]
ds_read_b64_tr_b16 v[36:37], v9 offset:49152
v_mul_f32 v81, v97, v81
v_mul_f32 v82, v98, v82
v_mfma_f32_16x16x32_bf16 v[116:119], v[40:43], a[20:23], v[116:119]
ds_read_b64_tr_b16 v[38:39], v9 offset:49408
v_mul_f32 v83, v99, v83
v_cvt_pk_bf16_f32 v96, v80, v81
v_mfma_f32_16x16x32_bf16 v[120:123], v[40:43], a[24:27], v[120:123]
buffer_load_dwordx4 v4, s[28:31], s45 offen lds
v_cvt_pk_bf16_f32 v97, v82, v83
ds_write_b64 v15, v[96:97] offset:0
v_mfma_f32_16x16x32_bf16 v[124:127], v[40:43], a[28:31], v[124:127]
v_max_f32 v84, 0, v84
v_max_f32 v85, 0, v85
v_max_f32 v86, 0, v86
s_waitcnt lgkmcnt(5)
v_mfma_f32_16x16x32_bf16 v[128:131], v[44:47], a[16:19], v[128:131]
ds_read_b64_tr_b16 v[40:41], v7 offset:53248
v_max_f32 v87, 0, v87
v_mul_f32 v84, v100, v84
v_mfma_f32_16x16x32_bf16 v[132:135], v[44:47], a[20:23], v[132:135]
ds_read_b64_tr_b16 v[42:43], v7 offset:53504
v_mul_f32 v85, v101, v85
v_mul_f32 v86, v102, v86
v_mfma_f32_16x16x32_bf16 v[136:139], v[44:47], a[24:27], v[136:139]
v_mul_f32 v87, v103, v87
v_cvt_pk_bf16_f32 v100, v84, v85
v_cvt_pk_bf16_f32 v101, v86, v87
v_mfma_f32_16x16x32_bf16 v[140:143], v[44:47], a[28:31], v[140:143]
s_add_u32 m0, s44, 155648
s_add_u32 s45, s50, 147584
ds_write_b64 v15, v[100:101] offset:1024
v_max_f32 v88, 0, v88
s_waitcnt lgkmcnt(6)
v_mfma_f32_16x16x32_bf16 v[112:115], v[32:35], a[32:35], v[112:115]
ds_read_b64_tr_b16 v[44:45], v9 offset:53248
v_max_f32 v89, 0, v89
v_max_f32 v90, 0, v90
v_mfma_f32_16x16x32_bf16 v[116:119], v[32:35], a[36:39], v[116:119]
ds_read_b64_tr_b16 v[46:47], v9 offset:53504
v_max_f32 v91, 0, v91
v_mul_f32 v88, v104, v88
v_mfma_f32_16x16x32_bf16 v[120:123], v[32:35], a[40:43], v[120:123]
buffer_load_dwordx4 v4, s[28:31], s45 offen lds
v_mul_f32 v89, v105, v89
v_mul_f32 v90, v106, v90
v_mfma_f32_16x16x32_bf16 v[124:127], v[32:35], a[44:47], v[124:127]
s_add_u32 m0, s44, 159744
s_add_u32 s45, s50, 184448
v_mul_f32 v91, v107, v91
v_cvt_pk_bf16_f32 v104, v88, v89
s_waitcnt lgkmcnt(6)
v_mfma_f32_16x16x32_bf16 v[128:131], v[36:39], a[32:35], v[128:131]
ds_read_b64_tr_b16 v[32:33], v7 offset:57344
v_cvt_pk_bf16_f32 v105, v90, v91
v_mfma_f32_16x16x32_bf16 v[132:135], v[36:39], a[36:39], v[132:135]
ds_read_b64_tr_b16 v[34:35], v7 offset:57600
ds_write_b64 v16, v[104:105] offset:0
v_mfma_f32_16x16x32_bf16 v[136:139], v[36:39], a[40:43], v[136:139]
buffer_load_dwordx4 v4, s[28:31], s45 offen lds
v_max_f32 v92, 0, v92
v_mfma_f32_16x16x32_bf16 v[140:143], v[36:39], a[44:47], v[140:143]
v_max_f32 v93, 0, v93
v_max_f32 v94, 0, v94
s_waitcnt lgkmcnt(6)
v_mfma_f32_16x16x32_bf16 v[112:115], v[40:43], a[48:51], v[112:115]
ds_read_b64_tr_b16 v[36:37], v9 offset:57344
v_max_f32 v95, 0, v95
v_mfma_f32_16x16x32_bf16 v[116:119], v[40:43], a[52:55], v[116:119]
ds_read_b64_tr_b16 v[38:39], v9 offset:57600
v_mul_f32 v92, v108, v92
v_mfma_f32_16x16x32_bf16 v[120:123], v[40:43], a[56:59], v[120:123]
v_mul_f32 v93, v109, v93
v_mul_f32 v94, v110, v94
v_mfma_f32_16x16x32_bf16 v[124:127], v[40:43], a[60:63], v[124:127]
v_mul_f32 v95, v111, v95
v_cvt_pk_bf16_f32 v108, v92, v93
s_waitcnt lgkmcnt(5)
v_mfma_f32_16x16x32_bf16 v[128:131], v[44:47], a[48:51], v[128:131]
ds_read_b64_tr_b16 v[40:41], v7 offset:61440
v_cvt_pk_bf16_f32 v109, v94, v95
v_mfma_f32_16x16x32_bf16 v[132:135], v[44:47], a[52:55], v[132:135]
ds_read_b64_tr_b16 v[42:43], v7 offset:61696
ds_write_b64 v16, v[108:109] offset:1024
v_mfma_f32_16x16x32_bf16 v[136:139], v[44:47], a[56:59], v[136:139]
v_mfma_f32_16x16x32_bf16 v[140:143], v[44:47], a[60:63], v[140:143]
s_waitcnt lgkmcnt(6)
v_mfma_f32_16x16x32_bf16 v[112:115], v[32:35], a[64:67], v[112:115]
ds_read_b64_tr_b16 v[44:45], v9 offset:61440
v_mfma_f32_16x16x32_bf16 v[116:119], v[32:35], a[68:71], v[116:119]
ds_read_b64_tr_b16 v[46:47], v9 offset:61696
v_mfma_f32_16x16x32_bf16 v[120:123], v[32:35], a[72:75], v[120:123]
v_mfma_f32_16x16x32_bf16 v[124:127], v[32:35], a[76:79], v[124:127]
s_waitcnt lgkmcnt(5)
v_mfma_f32_16x16x32_bf16 v[128:131], v[36:39], a[64:67], v[128:131]
s_waitcnt vmcnt(6) lgkmcnt(0)
s_barrier
ds_read_b64_tr_b16 v[32:33], v8 offset:0
v_mfma_f32_16x16x32_bf16 v[132:135], v[36:39], a[68:71], v[132:135]
ds_read_b64_tr_b16 v[34:35], v8 offset:256
v_mfma_f32_16x16x32_bf16 v[136:139], v[36:39], a[72:75], v[136:139]
v_mfma_f32_16x16x32_bf16 v[140:143], v[36:39], a[76:79], v[140:143]
s_add_u32 m0, s44, 90112
s_add_u32 s45, s50, 221312
v_mfma_f32_16x16x32_bf16 v[112:115], v[40:43], a[80:83], v[112:115]
ds_read_b64_tr_b16 v[36:37], v10 offset:0
ds_read_b128 a[128:131], v13 offset:0
v_mfma_f32_16x16x32_bf16 v[116:119], v[40:43], a[84:87], v[116:119]
ds_read_b64_tr_b16 v[38:39], v10 offset:256
ds_read_b128 a[132:135], v13 offset:1024
v_mfma_f32_16x16x32_bf16 v[120:123], v[40:43], a[88:91], v[120:123]
buffer_load_dwordx4 v4, s[28:31], s45 offen lds
ds_read_b128 a[136:139], v14 offset:0
v_mfma_f32_16x16x32_bf16 v[124:127], v[40:43], a[92:95], v[124:127]
s_add_u32 m0, s44, 94208
s_add_u32 s45, s50, 258176
ds_read_b128 a[140:143], v14 offset:1024
v_mfma_f32_16x16x32_bf16 v[128:131], v[44:47], a[80:83], v[128:131]
ds_read_b64_tr_b16 v[40:41], v8 offset:4096
ds_read_b128 a[144:147], v13 offset:8192
v_mfma_f32_16x16x32_bf16 v[132:135], v[44:47], a[84:87], v[132:135]
ds_read_b64_tr_b16 v[42:43], v8 offset:4352
ds_read_b128 a[148:151], v13 offset:9216
v_mfma_f32_16x16x32_bf16 v[136:139], v[44:47], a[88:91], v[136:139]
buffer_load_dwordx4 v4, s[28:31], s45 offen lds
ds_read_b128 a[152:155], v14 offset:8192
v_mfma_f32_16x16x32_bf16 v[140:143], v[44:47], a[92:95], v[140:143]
s_add_u32 m0, s44, 98304
s_add_u32 s45, s51, 128
ds_read_b128 a[156:159], v14 offset:9216
s_waitcnt lgkmcnt(12)
v_mfma_f32_16x16x32_bf16 v[112:115], v[32:35], a[96:99], v[112:115]
ds_read_b64_tr_b16 v[44:45], v10 offset:4096
v_mov_b32 v144, 0
v_mfma_f32_16x16x32_bf16 v[116:119], v[32:35], a[100:103], v[116:119]
ds_read_b64_tr_b16 v[46:47], v10 offset:4352
v_mov_b32 v145, 0
v_mfma_f32_16x16x32_bf16 v[120:123], v[32:35], a[104:107], v[120:123]
buffer_load_dwordx4 v4, s[28:31], s45 offen lds
v_mov_b32 v146, 0
v_mfma_f32_16x16x32_bf16 v[124:127], v[32:35], a[108:111], v[124:127]
s_add_u32 m0, s44, 102400
s_add_u32 s45, s52, 128
v_mov_b32 v147, 0
s_waitcnt lgkmcnt(11)
v_mfma_f32_16x16x32_bf16 v[128:131], v[36:39], a[96:99], v[128:131]
ds_read_b64_tr_b16 v[32:33], v8 offset:8192
v_mov_b32 v148, 0
v_mfma_f32_16x16x32_bf16 v[132:135], v[36:39], a[100:103], v[132:135]
ds_read_b64_tr_b16 v[34:35], v8 offset:8448
v_mov_b32 v149, 0
v_mfma_f32_16x16x32_bf16 v[136:139], v[36:39], a[104:107], v[136:139]
buffer_load_dwordx4 v5, s[32:35], s45 offen lds
v_mov_b32 v150, 0
v_mfma_f32_16x16x32_bf16 v[140:143], v[36:39], a[108:111], v[140:143]
s_add_u32 m0, s44, 106496
s_add_u32 s45, s52, 128
v_mov_b32 v151, 0
s_waitcnt lgkmcnt(7)
v_mfma_f32_16x16x32_bf16 v[112:115], v[40:43], a[112:115], v[112:115]
ds_read_b64_tr_b16 v[36:37], v10 offset:8192
s_mov_b64 exec, 0xffff
ds_read_b64 v[144:145], v17 offset:0
ds_read_b64 v[146:147], v17 offset:128
ds_read_b64 v[148:149], v18 offset:0
ds_read_b64 v[150:151], v18 offset:128
s_mov_b64 exec, -1
v_mfma_f32_16x16x32_bf16 v[116:119], v[40:43], a[116:119], v[116:119]
ds_read_b64_tr_b16 v[38:39], v10 offset:8448
v_mfma_f32_16x16x32_bf16 v[120:123], v[40:43], a[120:123], v[120:123]
buffer_load_dwordx4 v6, s[32:35], s45 offen lds
v_mfma_f32_16x16x32_bf16 v[124:127], v[40:43], a[124:127], v[124:127]
s_add_u32 m0, s44, 0
s_add_u32 s45, s50, 256
s_waitcnt lgkmcnt(8)
v_mfma_f32_16x16x32_bf16 v[128:131], v[44:47], a[112:115], v[128:131]
ds_read_b64_tr_b16 v[40:41], v8 offset:12288
v_mfma_f32_16x16x32_bf16 v[132:135], v[44:47], a[116:119], v[132:135]
ds_read_b64_tr_b16 v[42:43], v8 offset:12544
v_mfma_f32_16x16x32_bf16 v[136:139], v[44:47], a[120:123], v[136:139]
buffer_load_dwordx4 v4, s[28:31], s45 offen lds
v_mfma_f32_16x16x32_bf16 v[140:143], v[44:47], a[124:127], v[140:143]
s_add_u32 m0, s44, 4096
s_add_u32 s45, s50, 37120
s_waitcnt lgkmcnt(8)
v_mfma_f32_16x16x32_bf16 v[112:115], v[32:35], a[128:131], v[112:115]
ds_read_b64_tr_b16 v[44:45], v10 offset:12288
v_and_b32 v28, 15, v0
v_mfma_f32_16x16x32_bf16 v[116:119], v[32:35], a[132:135], v[116:119]
ds_read_b64_tr_b16 v[46:47], v10 offset:12544
v_lshrrev_b32 v30, 4, v0
v_mfma_f32_16x16x32_bf16 v[120:123], v[32:35], a[136:139], v[120:123]
buffer_load_dwordx4 v4, s[28:31], s45 offen lds
v_mul_u32_u24 v26, 2359296, v30
v_mfma_f32_16x16x32_bf16 v[124:127], v[32:35], a[140:143], v[124:127]
s_add_u32 m0, s44, 8192
s_add_u32 s45, s50, 73984
v_lshl_add_u32 v26, v28, 4, v26
s_waitcnt lgkmcnt(4)
v_mfma_f32_16x16x32_bf16 v[128:131], v[36:39], a[128:131], v[128:131]
ds_read_b64_tr_b16 v[32:33], v25 offset:16384
s_lshl_b32 s46, s3, 8
v_add_u32 v26, s46, v26
v_mfma_f32_16x16x32_bf16 v[132:135], v[36:39], a[132:135], v[132:135]
s_lshr_b32 s46, s4, 1
s_mul_i32 s69, s46, 18432
s_mul_i32 s68, s5, 147456
s_add_u32 s69, s69, s68
s_and_b32 s46, s4, 1
s_lshl_b32 s47, s46, 10
s_add_u32 s68, s69, s47
s_lshl_b32 s46, s46, 6
s_add_u32 s69, s69, s46
s_lshl_b32 s46, s3, 3
s_add_u32 s69, s69, s46
v_mul_u32_u24 v31, 1152, v28
v_mfma_f32_16x16x32_bf16 v[136:139], v[36:39], a[136:139], v[136:139]
buffer_load_dwordx4 v4, s[28:31], s45 offen lds
v_lshrrev_b32 v29, 1, v30
v_mfma_f32_16x16x32_bf16 v[140:143], v[36:39], a[140:143], v[140:143]
s_add_u32 m0, s44, 12288
s_add_u32 s45, s50, 110848
v_lshl_add_u32 v31, v29, 7, v31
s_waitcnt lgkmcnt(3)
v_mfma_f32_16x16x32_bf16 v[112:115], v[40:43], a[144:147], v[112:115]
ds_read_b64_tr_b16 v[36:37], v25 offset:16416
v_and_b32 v29, 1, v30
v_mfma_f32_16x16x32_bf16 v[116:119], v[40:43], a[148:151], v[116:119]
v_lshl_add_u32 v31, v29, 5, v31
v_mov_b32 v182, 0x3f80
v_mfma_f32_16x16x32_bf16 v[120:123], v[40:43], a[152:155], v[120:123]
buffer_load_dwordx4 v4, s[28:31], s45 offen lds
v_mov_b32 v183, 0x3f800000
v_mfma_f32_16x16x32_bf16 v[124:127], v[40:43], a[156:159], v[124:127]
v_cmp_eq_u32 vcc, 0, v28
s_nop 1
v_cndmask_b32 v184, 0, v182, vcc
v_cmp_eq_u32 vcc, 1, v28
s_nop 1
v_cndmask_b32 v184, v184, v183, vcc
s_waitcnt lgkmcnt(2)
v_mfma_f32_16x16x32_bf16 v[128:131], v[44:47], a[144:147], v[128:131]
s_waitcnt vmcnt(9) lgkmcnt(0)
s_barrier
ds_read_b64_tr_b16 v[40:41], v8 offset:24576
v_cmp_eq_u32 vcc, 2, v28
s_nop 1
v_cndmask_b32 v185, 0, v182, vcc
v_mfma_f32_16x16x32_bf16 v[132:135], v[44:47], a[148:151], v[132:135]
ds_read_b64_tr_b16 v[42:43], v8 offset:24832
v_cmp_eq_u32 vcc, 3, v28
s_nop 1
v_cndmask_b32 v185, v185, v183, vcc
v_mfma_f32_16x16x32_bf16 v[136:139], v[44:47], a[152:155], v[136:139]
v_cmp_eq_u32 vcc, 4, v28
s_nop 1
v_cndmask_b32 v186, 0, v182, vcc
v_cmp_eq_u32 vcc, 5, v28
s_nop 1
v_cndmask_b32 v186, v186, v183, vcc
v_mfma_f32_16x16x32_bf16 v[140:143], v[44:47], a[156:159], v[140:143]
s_add_u32 m0, s44, 16384
s_add_u32 s45, s50, 147712
v_cmp_eq_u32 vcc, 6, v28
s_nop 1
v_cndmask_b32 v187, 0, v182, vcc
v_mfma_f32_16x16x16_bf16 v[112:115], v[32:33], v[144:145], v[112:115]
ds_read_b64_tr_b16 v[44:45], v10 offset:24576
v_cmp_eq_u32 vcc, 7, v28
s_nop 1
v_cndmask_b32 v187, v187, v183, vcc
v_mfma_f32_16x16x16_bf16 v[116:119], v[32:33], v[146:147], v[116:119]
ds_read_b64_tr_b16 v[46:47], v10 offset:24832
v_cmp_eq_u32 vcc, 8, v28
s_nop 1
v_cndmask_b32 v188, 0, v182, vcc
v_mfma_f32_16x16x16_bf16 v[120:123], v[32:33], v[148:149], v[120:123]
buffer_load_dwordx4 v4, s[28:31], s45 offen lds
v_cmp_eq_u32 vcc, 9, v28
s_nop 1
v_cndmask_b32 v188, v188, v183, vcc
v_mfma_f32_16x16x16_bf16 v[124:127], v[32:33], v[150:151], v[124:127]
s_add_u32 m0, s44, 20480
s_add_u32 s45, s50, 184576
v_cmp_eq_u32 vcc, 10, v28
s_nop 1
v_cndmask_b32 v189, 0, v182, vcc
v_mfma_f32_16x16x16_bf16 v[128:131], v[36:37], v[144:145], v[128:131]
ds_read_b64_tr_b16 v[32:33], v8 offset:28672
v_cmp_eq_u32 vcc, 11, v28
s_nop 1
v_cndmask_b32 v189, v189, v183, vcc
v_mfma_f32_16x16x16_bf16 v[132:135], v[36:37], v[146:147], v[132:135]
ds_read_b64_tr_b16 v[34:35], v8 offset:28928
v_cmp_eq_u32 vcc, 12, v28
s_nop 1
v_cndmask_b32 v190, 0, v182, vcc
v_mfma_f32_16x16x16_bf16 v[136:139], v[36:37], v[148:149], v[136:139]
buffer_load_dwordx4 v4, s[28:31], s45 offen lds
v_cmp_eq_u32 vcc, 13, v28
s_nop 1
v_cndmask_b32 v190, v190, v183, vcc
v_mfma_f32_16x16x16_bf16 v[140:143], v[36:37], v[150:151], v[140:143]
s_add_u32 m0, s44, 24576
s_add_u32 s45, s50, 221440
v_cmp_eq_u32 vcc, 14, v28
s_nop 1
v_cndmask_b32 v191, 0, v182, vcc
s_waitcnt lgkmcnt(4)
v_mfma_f32_16x16x32_bf16 v[48:51], v[40:43], a[0:3], 0
ds_read_b64_tr_b16 v[36:37], v10 offset:28672
v_cmp_eq_u32 vcc, 15, v28
s_nop 1
v_cndmask_b32 v191, v191, v183, vcc
v_mfma_f32_16x16x32_bf16 v[52:55], v[40:43], a[4:7], 0
ds_read_b64_tr_b16 v[38:39], v10 offset:28928
buffer_load_dwordx2 v[172:173], v31, s[8:11], s69 offen offset:0
v_mfma_f32_16x16x32_bf16 v[56:59], v[40:43], a[8:11], 0
buffer_load_dwordx4 v4, s[28:31], s45 offen lds
buffer_load_dwordx2 v[174:175], v31, s[8:11], s69 offen offset:256
v_mfma_f32_16x16x32_bf16 v[60:63], v[40:43], a[12:15], 0
s_add_u32 m0, s44, 28672
s_add_u32 s45, s50, 258304
buffer_load_dwordx2 v[176:177], v31, s[8:11], s69 offen offset:512
s_waitcnt lgkmcnt(4)
v_mfma_f32_16x16x32_bf16 v[64:67], v[44:47], a[0:3], 0
ds_read_b64_tr_b16 v[40:41], v8 offset:32768
buffer_load_dwordx2 v[178:179], v31, s[8:11], s69 offen offset:768
v_mfma_f32_16x16x32_bf16 v[68:71], v[44:47], a[4:7], 0
ds_read_b64_tr_b16 v[42:43], v8 offset:33024
buffer_load_dwordx2 v[180:181], v31, s[8:11], s69 offen offset:1024
v_mfma_f32_16x16x32_bf16 v[72:75], v[44:47], a[8:11], 0
buffer_load_dwordx4 v4, s[28:31], s45 offen lds
v_cvt_pk_bf16_f32 v112, v112, v113
v_mfma_f32_16x16x32_bf16 v[76:79], v[44:47], a[12:15], 0
s_add_u32 m0, s44, 32768
s_add_u32 s45, s51, 256
v_cvt_pk_bf16_f32 v113, v114, v115
s_waitcnt lgkmcnt(4)
v_mfma_f32_16x16x32_bf16 v[48:51], v[32:35], a[16:19], v[48:51]
ds_read_b64_tr_b16 v[44:45], v10 offset:32768
v_cvt_pk_bf16_f32 v114, v128, v129
v_mfma_f32_16x16x32_bf16 v[52:55], v[32:35], a[20:23], v[52:55]
ds_read_b64_tr_b16 v[46:47], v10 offset:33024
v_cvt_pk_bf16_f32 v115, v130, v131
v_mfma_f32_16x16x32_bf16 v[56:59], v[32:35], a[24:27], v[56:59]
buffer_load_dwordx4 v4, s[28:31], s45 offen lds
s_add_u32 s46, s53, 0
buffer_store_dwordx4 v[112:115], v1, s[36:39], s46 offen sc1
v_mfma_f32_16x16x32_bf16 v[60:63], v[32:35], a[28:31], v[60:63]
s_add_u32 m0, s44, 36864
s_add_u32 s45, s52, 256
v_cvt_pk_bf16_f32 v116, v116, v117
s_waitcnt lgkmcnt(4)
v_mfma_f32_16x16x32_bf16 v[64:67], v[36:39], a[16:19], v[64:67]
ds_read_b64_tr_b16 v[32:33], v8 offset:36864
v_cvt_pk_bf16_f32 v117, v118, v119
v_mfma_f32_16x16x32_bf16 v[68:71], v[36:39], a[20:23], v[68:71]
ds_read_b64_tr_b16 v[34:35], v8 offset:37120
v_cvt_pk_bf16_f32 v118, v132, v133
v_mfma_f32_16x16x32_bf16 v[72:75], v[36:39], a[24:27], v[72:75]
buffer_load_dwordx4 v5, s[32:35], s45 offen lds
v_cvt_pk_bf16_f32 v119, v134, v135
v_mfma_f32_16x16x32_bf16 v[76:79], v[36:39], a[28:31], v[76:79]
s_add_u32 m0, s44, 40960
s_add_u32 s45, s52, 256
s_add_u32 s46, s53, 18432
buffer_store_dwordx4 v[116:119], v1, s[36:39], s46 offen sc1
s_waitcnt lgkmcnt(4)
v_mfma_f32_16x16x32_bf16 v[48:51], v[40:43], a[32:35], v[48:51]
ds_read_b64_tr_b16 v[36:37], v10 offset:36864
v_cvt_pk_bf16_f32 v120, v120, v121
v_mfma_f32_16x16x32_bf16 v[52:55], v[40:43], a[36:39], v[52:55]
ds_read_b64_tr_b16 v[38:39], v10 offset:37120
v_cvt_pk_bf16_f32 v121, v122, v123
v_mfma_f32_16x16x32_bf16 v[56:59], v[40:43], a[40:43], v[56:59]
buffer_load_dwordx4 v6, s[32:35], s45 offen lds
v_cvt_pk_bf16_f32 v122, v136, v137
v_mfma_f32_16x16x32_bf16 v[60:63], v[40:43], a[44:47], v[60:63]
s_add_u32 m0, s44, 114688
s_add_u32 s45, s50, 384
v_cvt_pk_bf16_f32 v123, v138, v139
s_waitcnt lgkmcnt(4)
v_mfma_f32_16x16x32_bf16 v[64:67], v[44:47], a[32:35], v[64:67]
ds_read_b64_tr_b16 v[40:41], v8 offset:40960
s_add_u32 s46, s53, 0
buffer_store_dwordx4 v[120:123], v2, s[36:39], s46 offen sc1
v_mfma_f32_16x16x32_bf16 v[68:71], v[44:47], a[36:39], v[68:71]
ds_read_b64_tr_b16 v[42:43], v8 offset:41216
v_cvt_pk_bf16_f32 v124, v124, v125
v_mfma_f32_16x16x32_bf16 v[72:75], v[44:47], a[40:43], v[72:75]
buffer_load_dwordx4 v4, s[28:31], s45 offen lds
v_cvt_pk_bf16_f32 v125, v126, v127
v_mfma_f32_16x16x32_bf16 v[76:79], v[44:47], a[44:47], v[76:79]
s_add_u32 m0, s44, 118784
s_add_u32 s45, s50, 37248
v_cvt_pk_bf16_f32 v126, v140, v141
s_waitcnt lgkmcnt(4)
v_mfma_f32_16x16x32_bf16 v[48:51], v[32:35], a[48:51], v[48:51]
ds_read_b64_tr_b16 v[44:45], v10 offset:40960
v_cvt_pk_bf16_f32 v127, v142, v143
v_mfma_f32_16x16x32_bf16 v[52:55], v[32:35], a[52:55], v[52:55]
ds_read_b64_tr_b16 v[46:47], v10 offset:41216
s_add_u32 s46, s53, 18432
buffer_store_dwordx4 v[124:127], v2, s[36:39], s46 offen sc1
v_mfma_f32_16x16x32_bf16 v[56:59], v[32:35], a[56:59], v[56:59]
buffer_load_dwordx4 v4, s[28:31], s45 offen lds
v_mfma_f32_16x16x32_bf16 v[60:63], v[32:35], a[60:63], v[60:63]
s_add_u32 m0, s44, 122880
s_add_u32 s45, s50, 74112
s_waitcnt lgkmcnt(4)
v_mfma_f32_16x16x32_bf16 v[64:67], v[36:39], a[48:51], v[64:67]
ds_read_b64_tr_b16 v[32:33], v8 offset:45056
v_mfma_f32_16x16x32_bf16 v[68:71], v[36:39], a[52:55], v[68:71]
ds_read_b64_tr_b16 v[34:35], v8 offset:45312
v_mfma_f32_16x16x32_bf16 v[72:75], v[36:39], a[56:59], v[72:75]
buffer_load_dwordx4 v4, s[28:31], s45 offen lds
v_mfma_f32_16x16x32_bf16 v[76:79], v[36:39], a[60:63], v[76:79]
s_add_u32 m0, s44, 126976
s_add_u32 s45, s50, 110976
s_waitcnt lgkmcnt(4)
v_mfma_f32_16x16x32_bf16 v[48:51], v[40:43], a[64:67], v[48:51]
ds_read_b64_tr_b16 v[36:37], v10 offset:45056
v_mfma_f32_16x16x32_bf16 v[52:55], v[40:43], a[68:71], v[52:55]
ds_read_b64_tr_b16 v[38:39], v10 offset:45312
v_mfma_f32_16x16x32_bf16 v[56:59], v[40:43], a[72:75], v[56:59]
buffer_load_dwordx4 v4, s[28:31], s45 offen lds
v_mfma_f32_16x16x32_bf16 v[60:63], v[40:43], a[76:79], v[60:63]
s_waitcnt lgkmcnt(4)
v_mfma_f32_16x16x32_bf16 v[64:67], v[44:47], a[64:67], v[64:67]
s_waitcnt vmcnt(24) lgkmcnt(0)
s_barrier
ds_read_b64_tr_b16 v[40:41], v7 offset:40960
v_mfma_f32_16x16x32_bf16 v[68:71], v[44:47], a[68:71], v[68:71]
ds_read_b64_tr_b16 v[42:43], v7 offset:41216
v_mfma_f32_16x16x32_bf16 v[72:75], v[44:47], a[72:75], v[72:75]
v_mfma_f32_16x16x32_bf16 v[76:79], v[44:47], a[76:79], v[76:79]
s_add_u32 m0, s44, 131072
s_add_u32 s45, s50, 147840
v_mfma_f32_16x16x32_bf16 v[48:51], v[32:35], a[80:83], v[48:51]
ds_read_b64_tr_b16 v[44:45], v9 offset:40960
v_mfma_f32_16x16x32_bf16 v[52:55], v[32:35], a[84:87], v[52:55]
ds_read_b64_tr_b16 v[46:47], v9 offset:41216
v_mfma_f32_16x16x32_bf16 v[56:59], v[32:35], a[88:91], v[56:59]
buffer_load_dwordx4 v4, s[28:31], s45 offen lds
v_mfma_f32_16x16x32_bf16 v[60:63], v[32:35], a[92:95], v[60:63]
s_add_u32 m0, s44, 135168
s_add_u32 s45, s50, 184704
v_mfma_f32_16x16x32_bf16 v[64:67], v[36:39], a[80:83], v[64:67]
ds_read_b64_tr_b16 v[32:33], v7 offset:45056
v_mfma_f32_16x16x32_bf16 v[68:71], v[36:39], a[84:87], v[68:71]
ds_read_b64_tr_b16 v[34:35], v7 offset:45312
v_mfma_f32_16x16x32_bf16 v[72:75], v[36:39], a[88:91], v[72:75]
buffer_load_dwordx4 v4, s[28:31], s45 offen lds
v_mfma_f32_16x16x32_bf16 v[76:79], v[36:39], a[92:95], v[76:79]
s_add_u32 m0, s44, 49152
s_add_u32 s45, s50, 221568
s_waitcnt lgkmcnt(4)
v_mfma_f32_16x16x32_bf16 v[48:51], v[40:43], a[96:99], v[48:51]
ds_read_b64_tr_b16 v[36:37], v9 offset:45056
v_mfma_f32_16x16x32_bf16 v[52:55], v[40:43], a[100:103], v[52:55]
ds_read_b64_tr_b16 v[38:39], v9 offset:45312
v_mfma_f32_16x16x32_bf16 v[56:59], v[40:43], a[104:107], v[56:59]
buffer_load_dwordx4 v4, s[28:31], s45 offen lds
v_mfma_f32_16x16x32_bf16 v[60:63], v[40:43], a[108:111], v[60:63]
s_add_u32 m0, s44, 53248
s_add_u32 s45, s50, 258432
s_waitcnt lgkmcnt(4)
v_mfma_f32_16x16x32_bf16 v[64:67], v[44:47], a[96:99], v[64:67]
ds_read_b64_tr_b16 v[40:41], v7 offset:49152
v_mfma_f32_16x16x32_bf16 v[68:71], v[44:47], a[100:103], v[68:71]
ds_read_b64_tr_b16 v[42:43], v7 offset:49408
v_mfma_f32_16x16x32_bf16 v[72:75], v[44:47], a[104:107], v[72:75]
buffer_load_dwordx4 v4, s[28:31], s45 offen lds
v_mfma_f32_16x16x32_bf16 v[76:79], v[44:47], a[108:111], v[76:79]
s_add_u32 m0, s44, 57344
s_add_u32 s45, s51, 384
s_waitcnt lgkmcnt(4)
v_mfma_f32_16x16x32_bf16 v[48:51], v[32:35], a[112:115], v[48:51]
ds_read_b64_tr_b16 v[44:45], v9 offset:49152
v_mfma_f32_16x16x32_bf16 v[52:55], v[32:35], a[116:119], v[52:55]
ds_read_b64_tr_b16 v[46:47], v9 offset:49408
v_mfma_f32_16x16x32_bf16 v[56:59], v[32:35], a[120:123], v[56:59]
buffer_load_dwordx4 v4, s[28:31], s45 offen lds
v_mfma_f32_16x16x32_bf16 v[60:63], v[32:35], a[124:127], v[60:63]
s_add_u32 m0, s44, 61440
s_add_u32 s45, s52, 384
s_waitcnt lgkmcnt(4)
v_mfma_f32_16x16x32_bf16 v[64:67], v[36:39], a[112:115], v[64:67]
ds_read_b64_tr_b16 v[32:33], v7 offset:53248
v_mfma_f32_16x16x32_bf16 v[68:71], v[36:39], a[116:119], v[68:71]
ds_read_b64_tr_b16 v[34:35], v7 offset:53504
v_mfma_f32_16x16x32_bf16 v[72:75], v[36:39], a[120:123], v[72:75]
buffer_load_dwordx4 v5, s[32:35], s45 offen lds
v_mfma_f32_16x16x32_bf16 v[76:79], v[36:39], a[124:127], v[76:79]
s_add_u32 m0, s44, 65536
s_add_u32 s45, s52, 384
s_waitcnt lgkmcnt(4)
v_mfma_f32_16x16x32_bf16 v[48:51], v[40:43], a[128:131], v[48:51]
ds_read_b64_tr_b16 v[36:37], v9 offset:53248
v_mfma_f32_16x16x32_bf16 v[52:55], v[40:43], a[132:135], v[52:55]
ds_read_b64_tr_b16 v[38:39], v9 offset:53504
v_mfma_f32_16x16x32_bf16 v[56:59], v[40:43], a[136:139], v[56:59]
buffer_load_dwordx4 v6, s[32:35], s45 offen lds
v_mfma_f32_16x16x32_bf16 v[60:63], v[40:43], a[140:143], v[60:63]
s_add_u32 m0, s44, 139264
s_add_u32 s45, s50, 512
s_waitcnt lgkmcnt(4)
v_mfma_f32_16x16x32_bf16 v[64:67], v[44:47], a[128:131], v[64:67]
ds_read_b64_tr_b16 v[40:41], v24 offset:57344
s_and_b32 s88, s5, 3
s_lshl_b32 s71, 16, s88
s_and_b32 s88, s5, 12
s_cmp_eq_u32 s3, 0
s_cselect_b32 s71, s71, 0
s_cselect_b32 s88, s88, 1024
v_lshl_add_u32 v27, v28, 4, s88
v_mfma_f32_16x16x32_bf16 v[68:71], v[44:47], a[132:135], v[68:71]
buffer_load_ubyte v28, v27, s[40:43], 0 offen sc1
v_mfma_f32_16x16x32_bf16 v[72:75], v[44:47], a[136:139], v[72:75]
buffer_load_dwordx4 v4, s[28:31], s45 offen lds
v_mfma_f32_16x16x32_bf16 v[76:79], v[44:47], a[140:143], v[76:79]
s_add_u32 m0, s44, 143360
s_add_u32 s45, s50, 37376
s_waitcnt lgkmcnt(3)
v_mfma_f32_16x16x32_bf16 v[48:51], v[32:35], a[144:147], v[48:51]
ds_read_b64_tr_b16 v[44:45], v24 offset:57376
v_mfma_f32_16x16x32_bf16 v[52:55], v[32:35], a[148:151], v[52:55]
v_mfma_f32_16x16x32_bf16 v[56:59], v[32:35], a[152:155], v[56:59]
buffer_load_dwordx4 v4, s[28:31], s45 offen lds
v_mfma_f32_16x16x32_bf16 v[60:63], v[32:35], a[156:159], v[60:63]
s_waitcnt lgkmcnt(2)
v_mfma_f32_16x16x32_bf16 v[64:67], v[36:39], a[144:147], v[64:67]
s_waitcnt vmcnt(28) lgkmcnt(0)
s_barrier
ds_read_b64_tr_b16 v[32:33], v11 offset:0
v_mfma_f32_16x16x32_bf16 v[68:71], v[36:39], a[148:151], v[68:71]
ds_read_b64_tr_b16 v[34:35], v11 offset:256
v_mfma_f32_16x16x32_bf16 v[72:75], v[36:39], a[152:155], v[72:75]
v_mfma_f32_16x16x32_bf16 v[76:79], v[36:39], a[156:159], v[76:79]
s_add_u32 m0, s44, 147456
s_add_u32 s45, s50, 74240
v_mfma_f32_16x16x16_bf16 v[48:51], v[40:41], v[144:145], v[48:51]
ds_read_b64_tr_b16 v[36:37], v12 offset:0
v_mfma_f32_16x16x16_bf16 v[52:55], v[40:41], v[146:147], v[52:55]
ds_read_b64_tr_b16 v[38:39], v12 offset:256
v_mfma_f32_16x16x16_bf16 v[56:59], v[40:41], v[148:149], v[56:59]
buffer_load_dwordx4 v4, s[28:31], s45 offen lds
v_mfma_f32_16x16x16_bf16 v[60:63], v[40:41], v[150:151], v[60:63]
s_add_u32 m0, s44, 151552
s_add_u32 s45, s50, 111104
v_mfma_f32_16x16x16_bf16 v[64:67], v[44:45], v[144:145], v[64:67]
ds_read_b64_tr_b16 v[40:41], v11 offset:4096
v_mfma_f32_16x16x16_bf16 v[68:71], v[44:45], v[146:147], v[68:71]
ds_read_b64_tr_b16 v[42:43], v11 offset:4352
v_mfma_f32_16x16x16_bf16 v[72:75], v[44:45], v[148:149], v[72:75]
buffer_load_dwordx4 v4, s[28:31], s45 offen lds
v_mfma_f32_16x16x16_bf16 v[76:79], v[44:45], v[150:151], v[76:79]
s_add_u32 m0, s44, 155648
s_add_u32 s45, s50, 147968
s_waitcnt lgkmcnt(4)
v_mfma_f32_16x16x32_bf16 v[112:115], v[32:35], a[0:3], 0
ds_read_b64_tr_b16 v[44:45], v12 offset:4096
v_mfma_f32_16x16x32_bf16 v[116:119], v[32:35], a[4:7], 0
ds_read_b64_tr_b16 v[46:47], v12 offset:4352
v_mfma_f32_16x16x32_bf16 v[120:123], v[32:35], a[8:11], 0
buffer_load_dwordx4 v4, s[28:31], s45 offen lds
v_mfma_f32_16x16x32_bf16 v[124:127], v[32:35], a[12:15], 0
s_add_u32 m0, s44, 159744
s_add_u32 s45, s50, 184832
s_waitcnt lgkmcnt(4)
v_mfma_f32_16x16x32_bf16 v[128:131], v[36:39], a[0:3], 0
ds_read_b64_tr_b16 v[32:33], v11 offset:8192
v_cvt_pk_bf16_f32 v48, v48, v49
v_mfma_f32_16x16x32_bf16 v[132:135], v[36:39], a[4:7], 0
ds_read_b64_tr_b16 v[34:35], v11 offset:8448
v_cvt_pk_bf16_f32 v49, v50, v51
v_mfma_f32_16x16x32_bf16 v[136:139], v[36:39], a[8:11], 0
buffer_load_dwordx4 v4, s[28:31], s45 offen lds
v_cvt_pk_bf16_f32 v50, v64, v65
v_mfma_f32_16x16x32_bf16 v[140:143], v[36:39], a[12:15], 0
s_add_u32 m0, s44, 90112
s_add_u32 s45, s50, 221696
v_cvt_pk_bf16_f32 v51, v66, v67
s_waitcnt lgkmcnt(4)
v_mfma_f32_16x16x32_bf16 v[112:115], v[40:43], a[16:19], v[112:115]
ds_read_b64_tr_b16 v[36:37], v12 offset:8192
s_add_u32 s46, s53, 2048
buffer_store_dwordx4 v[48:51], v1, s[36:39], s46 offen sc1
v_mfma_f32_16x16x32_bf16 v[116:119], v[40:43], a[20:23], v[116:119]
ds_read_b64_tr_b16 v[38:39], v12 offset:8448
v_cvt_pk_bf16_f32 v52, v52, v53
v_mfma_f32_16x16x32_bf16 v[120:123], v[40:43], a[24:27], v[120:123]
buffer_load_dwordx4 v4, s[28:31], s45 offen lds
v_cvt_pk_bf16_f32 v53, v54, v55
v_mfma_f32_16x16x32_bf16 v[124:127], v[40:43], a[28:31], v[124:127]
s_add_u32 m0, s44, 94208
s_add_u32 s45, s50, 258560
v_cvt_pk_bf16_f32 v54, v68, v69
s_waitcnt lgkmcnt(4)
v_mfma_f32_16x16x32_bf16 v[128:131], v[44:47], a[16:19], v[128:131]
ds_read_b64_tr_b16 v[40:41], v11 offset:12288
v_cvt_pk_bf16_f32 v55, v70, v71
v_mfma_f32_16x16x32_bf16 v[132:135], v[44:47], a[20:23], v[132:135]
ds_read_b64_tr_b16 v[42:43], v11 offset:12544
s_add_u32 s46, s53, 20480
buffer_store_dwordx4 v[52:55], v1, s[36:39], s46 offen sc1
v_mfma_f32_16x16x32_bf16 v[136:139], v[44:47], a[24:27], v[136:139]
buffer_load_dwordx4 v4, s[28:31], s45 offen lds
v_cvt_pk_bf16_f32 v56, v56, v57
v_mfma_f32_16x16x32_bf16 v[140:143], v[44:47], a[28:31], v[140:143]
s_add_u32 m0, s44, 98304
s_add_u32 s45, s51, 512
v_cvt_pk_bf16_f32 v57, v58, v59
s_waitcnt lgkmcnt(4)
v_mfma_f32_16x16x32_bf16 v[112:115], v[32:35], a[32:35], v[112:115]
ds_read_b64_tr_b16 v[44:45], v12 offset:12288
v_cvt_pk_bf16_f32 v58, v72, v73
v_mfma_f32_16x16x32_bf16 v[116:119], v[32:35], a[36:39], v[116:119]
ds_read_b64_tr_b16 v[46:47], v12 offset:12544
v_cvt_pk_bf16_f32 v59, v74, v75
v_mfma_f32_16x16x32_bf16 v[120:123], v[32:35], a[40:43], v[120:123]
buffer_load_dwordx4 v4, s[28:31], s45 offen lds
s_add_u32 s46, s53, 2048
buffer_store_dwordx4 v[56:59], v2, s[36:39], s46 offen sc1
v_mfma_f32_16x16x32_bf16 v[124:127], v[32:35], a[44:47], v[124:127]
s_add_u32 m0, s44, 102400
s_add_u32 s45, s52, 512
v_cvt_pk_bf16_f32 v60, v60, v61
s_waitcnt lgkmcnt(4)
v_mfma_f32_16x16x32_bf16 v[128:131], v[36:39], a[32:35], v[128:131]
ds_read_b64_tr_b16 v[32:33], v11 offset:16384
v_cvt_pk_bf16_f32 v61, v62, v63
v_mfma_f32_16x16x32_bf16 v[132:135], v[36:39], a[36:39], v[132:135]
ds_read_b64_tr_b16 v[34:35], v11 offset:16640
v_cvt_pk_bf16_f32 v62, v76, v77
v_mfma_f32_16x16x32_bf16 v[136:139], v[36:39], a[40:43], v[136:139]
buffer_load_dwordx4 v5, s[32:35], s45 offen lds
v_cvt_pk_bf16_f32 v63, v78, v79
v_mfma_f32_16x16x32_bf16 v[140:143], v[36:39], a[44:47], v[140:143]
s_add_u32 m0, s44, 106496
s_add_u32 s45, s52, 512
s_add_u32 s46, s53, 20480
buffer_store_dwordx4 v[60:63], v2, s[36:39], s46 offen sc1
s_waitcnt lgkmcnt(4)
v_mfma_f32_16x16x32_bf16 v[112:115], v[40:43], a[48:51], v[112:115]
ds_read_b64_tr_b16 v[36:37], v12 offset:16384
v_mfma_f32_16x16x32_bf16 v[116:119], v[40:43], a[52:55], v[116:119]
ds_read_b64_tr_b16 v[38:39], v12 offset:16640
v_mfma_f32_16x16x32_bf16 v[120:123], v[40:43], a[56:59], v[120:123]
buffer_load_dwordx4 v6, s[32:35], s45 offen lds
v_mfma_f32_16x16x32_bf16 v[124:127], v[40:43], a[60:63], v[124:127]
s_waitcnt lgkmcnt(4)
v_mfma_f32_16x16x32_bf16 v[128:131], v[44:47], a[48:51], v[128:131]
ds_read_b64_tr_b16 v[40:41], v11 offset:20480
v_mfma_f32_16x16x32_bf16 v[132:135], v[44:47], a[52:55], v[132:135]
ds_read_b64_tr_b16 v[42:43], v11 offset:20736
v_mfma_f32_16x16x32_bf16 v[136:139], v[44:47], a[56:59], v[136:139]
v_mfma_f32_16x16x32_bf16 v[140:143], v[44:47], a[60:63], v[140:143]
s_waitcnt lgkmcnt(4)
v_mfma_f32_16x16x32_bf16 v[112:115], v[32:35], a[64:67], v[112:115]
ds_read_b64_tr_b16 v[44:45], v12 offset:20480
v_mfma_f32_16x16x32_bf16 v[116:119], v[32:35], a[68:71], v[116:119]
ds_read_b64_tr_b16 v[46:47], v12 offset:20736
v_mfma_f32_16x16x32_bf16 v[120:123], v[32:35], a[72:75], v[120:123]
v_mfma_f32_16x16x32_bf16 v[124:127], v[32:35], a[76:79], v[124:127]
s_waitcnt lgkmcnt(4)
v_mfma_f32_16x16x32_bf16 v[128:131], v[36:39], a[64:67], v[128:131]
s_waitcnt vmcnt(29) lgkmcnt(0)
s_barrier
ds_read_b64_tr_b16 v[32:33], v11 offset:24576
v_mfma_f32_16x16x32_bf16 v[132:135], v[36:39], a[68:71], v[132:135]
ds_read_b64_tr_b16 v[34:35], v11 offset:24832
v_mfma_f32_16x16x32_bf16 v[136:139], v[36:39], a[72:75], v[136:139]
v_mfma_f32_16x16x32_bf16 v[140:143], v[36:39], a[76:79], v[140:143]
s_add_u32 m0, s44, 0
s_add_u32 s45, s50, 640
v_mfma_f32_16x16x32_bf16 v[112:115], v[40:43], a[80:83], v[112:115]
ds_read_b64_tr_b16 v[36:37], v12 offset:24576
v_mfma_f32_16x16x32_bf16 v[116:119], v[40:43], a[84:87], v[116:119]
ds_read_b64_tr_b16 v[38:39], v12 offset:24832
v_mfma_f32_16x16x32_bf16 v[120:123], v[40:43], a[88:91], v[120:123]
buffer_load_dwordx4 v4, s[28:31], s45 offen lds
v_mfma_f32_16x16x32_bf16 v[124:127], v[40:43], a[92:95], v[124:127]
s_add_u32 m0, s44, 4096
s_add_u32 s45, s50, 37504
v_mfma_f32_16x16x32_bf16 v[128:131], v[44:47], a[80:83], v[128:131]
ds_read_b64_tr_b16 v[40:41], v11 offset:28672
v_mfma_f32_16x16x32_bf16 v[132:135], v[44:47], a[84:87], v[132:135]
ds_read_b64_tr_b16 v[42:43], v11 offset:28928
v_mfma_f32_16x16x32_bf16 v[136:139], v[44:47], a[88:91], v[136:139]
buffer_load_dwordx4 v4, s[28:31], s45 offen lds
v_mfma_f32_16x16x32_bf16 v[140:143], v[44:47], a[92:95], v[140:143]
s_add_u32 m0, s44, 8192
s_add_u32 s45, s50, 74368
s_waitcnt lgkmcnt(4)
v_mfma_f32_16x16x32_bf16 v[112:115], v[32:35], a[96:99], v[112:115]
ds_read_b64_tr_b16 v[44:45], v12 offset:28672
v_mfma_f32_16x16x32_bf16 v[116:119], v[32:35], a[100:103], v[116:119]
ds_read_b64_tr_b16 v[46:47], v12 offset:28928
v_mfma_f32_16x16x32_bf16 v[120:123], v[32:35], a[104:107], v[120:123]
buffer_load_dwordx4 v4, s[28:31], s45 offen lds
v_mfma_f32_16x16x32_bf16 v[124:127], v[32:35], a[108:111], v[124:127]
s_add_u32 m0, s44, 12288
s_add_u32 s45, s50, 111232
s_waitcnt lgkmcnt(4)
v_mfma_f32_16x16x32_bf16 v[128:131], v[36:39], a[96:99], v[128:131]
ds_read_b64_tr_b16 v[32:33], v11 offset:32768
v_mfma_f32_16x16x32_bf16 v[132:135], v[36:39], a[100:103], v[132:135]
ds_read_b64_tr_b16 v[34:35], v11 offset:33024
v_mfma_f32_16x16x32_bf16 v[136:139], v[36:39], a[104:107], v[136:139]
buffer_load_dwordx4 v4, s[28:31], s45 offen lds
v_mfma_f32_16x16x32_bf16 v[140:143], v[36:39], a[108:111], v[140:143]
s_add_u32 m0, s44, 16384
s_add_u32 s45, s50, 148096
s_waitcnt lgkmcnt(4)
v_mfma_f32_16x16x32_bf16 v[112:115], v[40:43], a[112:115], v[112:115]
ds_read_b64_tr_b16 v[36:37], v12 offset:32768
v_mfma_f32_16x16x32_bf16 v[116:119], v[40:43], a[116:119], v[116:119]
ds_read_b64_tr_b16 v[38:39], v12 offset:33024
v_mfma_f32_16x16x32_bf16 v[120:123], v[40:43], a[120:123], v[120:123]
buffer_load_dwordx4 v4, s[28:31], s45 offen lds
v_mfma_f32_16x16x32_bf16 v[124:127], v[40:43], a[124:127], v[124:127]
s_add_u32 m0, s44, 20480
s_add_u32 s45, s50, 184960
s_waitcnt lgkmcnt(4)
v_mfma_f32_16x16x32_bf16 v[128:131], v[44:47], a[112:115], v[128:131]
ds_read_b64_tr_b16 v[40:41], v11 offset:36864
v_mfma_f32_16x16x32_bf16 v[132:135], v[44:47], a[116:119], v[132:135]
ds_read_b64_tr_b16 v[42:43], v11 offset:37120
v_mfma_f32_16x16x32_bf16 v[136:139], v[44:47], a[120:123], v[136:139]
buffer_load_dwordx4 v4, s[28:31], s45 offen lds
v_mfma_f32_16x16x32_bf16 v[140:143], v[44:47], a[124:127], v[140:143]
s_waitcnt lgkmcnt(4)
v_mfma_f32_16x16x32_bf16 v[112:115], v[32:35], a[128:131], v[112:115]
ds_read_b64_tr_b16 v[44:45], v12 offset:36864
v_mfma_f32_16x16x32_bf16 v[116:119], v[32:35], a[132:135], v[116:119]
ds_read_b64_tr_b16 v[46:47], v12 offset:37120
v_mfma_f32_16x16x32_bf16 v[120:123], v[32:35], a[136:139], v[120:123]
v_mfma_f32_16x16x32_bf16 v[124:127], v[32:35], a[140:143], v[124:127]
s_waitcnt lgkmcnt(4)
v_mfma_f32_16x16x32_bf16 v[128:131], v[36:39], a[128:131], v[128:131]
ds_read_b64_tr_b16 v[32:33], v3 offset:40960
s_waitcnt vmcnt(21)
v_and_b32 v28, s71, v28
v_cmp_ne_u32 vcc, s71, v28
s_cbranch_vccnz L1_spin1
L1_back1:
v_mfma_f32_16x16x32_bf16 v[132:135], v[36:39], a[132:135], v[132:135]
v_mfma_f32_16x16x32_bf16 v[136:139], v[36:39], a[136:139], v[136:139]
v_mfma_f32_16x16x32_bf16 v[140:143], v[36:39], a[140:143], v[140:143]
s_waitcnt lgkmcnt(3)
v_mfma_f32_16x16x32_bf16 v[112:115], v[40:43], a[144:147], v[112:115]
ds_read_b64_tr_b16 v[36:37], v3 offset:40992
v_mfma_f32_16x16x32_bf16 v[116:119], v[40:43], a[148:151], v[116:119]
v_mfma_f32_16x16x32_bf16 v[120:123], v[40:43], a[152:155], v[120:123]
v_mfma_f32_16x16x32_bf16 v[124:127], v[40:43], a[156:159], v[124:127]
s_waitcnt lgkmcnt(2)
v_mfma_f32_16x16x32_bf16 v[128:131], v[44:47], a[144:147], v[128:131]
s_waitcnt lgkmcnt(0)
s_barrier
ds_read_b64_tr_b16 v[40:41], v8 offset:0
v_mfma_f32_16x16x32_bf16 v[132:135], v[44:47], a[148:151], v[132:135]
ds_read_b64_tr_b16 v[42:43], v8 offset:256
v_mfma_f32_16x16x32_bf16 v[136:139], v[44:47], a[152:155], v[136:139]
v_mfma_f32_16x16x32_bf16 v[140:143], v[44:47], a[156:159], v[140:143]
s_add_u32 m0, s44, 24576
s_add_u32 s45, s50, 221824
v_mfma_f32_16x16x16_bf16 v[112:115], v[32:33], v[144:145], v[112:115]
ds_read_b64_tr_b16 v[44:45], v10 offset:0
v_mfma_f32_16x16x16_bf16 v[116:119], v[32:33], v[146:147], v[116:119]
ds_read_b64_tr_b16 v[46:47], v10 offset:256
v_mfma_f32_16x16x16_bf16 v[120:123], v[32:33], v[148:149], v[120:123]
buffer_load_dwordx4 v4, s[28:31], s45 offen lds
v_mfma_f32_16x16x16_bf16 v[124:127], v[32:33], v[150:151], v[124:127]
s_add_u32 m0, s44, 28672
s_add_u32 s45, s50, 258688
v_mfma_f32_16x16x16_bf16 v[128:131], v[36:37], v[144:145], v[128:131]
ds_read_b64_tr_b16 v[32:33], v8 offset:4096
v_mfma_f32_16x16x16_bf16 v[132:135], v[36:37], v[146:147], v[132:135]
ds_read_b64_tr_b16 v[34:35], v8 offset:4352
v_mfma_f32_16x16x16_bf16 v[136:139], v[36:37], v[148:149], v[136:139]
buffer_load_dwordx4 v4, s[28:31], s45 offen lds
v_mfma_f32_16x16x16_bf16 v[140:143], v[36:37], v[150:151], v[140:143]
s_add_u32 m0, s44, 32768
s_add_u32 s45, s51, 640
s_waitcnt lgkmcnt(4)
v_mfma_f32_16x16x32_bf16 v[48:51], v[40:43], a[0:3], 0
ds_read_b64_tr_b16 v[36:37], v10 offset:4096
v_lshlrev_b32 v152, 16, v172
v_and_b32 v153, s63, v172
v_mfma_f32_16x16x32_bf16 v[52:55], v[40:43], a[4:7], 0
ds_read_b64_tr_b16 v[38:39], v10 offset:4352
v_lshlrev_b32 v154, 16, v173
v_and_b32 v155, s63, v173
v_mfma_f32_16x16x32_bf16 v[56:59], v[40:43], a[8:11], 0
buffer_load_dwordx4 v4, s[28:31], s45 offen lds
v_lshlrev_b32 v156, 16, v174
v_and_b32 v157, s63, v174
v_mfma_f32_16x16x32_bf16 v[60:63], v[40:43], a[12:15], 0
s_add_u32 m0, s44, 36864
s_add_u32 s45, s52, 640
v_lshlrev_b32 v158, 16, v175
v_and_b32 v159, s63, v175
s_waitcnt lgkmcnt(4)
v_mfma_f32_16x16x32_bf16 v[64:67], v[44:47], a[0:3], 0
ds_read_b64_tr_b16 v[40:41], v8 offset:8192
v_cvt_pk_bf16_f32 v112, v112, v113
v_mfma_f32_16x16x32_bf16 v[68:71], v[44:47], a[4:7], 0
ds_read_b64_tr_b16 v[42:43], v8 offset:8448
v_cvt_pk_bf16_f32 v113, v114, v115
v_mfma_f32_16x16x32_bf16 v[72:75], v[44:47], a[8:11], 0
buffer_load_dwordx4 v5, s[32:35], s45 offen lds
v_cvt_pk_bf16_f32 v114, v128, v129
v_mfma_f32_16x16x32_bf16 v[76:79], v[44:47], a[12:15], 0
s_add_u32 m0, s44, 40960
s_add_u32 s45, s52, 640
v_cvt_pk_bf16_f32 v115, v130, v131
s_waitcnt lgkmcnt(4)
v_mfma_f32_16x16x32_bf16 v[48:51], v[32:35], a[16:19], v[48:51]
ds_read_b64_tr_b16 v[44:45], v10 offset:8192
s_add_u32 s46, s53, 4096
buffer_store_dwordx4 v[112:115], v1, s[36:39], s46 offen sc1
v_mfma_f32_16x16x32_bf16 v[52:55], v[32:35], a[20:23], v[52:55]
ds_read_b64_tr_b16 v[46:47], v10 offset:8448
v_cvt_pk_bf16_f32 v116, v116, v117
v_mfma_f32_16x16x32_bf16 v[56:59], v[32:35], a[24:27], v[56:59]
buffer_load_dwordx4 v6, s[32:35], s45 offen lds
v_cvt_pk_bf16_f32 v117, v118, v119
v_mfma_f32_16x16x32_bf16 v[60:63], v[32:35], a[28:31], v[60:63]
v_cvt_pk_bf16_f32 v118, v132, v133
v_cvt_pk_bf16_f32 v119, v134, v135
s_waitcnt lgkmcnt(4)
v_mfma_f32_16x16x32_bf16 v[64:67], v[36:39], a[16:19], v[64:67]
ds_read_b64_tr_b16 v[32:33], v8 offset:12288
s_add_u32 s46, s53, 22528
buffer_store_dwordx4 v[116:119], v1, s[36:39], s46 offen sc1
v_mfma_f32_16x16x32_bf16 v[68:71], v[36:39], a[20:23], v[68:71]
ds_read_b64_tr_b16 v[34:35], v8 offset:12544
v_cvt_pk_bf16_f32 v120, v120, v121
v_mfma_f32_16x16x32_bf16 v[72:75], v[36:39], a[24:27], v[72:75]
v_cvt_pk_bf16_f32 v121, v122, v123
v_cvt_pk_bf16_f32 v122, v136, v137
v_mfma_f32_16x16x32_bf16 v[76:79], v[36:39], a[28:31], v[76:79]
v_cvt_pk_bf16_f32 v123, v138, v139
s_add_u32 s46, s53, 4096
buffer_store_dwordx4 v[120:123], v2, s[36:39], s46 offen sc1
s_waitcnt lgkmcnt(4)
v_mfma_f32_16x16x32_bf16 v[48:51], v[40:43], a[32:35], v[48:51]
ds_read_b64_tr_b16 v[36:37], v10 offset:12288
v_cvt_pk_bf16_f32 v124, v124, v125
v_mfma_f32_16x16x32_bf16 v[52:55], v[40:43], a[36:39], v[52:55]
ds_read_b64_tr_b16 v[38:39], v10 offset:12544
v_cvt_pk_bf16_f32 v125, v126, v127
v_mfma_f32_16x16x32_bf16 v[56:59], v[40:43], a[40:43], v[56:59]
v_cvt_pk_bf16_f32 v126, v140, v141
v_cvt_pk_bf16_f32 v127, v142, v143
v_mfma_f32_16x16x32_bf16 v[60:63], v[40:43], a[44:47], v[60:63]
s_add_u32 s46, s53, 22528
buffer_store_dwordx4 v[124:127], v2, s[36:39], s46 offen sc1
v_lshlrev_b32 v160, 16, v176
v_and_b32 v161, s63, v176
s_waitcnt lgkmcnt(4)
v_mfma_f32_16x16x32_bf16 v[64:67], v[44:47], a[32:35], v[64:67]
ds_read_b64_tr_b16 v[40:41], v8 offset:16384
v_lshlrev_b32 v162, 16, v177
v_and_b32 v163, s63, v177
v_mfma_f32_16x16x32_bf16 v[68:71], v[44:47], a[36:39], v[68:71]
ds_read_b64_tr_b16 v[42:43], v8 offset:16640
v_lshlrev_b32 v164, 16, v178
v_and_b32 v165, s63, v178
v_mfma_f32_16x16x32_bf16 v[72:75], v[44:47], a[40:43], v[72:75]
v_lshlrev_b32 v166, 16, v179
v_and_b32 v167, s63, v179
v_lshlrev_b32 v168, 16, v180
v_and_b32 v169, s63, v180
v_mfma_f32_16x16x32_bf16 v[76:79], v[44:47], a[44:47], v[76:79]
v_lshlrev_b32 v170, 16, v181
v_and_b32 v171, s63, v181
s_add_u32 s88, s68, 0
buffer_load_dwordx4 a[160:163], v26, s[36:39], s88 offen sc1
s_waitcnt lgkmcnt(4)
v_mfma_f32_16x16x32_bf16 v[48:51], v[32:35], a[48:51], v[48:51]
ds_read_b64_tr_b16 v[44:45], v10 offset:16384
s_add_u32 s88, s68, 9437184
buffer_load_dwordx4 a[164:167], v26, s[36:39], s88 offen sc1
v_mfma_f32_16x16x32_bf16 v[52:55], v[32:35], a[52:55], v[52:55]
ds_read_b64_tr_b16 v[46:47], v10 offset:16640
s_add_u32 s88, s68, 18874368
buffer_load_dwordx4 a[168:171], v26, s[36:39], s88 offen sc1
v_mfma_f32_16x16x32_bf16 v[56:59], v[32:35], a[56:59], v[56:59]
s_add_u32 s88, s68, 28311552
buffer_load_dwordx4 a[172:175], v26, s[36:39], s88 offen sc1
v_mfma_f32_16x16x32_bf16 v[60:63], v[32:35], a[60:63], v[60:63]
s_waitcnt lgkmcnt(4)
v_mfma_f32_16x16x32_bf16 v[64:67], v[36:39], a[48:51], v[64:67]
ds_read_b64_tr_b16 v[32:33], v8 offset:20480
v_mfma_f32_16x16x32_bf16 v[68:71], v[36:39], a[52:55], v[68:71]
ds_read_b64_tr_b16 v[34:35], v8 offset:20736
v_mfma_f32_16x16x32_bf16 v[72:75], v[36:39], a[56:59], v[72:75]
v_mfma_f32_16x16x32_bf16 v[76:79], v[36:39], a[60:63], v[76:79]
s_waitcnt lgkmcnt(4)
v_mfma_f32_16x16x32_bf16 v[48:51], v[40:43], a[64:67], v[48:51]
ds_read_b64_tr_b16 v[36:37], v10 offset:20480
v_mfma_f32_16x16x32_bf16 v[52:55], v[40:43], a[68:71], v[52:55]
ds_read_b64_tr_b16 v[38:39], v10 offset:20736
v_mfma_f32_16x16x32_bf16 v[56:59], v[40:43], a[72:75], v[56:59]
v_mfma_f32_16x16x32_bf16 v[60:63], v[40:43], a[76:79], v[60:63]
s_waitcnt lgkmcnt(4)
v_mfma_f32_16x16x32_bf16 v[64:67], v[44:47], a[64:67], v[64:67]
s_waitcnt lgkmcnt(0)
s_barrier
ds_read_b64_tr_b16 v[40:41], v7 offset:0
v_mfma_f32_16x16x32_bf16 v[68:71], v[44:47], a[68:71], v[68:71]
ds_read_b64_tr_b16 v[42:43], v7 offset:256
v_mfma_f32_16x16x32_bf16 v[72:75], v[44:47], a[72:75], v[72:75]
v_mfma_f32_16x16x32_bf16 v[76:79], v[44:47], a[76:79], v[76:79]
s_add_u32 m0, s44, 114688
s_add_u32 s45, s50, 768
v_mfma_f32_16x16x32_bf16 v[48:51], v[32:35], a[80:83], v[48:51]
ds_read_b64_tr_b16 v[44:45], v9 offset:0
v_mfma_f32_16x16x32_bf16 v[52:55], v[32:35], a[84:87], v[52:55]
ds_read_b64_tr_b16 v[46:47], v9 offset:256
v_mfma_f32_16x16x32_bf16 v[56:59], v[32:35], a[88:91], v[56:59]
buffer_load_dwordx4 v4, s[28:31], s45 offen lds
v_mfma_f32_16x16x32_bf16 v[60:63], v[32:35], a[92:95], v[60:63]
s_add_u32 m0, s44, 118784
s_add_u32 s45, s50, 37632
v_mfma_f32_16x16x32_bf16 v[64:67], v[36:39], a[80:83], v[64:67]
ds_read_b64_tr_b16 v[32:33], v7 offset:4096
v_mfma_f32_16x16x32_bf16 v[68:71], v[36:39], a[84:87], v[68:71]
ds_read_b64_tr_b16 v[34:35], v7 offset:4352
v_mfma_f32_16x16x32_bf16 v[72:75], v[36:39], a[88:91], v[72:75]
buffer_load_dwordx4 v4, s[28:31], s45 offen lds
v_mfma_f32_16x16x32_bf16 v[76:79], v[36:39], a[92:95], v[76:79]
s_add_u32 m0, s44, 122880
s_add_u32 s45, s50, 74496
s_waitcnt lgkmcnt(4)
v_mfma_f32_16x16x32_bf16 v[48:51], v[40:43], a[96:99], v[48:51]
ds_read_b64_tr_b16 v[36:37], v9 offset:4096
v_mfma_f32_16x16x32_bf16 v[52:55], v[40:43], a[100:103], v[52:55]
ds_read_b64_tr_b16 v[38:39], v9 offset:4352
v_mfma_f32_16x16x32_bf16 v[56:59], v[40:43], a[104:107], v[56:59]
buffer_load_dwordx4 v4, s[28:31], s45 offen lds
v_mfma_f32_16x16x32_bf16 v[60:63], v[40:43], a[108:111], v[60:63]
s_add_u32 m0, s44, 126976
s_add_u32 s45, s50, 111360
s_waitcnt lgkmcnt(4)
v_mfma_f32_16x16x32_bf16 v[64:67], v[44:47], a[96:99], v[64:67]
ds_read_b64_tr_b16 v[40:41], v7 offset:8192
v_mfma_f32_16x16x32_bf16 v[68:71], v[44:47], a[100:103], v[68:71]
ds_read_b64_tr_b16 v[42:43], v7 offset:8448
v_mfma_f32_16x16x32_bf16 v[72:75], v[44:47], a[104:107], v[72:75]
buffer_load_dwordx4 v4, s[28:31], s45 offen lds
v_mfma_f32_16x16x32_bf16 v[76:79], v[44:47], a[108:111], v[76:79]
s_add_u32 m0, s44, 131072
s_add_u32 s45, s50, 148224
s_waitcnt lgkmcnt(4)
v_mfma_f32_16x16x32_bf16 v[48:51], v[32:35], a[112:115], v[48:51]
ds_read_b64_tr_b16 v[44:45], v9 offset:8192
v_mfma_f32_16x16x32_bf16 v[52:55], v[32:35], a[116:119], v[52:55]
ds_read_b64_tr_b16 v[46:47], v9 offset:8448
v_mfma_f32_16x16x32_bf16 v[56:59], v[32:35], a[120:123], v[56:59]
buffer_load_dwordx4 v4, s[28:31], s45 offen lds
v_mfma_f32_16x16x32_bf16 v[60:63], v[32:35], a[124:127], v[60:63]
s_add_u32 m0, s44, 135168
s_add_u32 s45, s50, 185088
s_waitcnt lgkmcnt(4)
v_mfma_f32_16x16x32_bf16 v[64:67], v[36:39], a[112:115], v[64:67]
ds_read_b64_tr_b16 v[32:33], v7 offset:12288
v_mfma_f32_16x16x32_bf16 v[68:71], v[36:39], a[116:119], v[68:71]
ds_read_b64_tr_b16 v[34:35], v7 offset:12544
v_mfma_f32_16x16x32_bf16 v[72:75], v[36:39], a[120:123], v[72:75]
buffer_load_dwordx4 v4, s[28:31], s45 offen lds
v_mfma_f32_16x16x32_bf16 v[76:79], v[36:39], a[124:127], v[76:79]
s_waitcnt lgkmcnt(4)
v_mfma_f32_16x16x32_bf16 v[48:51], v[40:43], a[128:131], v[48:51]
ds_read_b64_tr_b16 v[36:37], v9 offset:12288
v_mfma_f32_16x16x32_bf16 v[52:55], v[40:43], a[132:135], v[52:55]
ds_read_b64_tr_b16 v[38:39], v9 offset:12544
v_mfma_f32_16x16x32_bf16 v[56:59], v[40:43], a[136:139], v[56:59]
v_mfma_f32_16x16x32_bf16 v[60:63], v[40:43], a[140:143], v[60:63]
s_waitcnt lgkmcnt(4)
v_mfma_f32_16x16x32_bf16 v[64:67], v[44:47], a[128:131], v[64:67]
ds_read_b64_tr_b16 v[40:41], v24 offset:16384
v_mfma_f32_16x16x32_bf16 v[68:71], v[44:47], a[132:135], v[68:71]
v_mfma_f32_16x16x32_bf16 v[72:75], v[44:47], a[136:139], v[72:75]
v_mfma_f32_16x16x32_bf16 v[76:79], v[44:47], a[140:143], v[76:79]
s_waitcnt lgkmcnt(3)
v_mfma_f32_16x16x32_bf16 v[48:51], v[32:35], a[144:147], v[48:51]
ds_read_b64_tr_b16 v[44:45], v24 offset:16416
v_mfma_f32_16x16x32_bf16 v[52:55], v[32:35], a[148:151], v[52:55]
v_mfma_f32_16x16x32_bf16 v[56:59], v[32:35], a[152:155], v[56:59]
v_mfma_f32_16x16x32_bf16 v[60:63], v[32:35], a[156:159], v[60:63]
s_waitcnt lgkmcnt(2)
v_mfma_f32_16x16x32_bf16 v[64:67], v[36:39], a[144:147], v[64:67]
s_waitcnt vmcnt(34) lgkmcnt(0)
s_barrier
ds_read_b64_tr_b16 v[32:33], v8 offset:24576
v_mfma_f32_16x16x32_bf16 v[68:71], v[36:39], a[148:151], v[68:71]
ds_read_b64_tr_b16 v[34:35], v8 offset:24832
v_mfma_f32_16x16x32_bf16 v[72:75], v[36:39], a[152:155], v[72:75]
v_mfma_f32_16x16x32_bf16 v[76:79], v[36:39], a[156:159], v[76:79]
s_add_u32 m0, s44, 49152
s_add_u32 s45, s50, 221952
v_mfma_f32_16x16x16_bf16 v[48:51], v[40:41], v[144:145], v[48:51]
ds_read_b64_tr_b16 v[36:37], v10 offset:24576
v_mfma_f32_16x16x16_bf16 v[52:55], v[40:41], v[146:147], v[52:55]
ds_read_b64_tr_b16 v[38:39], v10 offset:24832
v_mfma_f32_16x16x16_bf16 v[56:59], v[40:41], v[148:149], v[56:59]
buffer_load_dwordx4 v4, s[28:31], s45 offen lds
v_mfma_f32_16x16x16_bf16 v[60:63], v[40:41], v[150:151], v[60:63]
s_add_u32 m0, s44, 53248
s_add_u32 s45, s50, 258816
v_mfma_f32_16x16x16_bf16 v[64:67], v[44:45], v[144:145], v[64:67]
ds_read_b64_tr_b16 v[40:41], v8 offset:28672
v_mfma_f32_16x16x16_bf16 v[68:71], v[44:45], v[146:147], v[68:71]
ds_read_b64_tr_b16 v[42:43], v8 offset:28928
v_mfma_f32_16x16x16_bf16 v[72:75], v[44:45], v[148:149], v[72:75]
buffer_load_dwordx4 v4, s[28:31], s45 offen lds
v_mfma_f32_16x16x16_bf16 v[76:79], v[44:45], v[150:151], v[76:79]
s_add_u32 m0, s44, 57344
s_add_u32 s45, s51, 768
s_waitcnt lgkmcnt(4)
v_mfma_f32_16x16x32_bf16 v[112:115], v[32:35], a[0:3], 0
ds_read_b64_tr_b16 v[44:45], v10 offset:28672
s_add_u32 s88, s68, 2048
buffer_load_dwordx4 a[176:179], v26, s[36:39], s88 offen sc1
v_mfma_f32_16x16x32_bf16 v[116:119], v[32:35], a[4:7], 0
ds_read_b64_tr_b16 v[46:47], v10 offset:28928
v_mfma_f32_16x16x32_bf16 v[120:123], v[32:35], a[8:11], 0
buffer_load_dwordx4 v4, s[28:31], s45 offen lds
v_mfma_f32_16x16x32_bf16 v[124:127], v[32:35], a[12:15], 0
s_add_u32 m0, s44, 61440
s_add_u32 s45, s52, 768
s_waitcnt lgkmcnt(4)
v_mfma_f32_16x16x32_bf16 v[128:131], v[36:39], a[0:3], 0
ds_read_b64_tr_b16 v[32:33], v8 offset:32768
v_cvt_pk_bf16_f32 v48, v48, v49
v_mfma_f32_16x16x32_bf16 v[132:135], v[36:39], a[4:7], 0
ds_read_b64_tr_b16 v[34:35], v8 offset:33024
v_cvt_pk_bf16_f32 v49, v50, v51
v_mfma_f32_16x16x32_bf16 v[136:139], v[36:39], a[8:11], 0
buffer_load_dwordx4 v5, s[32:35], s45 offen lds
v_cvt_pk_bf16_f32 v50, v64, v65
v_mfma_f32_16x16x32_bf16 v[140:143], v[36:39], a[12:15], 0
s_add_u32 m0, s44, 65536
s_add_u32 s45, s52, 768
v_cvt_pk_bf16_f32 v51, v66, v67
s_waitcnt lgkmcnt(4)
v_mfma_f32_16x16x32_bf16 v[112:115], v[40:43], a[16:19], v[112:115]
ds_read_b64_tr_b16 v[36:37], v10 offset:32768
s_add_u32 s46, s53, 6144
buffer_store_dwordx4 v[48:51], v1, s[36:39], s46 offen sc1
v_mfma_f32_16x16x32_bf16 v[116:119], v[40:43], a[20:23], v[116:119]
ds_read_b64_tr_b16 v[38:39], v10 offset:33024
v_cvt_pk_bf16_f32 v52, v52, v53
v_mfma_f32_16x16x32_bf16 v[120:123], v[40:43], a[24:27], v[120:123]
buffer_load_dwordx4 v6, s[32:35], s45 offen lds
v_cvt_pk_bf16_f32 v53, v54, v55
v_mfma_f32_16x16x32_bf16 v[124:127], v[40:43], a[28:31], v[124:127]
v_cvt_pk_bf16_f32 v54, v68, v69
v_cvt_pk_bf16_f32 v55, v70, v71
s_waitcnt lgkmcnt(4)
v_mfma_f32_16x16x32_bf16 v[128:131], v[44:47], a[16:19], v[128:131]
ds_read_b64_tr_b16 v[40:41], v8 offset:36864
s_add_u32 s46, s53, 24576
buffer_store_dwordx4 v[52:55], v1, s[36:39], s46 offen sc1
v_mfma_f32_16x16x32_bf16 v[132:135], v[44:47], a[20:23], v[132:135]
ds_read_b64_tr_b16 v[42:43], v8 offset:37120
v_cvt_pk_bf16_f32 v56, v56, v57
v_mfma_f32_16x16x32_bf16 v[136:139], v[44:47], a[24:27], v[136:139]
v_cvt_pk_bf16_f32 v57, v58, v59
v_cvt_pk_bf16_f32 v58, v72, v73
v_mfma_f32_16x16x32_bf16 v[140:143], v[44:47], a[28:31], v[140:143]
v_cvt_pk_bf16_f32 v59, v74, v75
s_add_u32 s46, s53, 6144
buffer_store_dwordx4 v[56:59], v2, s[36:39], s46 offen sc1
s_waitcnt lgkmcnt(4)
v_mfma_f32_16x16x32_bf16 v[112:115], v[32:35], a[32:35], v[112:115]
ds_read_b64_tr_b16 v[44:45], v10 offset:36864
v_cvt_pk_bf16_f32 v60, v60, v61
v_mfma_f32_16x16x32_bf16 v[116:119], v[32:35], a[36:39], v[116:119]
ds_read_b64_tr_b16 v[46:47], v10 offset:37120
v_cvt_pk_bf16_f32 v61, v62, v63
v_mfma_f32_16x16x32_bf16 v[120:123], v[32:35], a[40:43], v[120:123]
v_cvt_pk_bf16_f32 v62, v76, v77
v_cvt_pk_bf16_f32 v63, v78, v79
v_mfma_f32_16x16x32_bf16 v[124:127], v[32:35], a[44:47], v[124:127]
s_add_u32 s46, s53, 24576
buffer_store_dwordx4 v[60:63], v2, s[36:39], s46 offen sc1
s_add_u32 s88, s68, 9439232
buffer_load_dwordx4 a[180:183], v26, s[36:39], s88 offen sc1
s_waitcnt lgkmcnt(4)
v_mfma_f32_16x16x32_bf16 v[128:131], v[36:39], a[32:35], v[128:131]
ds_read_b64_tr_b16 v[32:33], v8 offset:40960
s_add_u32 s88, s68, 18876416
buffer_load_dwordx4 a[184:187], v26, s[36:39], s88 offen sc1
v_mfma_f32_16x16x32_bf16 v[132:135], v[36:39], a[36:39], v[132:135]
ds_read_b64_tr_b16 v[34:35], v8 offset:41216
v_mfma_f32_16x16x32_bf16 v[136:139], v[36:39], a[40:43], v[136:139]
v_mfma_f32_16x16x32_bf16 v[140:143], v[36:39], a[44:47], v[140:143]
s_waitcnt lgkmcnt(4)
v_mfma_f32_16x16x32_bf16 v[112:115], v[40:43], a[48:51], v[112:115]
ds_read_b64_tr_b16 v[36:37], v10 offset:40960
s_add_u32 s88, s68, 28313600
buffer_load_dwordx4 a[188:191], v26, s[36:39], s88 offen sc1
v_mfma_f32_16x16x32_bf16 v[116:119], v[40:43], a[52:55], v[116:119]
ds_read_b64_tr_b16 v[38:39], v10 offset:41216
v_mfma_f32_16x16x32_bf16 v[120:123], v[40:43], a[56:59], v[120:123]
v_mfma_f32_16x16x32_bf16 v[124:127], v[40:43], a[60:63], v[124:127]
s_waitcnt lgkmcnt(4)
v_mfma_f32_16x16x32_bf16 v[128:131], v[44:47], a[48:51], v[128:131]
ds_read_b64_tr_b16 v[40:41], v8 offset:45056
v_mfma_f32_16x16x32_bf16 v[132:135], v[44:47], a[52:55], v[132:135]
ds_read_b64_tr_b16 v[42:43], v8 offset:45312
v_mfma_f32_16x16x32_bf16 v[136:139], v[44:47], a[56:59], v[136:139]
v_mfma_f32_16x16x32_bf16 v[140:143], v[44:47], a[60:63], v[140:143]
s_waitcnt lgkmcnt(4)
v_mfma_f32_16x16x32_bf16 v[112:115], v[32:35], a[64:67], v[112:115]
ds_read_b64_tr_b16 v[44:45], v10 offset:45056
s_waitcnt vmcnt(22)
v_mfma_f32_16x16x32_bf16 v[80:83], v[184:187], a[160:163], v[152:155]
v_mfma_f32_16x16x32_bf16 v[116:119], v[32:35], a[68:71], v[116:119]
ds_read_b64_tr_b16 v[46:47], v10 offset:45312
v_mfma_f32_16x16x32_bf16 v[120:123], v[32:35], a[72:75], v[120:123]
v_mfma_f32_16x16x32_bf16 v[124:127], v[32:35], a[76:79], v[124:127]
s_waitcnt lgkmcnt(4)
v_mfma_f32_16x16x32_bf16 v[128:131], v[36:39], a[64:67], v[128:131]
s_waitcnt lgkmcnt(0)
s_barrier
ds_read_b64_tr_b16 v[32:33], v7 offset:40960
s_waitcnt vmcnt(21)
v_mfma_f32_16x16x32_bf16 v[80:83], v[184:187], a[164:167], v[80:83]
v_mfma_f32_16x16x32_bf16 v[132:135], v[36:39], a[68:71], v[132:135]
ds_read_b64_tr_b16 v[34:35], v7 offset:41216
v_mfma_f32_16x16x32_bf16 v[136:139], v[36:39], a[72:75], v[136:139]
v_mfma_f32_16x16x32_bf16 v[140:143], v[36:39], a[76:79], v[140:143]
s_add_u32 m0, s44, 139264
s_add_u32 s45, s50, 896
v_mfma_f32_16x16x32_bf16 v[112:115], v[40:43], a[80:83], v[112:115]
ds_read_b64_tr_b16 v[36:37], v9 offset:40960
s_waitcnt vmcnt(20)
v_mfma_f32_16x16x32_bf16 v[80:83], v[184:187], a[168:171], v[80:83]
v_mfma_f32_16x16x32_bf16 v[116:119], v[40:43], a[84:87], v[116:119]
ds_read_b64_tr_b16 v[38:39], v9 offset:41216
v_mfma_f32_16x16x32_bf16 v[120:123], v[40:43], a[88:91], v[120:123]
buffer_load_dwordx4 v4, s[28:31], s45 offen lds
v_mfma_f32_16x16x32_bf16 v[124:127], v[40:43], a[92:95], v[124:127]
s_add_u32 m0, s44, 143360
s_add_u32 s45, s50, 37760
v_mfma_f32_16x16x32_bf16 v[128:131], v[44:47], a[80:83], v[128:131]
ds_read_b64_tr_b16 v[40:41], v7 offset:45056
s_waitcnt vmcnt(20)
v_mfma_f32_16x16x32_bf16 v[80:83], v[184:187], a[172:175], v[80:83]
v_mfma_f32_16x16x32_bf16 v[132:135], v[44:47], a[84:87], v[132:135]
ds_read_b64_tr_b16 v[42:43], v7 offset:45312
v_mfma_f32_16x16x32_bf16 v[136:139], v[44:47], a[88:91], v[136:139]
buffer_load_dwordx4 v4, s[28:31], s45 offen lds
v_mfma_f32_16x16x32_bf16 v[140:143], v[44:47], a[92:95], v[140:143]
s_add_u32 m0, s44, 147456
s_add_u32 s45, s50, 74624
s_waitcnt lgkmcnt(4)
v_mfma_f32_16x16x32_bf16 v[112:115], v[32:35], a[96:99], v[112:115]
ds_read_b64_tr_b16 v[44:45], v9 offset:45056
v_mfma_f32_16x16x32_bf16 v[116:119], v[32:35], a[100:103], v[116:119]
ds_read_b64_tr_b16 v[46:47], v9 offset:45312
v_mfma_f32_16x16x32_bf16 v[120:123], v[32:35], a[104:107], v[120:123]
buffer_load_dwordx4 v4, s[28:31], s45 offen lds
v_mfma_f32_16x16x32_bf16 v[124:127], v[32:35], a[108:111], v[124:127]
s_add_u32 m0, s44, 151552
s_add_u32 s45, s50, 111488
s_waitcnt lgkmcnt(4)
v_mfma_f32_16x16x32_bf16 v[128:131], v[36:39], a[96:99], v[128:131]
ds_read_b64_tr_b16 v[32:33], v7 offset:49152
v_mfma_f32_16x16x32_bf16 v[132:135], v[36:39], a[100:103], v[132:135]
ds_read_b64_tr_b16 v[34:35], v7 offset:49408
v_mfma_f32_16x16x32_bf16 v[136:139], v[36:39], a[104:107], v[136:139]
buffer_load_dwordx4 v4, s[28:31], s45 offen lds
v_mfma_f32_16x16x32_bf16 v[140:143], v[36:39], a[108:111], v[140:143]
s_add_u32 m0, s44, 155648
s_add_u32 s45, s50, 148352
s_waitcnt lgkmcnt(4)
v_mfma_f32_16x16x32_bf16 v[112:115], v[40:43], a[112:115], v[112:115]
ds_read_b64_tr_b16 v[36:37], v9 offset:49152
v_cmp_u_f32 vcc, v80, v80
s_cbranch_vccnz L1_rs0
L1_rb0:
v_mfma_f32_16x16x32_bf16 v[116:119], v[40:43], a[116:119], v[116:119]
ds_read_b64_tr_b16 v[38:39], v9 offset:49408
v_mfma_f32_16x16x32_bf16 v[120:123], v[40:43], a[120:123], v[120:123]
buffer_load_dwordx4 v4, s[28:31], s45 offen lds
v_mfma_f32_16x16x32_bf16 v[124:127], v[40:43], a[124:127], v[124:127]
s_add_u32 m0, s44, 159744
s_add_u32 s45, s50, 185216
s_waitcnt lgkmcnt(4)
v_mfma_f32_16x16x32_bf16 v[128:131], v[44:47], a[112:115], v[128:131]
ds_read_b64_tr_b16 v[40:41], v7 offset:53248
v_mfma_f32_16x16x32_bf16 v[132:135], v[44:47], a[116:119], v[132:135]
ds_read_b64_tr_b16 v[42:43], v7 offset:53504
v_mfma_f32_16x16x32_bf16 v[136:139], v[44:47], a[120:123], v[136:139]
buffer_load_dwordx4 v4, s[28:31], s45 offen lds
v_mfma_f32_16x16x32_bf16 v[140:143], v[44:47], a[124:127], v[140:143]
s_waitcnt lgkmcnt(4)
v_mfma_f32_16x16x32_bf16 v[112:115], v[32:35], a[128:131], v[112:115]
ds_read_b64_tr_b16 v[44:45], v9 offset:53248
v_mfma_f32_16x16x32_bf16 v[116:119], v[32:35], a[132:135], v[116:119]
ds_read_b64_tr_b16 v[46:47], v9 offset:53504
v_mfma_f32_16x16x32_bf16 v[120:123], v[32:35], a[136:139], v[120:123]
v_mfma_f32_16x16x32_bf16 v[124:127], v[32:35], a[140:143], v[124:127]
s_waitcnt lgkmcnt(4)
v_mfma_f32_16x16x32_bf16 v[128:131], v[36:39], a[128:131], v[128:131]
ds_read_b64_tr_b16 v[32:33], v24 offset:57344
v_mfma_f32_16x16x32_bf16 v[132:135], v[36:39], a[132:135], v[132:135]
v_mfma_f32_16x16x32_bf16 v[136:139], v[36:39], a[136:139], v[136:139]
v_mfma_f32_16x16x32_bf16 v[140:143], v[36:39], a[140:143], v[140:143]
s_waitcnt lgkmcnt(3)
v_mfma_f32_16x16x32_bf16 v[112:115], v[40:43], a[144:147], v[112:115]
ds_read_b64_tr_b16 v[36:37], v24 offset:57376
v_mfma_f32_16x16x32_bf16 v[116:119], v[40:43], a[148:151], v[116:119]
v_mfma_f32_16x16x32_bf16 v[120:123], v[40:43], a[152:155], v[120:123]
v_mfma_f32_16x16x32_bf16 v[124:127], v[40:43], a[156:159], v[124:127]
s_waitcnt lgkmcnt(2)
v_mfma_f32_16x16x32_bf16 v[128:131], v[44:47], a[144:147], v[128:131]
s_waitcnt lgkmcnt(0)
s_barrier
ds_read_b64_tr_b16 v[40:41], v11 offset:0
v_mfma_f32_16x16x32_bf16 v[132:135], v[44:47], a[148:151], v[132:135]
ds_read_b64_tr_b16 v[42:43], v11 offset:256
v_mfma_f32_16x16x32_bf16 v[136:139], v[44:47], a[152:155], v[136:139]
v_mfma_f32_16x16x32_bf16 v[140:143], v[44:47], a[156:159], v[140:143]
s_add_u32 m0, s44, 90112
s_add_u32 s45, s50, 222080
v_mfma_f32_16x16x16_bf16 v[112:115], v[32:33], v[144:145], v[112:115]
ds_read_b64_tr_b16 v[44:45], v12 offset:0
v_mfma_f32_16x16x16_bf16 v[116:119], v[32:33], v[146:147], v[116:119]
ds_read_b64_tr_b16 v[46:47], v12 offset:256
v_mfma_f32_16x16x16_bf16 v[120:123], v[32:33], v[148:149], v[120:123]
buffer_load_dwordx4 v4, s[28:31], s45 offen lds
v_mfma_f32_16x16x16_bf16 v[124:127], v[32:33], v[150:151], v[124:127]
s_add_u32 m0, s44, 94208
s_add_u32 s45, s50, 258944
v_mfma_f32_16x16x16_bf16 v[128:131], v[36:37], v[144:145], v[128:131]
ds_read_b64_tr_b16 v[32:33], v11 offset:4096
v_mfma_f32_16x16x16_bf16 v[132:135], v[36:37], v[146:147], v[132:135]
ds_read_b64_tr_b16 v[34:35], v11 offset:4352
v_mfma_f32_16x16x16_bf16 v[136:139], v[36:37], v[148:149], v[136:139]
buffer_load_dwordx4 v4, s[28:31], s45 offen lds
v_mfma_f32_16x16x16_bf16 v[140:143], v[36:37], v[150:151], v[140:143]
s_add_u32 m0, s44, 98304
s_add_u32 s45, s51, 896
s_waitcnt lgkmcnt(4)
v_mfma_f32_16x16x32_bf16 v[48:51], v[40:43], a[0:3], 0
ds_read_b64_tr_b16 v[36:37], v12 offset:4096
s_add_u32 s88, s68, 4096
buffer_load_dwordx4 a[192:195], v26, s[36:39], s88 offen sc1
v_mfma_f32_16x16x32_bf16 v[52:55], v[40:43], a[4:7], 0
ds_read_b64_tr_b16 v[38:39], v12 offset:4352
v_mfma_f32_16x16x32_bf16 v[56:59], v[40:43], a[8:11], 0
buffer_load_dwordx4 v4, s[28:31], s45 offen lds
v_mfma_f32_16x16x32_bf16 v[60:63], v[40:43], a[12:15], 0
s_add_u32 m0, s44, 102400
s_add_u32 s45, s52, 896
s_waitcnt lgkmcnt(4)
v_mfma_f32_16x16x32_bf16 v[64:67], v[44:47], a[0:3], 0
ds_read_b64_tr_b16 v[40:41], v11 offset:8192
v_cvt_pk_bf16_f32 v112, v112, v113
v_mfma_f32_16x16x32_bf16 v[68:71], v[44:47], a[4:7], 0
ds_read_b64_tr_b16 v[42:43], v11 offset:8448
v_cvt_pk_bf16_f32 v113, v114, v115
v_mfma_f32_16x16x32_bf16 v[72:75], v[44:47], a[8:11], 0
buffer_load_dwordx4 v5, s[32:35], s45 offen lds
v_cvt_pk_bf16_f32 v114, v128, v129
v_mfma_f32_16x16x32_bf16 v[76:79], v[44:47], a[12:15], 0
s_add_u32 m0, s44, 106496
s_add_u32 s45, s52, 896
v_cvt_pk_bf16_f32 v115, v130, v131
s_waitcnt lgkmcnt(4)
v_mfma_f32_16x16x32_bf16 v[48:51], v[32:35], a[16:19], v[48:51]
ds_read_b64_tr_b16 v[44:45], v12 offset:8192
s_add_u32 s46, s53, 8192
buffer_store_dwordx4 v[112:115], v1, s[36:39], s46 offen sc1
v_mfma_f32_16x16x32_bf16 v[52:55], v[32:35], a[20:23], v[52:55]
ds_read_b64_tr_b16 v[46:47], v12 offset:8448
v_cvt_pk_bf16_f32 v116, v116, v117
v_mfma_f32_16x16x32_bf16 v[56:59], v[32:35], a[24:27], v[56:59]
buffer_load_dwordx4 v6, s[32:35], s45 offen lds
v_cvt_pk_bf16_f32 v117, v118, v119
v_mfma_f32_16x16x32_bf16 v[60:63], v[32:35], a[28:31], v[60:63]
v_cvt_pk_bf16_f32 v118, v132, v133
v_cvt_pk_bf16_f32 v119, v134, v135
s_waitcnt lgkmcnt(4)
v_mfma_f32_16x16x32_bf16 v[64:67], v[36:39], a[16:19], v[64:67]
ds_read_b64_tr_b16 v[32:33], v11 offset:12288
s_add_u32 s46, s53, 26624
buffer_store_dwordx4 v[116:119], v1, s[36:39], s46 offen sc1
v_mfma_f32_16x16x32_bf16 v[68:71], v[36:39], a[20:23], v[68:71]
ds_read_b64_tr_b16 v[34:35], v11 offset:12544
v_cvt_pk_bf16_f32 v120, v120, v121
v_mfma_f32_16x16x32_bf16 v[72:75], v[36:39], a[24:27], v[72:75]
v_cvt_pk_bf16_f32 v121, v122, v123
v_cvt_pk_bf16_f32 v122, v136, v137
v_mfma_f32_16x16x32_bf16 v[76:79], v[36:39], a[28:31], v[76:79]
v_cvt_pk_bf16_f32 v123, v138, v139
s_add_u32 s46, s53, 8192
buffer_store_dwordx4 v[120:123], v2, s[36:39], s46 offen sc1
s_waitcnt lgkmcnt(4)
v_mfma_f32_16x16x32_bf16 v[48:51], v[40:43], a[32:35], v[48:51]
ds_read_b64_tr_b16 v[36:37], v12 offset:12288
v_cvt_pk_bf16_f32 v124, v124, v125
v_mfma_f32_16x16x32_bf16 v[52:55], v[40:43], a[36:39], v[52:55]
ds_read_b64_tr_b16 v[38:39], v12 offset:12544
v_cvt_pk_bf16_f32 v125, v126, v127
v_mfma_f32_16x16x32_bf16 v[56:59], v[40:43], a[40:43], v[56:59]
v_cvt_pk_bf16_f32 v126, v140, v141
v_cvt_pk_bf16_f32 v127, v142, v143
v_mfma_f32_16x16x32_bf16 v[60:63], v[40:43], a[44:47], v[60:63]
s_add_u32 s46, s53, 26624
buffer_store_dwordx4 v[124:127], v2, s[36:39], s46 offen sc1
s_add_u32 s88, s68, 9441280
buffer_load_dwordx4 a[196:199], v26, s[36:39], s88 offen sc1
s_waitcnt lgkmcnt(4)
v_mfma_f32_16x16x32_bf16 v[64:67], v[44:47], a[32:35], v[64:67]
ds_read_b64_tr_b16 v[40:41], v11 offset:16384
s_add_u32 s88, s68, 18878464
buffer_load_dwordx4 a[200:203], v26, s[36:39], s88 offen sc1
v_mfma_f32_16x16x32_bf16 v[68:71], v[44:47], a[36:39], v[68:71]
ds_read_b64_tr_b16 v[42:43], v11 offset:16640
v_mfma_f32_16x16x32_bf16 v[72:75], v[44:47], a[40:43], v[72:75]
v_mfma_f32_16x16x32_bf16 v[76:79], v[44:47], a[44:47], v[76:79]
s_waitcnt lgkmcnt(4)
v_mfma_f32_16x16x32_bf16 v[48:51], v[32:35], a[48:51], v[48:51]
ds_read_b64_tr_b16 v[44:45], v12 offset:16384
s_add_u32 s88, s68, 28315648
buffer_load_dwordx4 a[204:207], v26, s[36:39], s88 offen sc1
v_mfma_f32_16x16x32_bf16 v[52:55], v[32:35], a[52:55], v[52:55]
ds_read_b64_tr_b16 v[46:47], v12 offset:16640
v_mfma_f32_16x16x32_bf16 v[56:59], v[32:35], a[56:59], v[56:59]
v_mfma_f32_16x16x32_bf16 v[60:63], v[32:35], a[60:63], v[60:63]
s_waitcnt lgkmcnt(4)
v_mfma_f32_16x16x32_bf16 v[64:67], v[36:39], a[48:51], v[64:67]
ds_read_b64_tr_b16 v[32:33], v11 offset:20480
v_mfma_f32_16x16x32_bf16 v[68:71], v[36:39], a[52:55], v[68:71]
ds_read_b64_tr_b16 v[34:35], v11 offset:20736
v_mfma_f32_16x16x32_bf16 v[72:75], v[36:39], a[56:59], v[72:75]
v_mfma_f32_16x16x32_bf16 v[76:79], v[36:39], a[60:63], v[76:79]
s_waitcnt lgkmcnt(4)
v_mfma_f32_16x16x32_bf16 v[48:51], v[40:43], a[64:67], v[48:51]
ds_read_b64_tr_b16 v[36:37], v12 offset:20480
s_waitcnt vmcnt(29)
v_mfma_f32_16x16x32_bf16 v[152:155], v[188:191], a[176:179], v[80:83]
v_mfma_f32_16x16x32_bf16 v[52:55], v[40:43], a[68:71], v[52:55]
ds_read_b64_tr_b16 v[38:39], v12 offset:20736
v_mfma_f32_16x16x32_bf16 v[56:59], v[40:43], a[72:75], v[56:59]
v_mfma_f32_16x16x32_bf16 v[60:63], v[40:43], a[76:79], v[60:63]
s_waitcnt lgkmcnt(4)
v_mfma_f32_16x16x32_bf16 v[64:67], v[44:47], a[64:67], v[64:67]
s_waitcnt lgkmcnt(0)
s_barrier
ds_read_b64_tr_b16 v[40:41], v11 offset:24576
s_waitcnt vmcnt(21)
v_mfma_f32_16x16x32_bf16 v[152:155], v[188:191], a[180:183], v[152:155]
v_mfma_f32_16x16x32_bf16 v[68:71], v[44:47], a[68:71], v[68:71]
ds_read_b64_tr_b16 v[42:43], v11 offset:24832
v_mfma_f32_16x16x32_bf16 v[72:75], v[44:47], a[72:75], v[72:75]
v_mfma_f32_16x16x32_bf16 v[76:79], v[44:47], a[76:79], v[76:79]
s_add_u32 m0, s44, 0
s_add_u32 s45, s50, 1024
v_mfma_f32_16x16x32_bf16 v[48:51], v[32:35], a[80:83], v[48:51]
ds_read_b64_tr_b16 v[44:45], v12 offset:24576
s_waitcnt vmcnt(20)
v_mfma_f32_16x16x32_bf16 v[152:155], v[188:191], a[184:187], v[152:155]
v_mfma_f32_16x16x32_bf16 v[52:55], v[32:35], a[84:87], v[52:55]
ds_read_b64_tr_b16 v[46:47], v12 offset:24832
v_mfma_f32_16x16x32_bf16 v[56:59], v[32:35], a[88:91], v[56:59]
buffer_load_dwordx4 v4, s[28:31], s45 offen lds
v_mfma_f32_16x16x32_bf16 v[60:63], v[32:35], a[92:95], v[60:63]
s_add_u32 m0, s44, 4096
s_add_u32 s45, s50, 37888
v_mfma_f32_16x16x32_bf16 v[64:67], v[36:39], a[80:83], v[64:67]
ds_read_b64_tr_b16 v[32:33], v11 offset:28672
s_waitcnt vmcnt(20)
v_mfma_f32_16x16x32_bf16 v[152:155], v[188:191], a[188:191], v[152:155]
v_mfma_f32_16x16x32_bf16 v[68:71], v[36:39], a[84:87], v[68:71]
ds_read_b64_tr_b16 v[34:35], v11 offset:28928
v_mfma_f32_16x16x32_bf16 v[72:75], v[36:39], a[88:91], v[72:75]
buffer_load_dwordx4 v4, s[28:31], s45 offen lds
v_mfma_f32_16x16x32_bf16 v[76:79], v[36:39], a[92:95], v[76:79]
s_add_u32 m0, s44, 8192
s_add_u32 s45, s50, 74752
s_waitcnt lgkmcnt(4)
v_mfma_f32_16x16x32_bf16 v[48:51], v[40:43], a[96:99], v[48:51]
ds_read_b64_tr_b16 v[36:37], v12 offset:28672
v_mfma_f32_16x16x32_bf16 v[52:55], v[40:43], a[100:103], v[52:55]
ds_read_b64_tr_b16 v[38:39], v12 offset:28928
v_mfma_f32_16x16x32_bf16 v[56:59], v[40:43], a[104:107], v[56:59]
buffer_load_dwordx4 v4, s[28:31], s45 offen lds
v_mfma_f32_16x16x32_bf16 v[60:63], v[40:43], a[108:111], v[60:63]
s_add_u32 m0, s44, 12288
s_add_u32 s45, s50, 111616
s_waitcnt lgkmcnt(4)
v_mfma_f32_16x16x32_bf16 v[64:67], v[44:47], a[96:99], v[64:67]
ds_read_b64_tr_b16 v[40:41], v11 offset:32768
v_mfma_f32_16x16x32_bf16 v[68:71], v[44:47], a[100:103], v[68:71]
ds_read_b64_tr_b16 v[42:43], v11 offset:33024
v_mfma_f32_16x16x32_bf16 v[72:75], v[44:47], a[104:107], v[72:75]
buffer_load_dwordx4 v4, s[28:31], s45 offen lds
v_mfma_f32_16x16x32_bf16 v[76:79], v[44:47], a[108:111], v[76:79]
s_add_u32 m0, s44, 16384
s_add_u32 s45, s50, 148480
s_waitcnt lgkmcnt(4)
v_mfma_f32_16x16x32_bf16 v[48:51], v[32:35], a[112:115], v[48:51]
ds_read_b64_tr_b16 v[44:45], v12 offset:32768
v_cmp_u_f32 vcc, v152, v152
s_cbranch_vccnz L1_rs1
L1_rb1:
v_mfma_f32_16x16x32_bf16 v[52:55], v[32:35], a[116:119], v[52:55]
ds_read_b64_tr_b16 v[46:47], v12 offset:33024
v_cvt_pk_bf16_f32 v152, v152, v153
v_mfma_f32_16x16x32_bf16 v[56:59], v[32:35], a[120:123], v[56:59]
buffer_load_dwordx4 v4, s[28:31], s45 offen lds
v_cvt_pk_bf16_f32 v153, v154, v155
v_mfma_f32_16x16x32_bf16 v[60:63], v[32:35], a[124:127], v[60:63]
s_add_u32 m0, s44, 20480
s_add_u32 s45, s50, 185344
buffer_store_dwordx2 v[152:153], v31, s[96:99], s69 offen offset:0
s_waitcnt lgkmcnt(4)
v_mfma_f32_16x16x32_bf16 v[64:67], v[36:39], a[112:115], v[64:67]
ds_read_b64_tr_b16 v[32:33], v11 offset:36864
v_mfma_f32_16x16x32_bf16 v[68:71], v[36:39], a[116:119], v[68:71]
ds_read_b64_tr_b16 v[34:35], v11 offset:37120
v_mfma_f32_16x16x32_bf16 v[72:75], v[36:39], a[120:123], v[72:75]
buffer_load_dwordx4 v4, s[28:31], s45 offen lds
v_mfma_f32_16x16x32_bf16 v[76:79], v[36:39], a[124:127], v[76:79]
s_waitcnt lgkmcnt(4)
v_mfma_f32_16x16x32_bf16 v[48:51], v[40:43], a[128:131], v[48:51]
ds_read_b64_tr_b16 v[36:37], v12 offset:36864
v_mfma_f32_16x16x32_bf16 v[52:55], v[40:43], a[132:135], v[52:55]
ds_read_b64_tr_b16 v[38:39], v12 offset:37120
v_mfma_f32_16x16x32_bf16 v[56:59], v[40:43], a[136:139], v[56:59]
v_mfma_f32_16x16x32_bf16 v[60:63], v[40:43], a[140:143], v[60:63]
s_waitcnt lgkmcnt(4)
v_mfma_f32_16x16x32_bf16 v[64:67], v[44:47], a[128:131], v[64:67]
ds_read_b64_tr_b16 v[40:41], v3 offset:40960
v_mfma_f32_16x16x32_bf16 v[68:71], v[44:47], a[132:135], v[68:71]
v_mfma_f32_16x16x32_bf16 v[72:75], v[44:47], a[136:139], v[72:75]
v_mfma_f32_16x16x32_bf16 v[76:79], v[44:47], a[140:143], v[76:79]
s_waitcnt lgkmcnt(3)
v_mfma_f32_16x16x32_bf16 v[48:51], v[32:35], a[144:147], v[48:51]
ds_read_b64_tr_b16 v[44:45], v3 offset:40992
v_mfma_f32_16x16x32_bf16 v[52:55], v[32:35], a[148:151], v[52:55]
v_mfma_f32_16x16x32_bf16 v[56:59], v[32:35], a[152:155], v[56:59]
v_mfma_f32_16x16x32_bf16 v[60:63], v[32:35], a[156:159], v[60:63]
s_waitcnt lgkmcnt(2)
v_mfma_f32_16x16x32_bf16 v[64:67], v[36:39], a[144:147], v[64:67]
s_waitcnt lgkmcnt(0)
s_barrier
ds_read_b64_tr_b16 v[32:33], v8 offset:0
v_mfma_f32_16x16x32_bf16 v[68:71], v[36:39], a[148:151], v[68:71]
ds_read_b64_tr_b16 v[34:35], v8 offset:256
v_mfma_f32_16x16x32_bf16 v[72:75], v[36:39], a[152:155], v[72:75]
v_mfma_f32_16x16x32_bf16 v[76:79], v[36:39], a[156:159], v[76:79]
s_add_u32 m0, s44, 24576
s_add_u32 s45, s50, 222208
v_mfma_f32_16x16x16_bf16 v[48:51], v[40:41], v[144:145], v[48:51]
ds_read_b64_tr_b16 v[36:37], v10 offset:0
v_mfma_f32_16x16x16_bf16 v[52:55], v[40:41], v[146:147], v[52:55]
ds_read_b64_tr_b16 v[38:39], v10 offset:256
v_mfma_f32_16x16x16_bf16 v[56:59], v[40:41], v[148:149], v[56:59]
buffer_load_dwordx4 v4, s[28:31], s45 offen lds
v_mfma_f32_16x16x16_bf16 v[60:63], v[40:41], v[150:151], v[60:63]
s_add_u32 m0, s44, 28672
s_add_u32 s45, s50, 259072
v_mfma_f32_16x16x16_bf16 v[64:67], v[44:45], v[144:145], v[64:67]
ds_read_b64_tr_b16 v[40:41], v8 offset:4096
v_mfma_f32_16x16x16_bf16 v[68:71], v[44:45], v[146:147], v[68:71]
ds_read_b64_tr_b16 v[42:43], v8 offset:4352
v_mfma_f32_16x16x16_bf16 v[72:75], v[44:45], v[148:149], v[72:75]
buffer_load_dwordx4 v4, s[28:31], s45 offen lds
v_mfma_f32_16x16x16_bf16 v[76:79], v[44:45], v[150:151], v[76:79]
s_add_u32 m0, s44, 32768
s_add_u32 s45, s51, 1024
s_waitcnt lgkmcnt(4)
v_mfma_f32_16x16x32_bf16 v[112:115], v[32:35], a[0:3], 0
ds_read_b64_tr_b16 v[44:45], v10 offset:4096
s_add_u32 s88, s68, 6144
buffer_load_dwordx4 a[208:211], v26, s[36:39], s88 offen sc1
v_mfma_f32_16x16x32_bf16 v[116:119], v[32:35], a[4:7], 0
ds_read_b64_tr_b16 v[46:47], v10 offset:4352
v_mfma_f32_16x16x32_bf16 v[120:123], v[32:35], a[8:11], 0
buffer_load_dwordx4 v4, s[28:31], s45 offen lds
v_mfma_f32_16x16x32_bf16 v[124:127], v[32:35], a[12:15], 0
s_add_u32 m0, s44, 36864
s_add_u32 s45, s52, 1024
s_waitcnt lgkmcnt(4)
v_mfma_f32_16x16x32_bf16 v[128:131], v[36:39], a[0:3], 0
ds_read_b64_tr_b16 v[32:33], v8 offset:8192
v_cvt_pk_bf16_f32 v48, v48, v49
v_mfma_f32_16x16x32_bf16 v[132:135], v[36:39], a[4:7], 0
ds_read_b64_tr_b16 v[34:35], v8 offset:8448
v_cvt_pk_bf16_f32 v49, v50, v51
v_mfma_f32_16x16x32_bf16 v[136:139], v[36:39], a[8:11], 0
buffer_load_dwordx4 v5, s[32:35], s45 offen lds
v_cvt_pk_bf16_f32 v50, v64, v65
v_mfma_f32_16x16x32_bf16 v[140:143], v[36:39], a[12:15], 0
s_add_u32 m0, s44, 40960
s_add_u32 s45, s52, 1024
v_cvt_pk_bf16_f32 v51, v66, v67
s_waitcnt lgkmcnt(4)
v_mfma_f32_16x16x32_bf16 v[112:115], v[40:43], a[16:19], v[112:115]
ds_read_b64_tr_b16 v[36:37], v10 offset:8192
s_add_u32 s46, s53, 10240
buffer_store_dwordx4 v[48:51], v1, s[36:39], s46 offen sc1
v_mfma_f32_16x16x32_bf16 v[116:119], v[40:43], a[20:23], v[116:119]
ds_read_b64_tr_b16 v[38:39], v10 offset:8448
v_cvt_pk_bf16_f32 v52, v52, v53
v_mfma_f32_16x16x32_bf16 v[120:123], v[40:43], a[24:27], v[120:123]
buffer_load_dwordx4 v6, s[32:35], s45 offen lds
v_cvt_pk_bf16_f32 v53, v54, v55
v_mfma_f32_16x16x32_bf16 v[124:127], v[40:43], a[28:31], v[124:127]
v_cvt_pk_bf16_f32 v54, v68, v69
v_cvt_pk_bf16_f32 v55, v70, v71
s_waitcnt lgkmcnt(4)
v_mfma_f32_16x16x32_bf16 v[128:131], v[44:47], a[16:19], v[128:131]
ds_read_b64_tr_b16 v[40:41], v8 offset:12288
s_add_u32 s46, s53, 28672
buffer_store_dwordx4 v[52:55], v1, s[36:39], s46 offen sc1
v_mfma_f32_16x16x32_bf16 v[132:135], v[44:47], a[20:23], v[132:135]
ds_read_b64_tr_b16 v[42:43], v8 offset:12544
v_cvt_pk_bf16_f32 v56, v56, v57
v_mfma_f32_16x16x32_bf16 v[136:139], v[44:47], a[24:27], v[136:139]
v_cvt_pk_bf16_f32 v57, v58, v59
v_cvt_pk_bf16_f32 v58, v72, v73
v_mfma_f32_16x16x32_bf16 v[140:143], v[44:47], a[28:31], v[140:143]
v_cvt_pk_bf16_f32 v59, v74, v75
s_add_u32 s46, s53, 10240
buffer_store_dwordx4 v[56:59], v2, s[36:39], s46 offen sc1
s_waitcnt lgkmcnt(4)
v_mfma_f32_16x16x32_bf16 v[112:115], v[32:35], a[32:35], v[112:115]
ds_read_b64_tr_b16 v[44:45], v10 offset:12288
v_cvt_pk_bf16_f32 v60, v60, v61
v_mfma_f32_16x16x32_bf16 v[116:119], v[32:35], a[36:39], v[116:119]
ds_read_b64_tr_b16 v[46:47], v10 offset:12544
v_cvt_pk_bf16_f32 v61, v62, v63
v_mfma_f32_16x16x32_bf16 v[120:123], v[32:35], a[40:43], v[120:123]
v_cvt_pk_bf16_f32 v62, v76, v77
v_cvt_pk_bf16_f32 v63, v78, v79
v_mfma_f32_16x16x32_bf16 v[124:127], v[32:35], a[44:47], v[124:127]
s_add_u32 s46, s53, 28672
buffer_store_dwordx4 v[60:63], v2, s[36:39], s46 offen sc1
s_add_u32 s88, s68, 9443328
buffer_load_dwordx4 a[212:215], v26, s[36:39], s88 offen sc1
s_waitcnt lgkmcnt(4)
v_mfma_f32_16x16x32_bf16 v[128:131], v[36:39], a[32:35], v[128:131]
ds_read_b64_tr_b16 v[32:33], v8 offset:16384
s_add_u32 s88, s68, 18880512
buffer_load_dwordx4 a[216:219], v26, s[36:39], s88 offen sc1
v_mfma_f32_16x16x32_bf16 v[132:135], v[36:39], a[36:39], v[132:135]
ds_read_b64_tr_b16 v[34:35], v8 offset:16640
v_mfma_f32_16x16x32_bf16 v[136:139], v[36:39], a[40:43], v[136:139]
v_mfma_f32_16x16x32_bf16 v[140:143], v[36:39], a[44:47], v[140:143]
s_waitcnt lgkmcnt(4)
v_mfma_f32_16x16x32_bf16 v[112:115], v[40:43], a[48:51], v[112:115]
ds_read_b64_tr_b16 v[36:37], v10 offset:16384
s_add_u32 s88, s68, 28317696
buffer_load_dwordx4 a[220:223], v26, s[36:39], s88 offen sc1
v_mfma_f32_16x16x32_bf16 v[116:119], v[40:43], a[52:55], v[116:119]
ds_read_b64_tr_b16 v[38:39], v10 offset:16640
v_mfma_f32_16x16x32_bf16 v[120:123], v[40:43], a[56:59], v[120:123]
v_mfma_f32_16x16x32_bf16 v[124:127], v[40:43], a[60:63], v[124:127]
s_waitcnt lgkmcnt(4)
v_mfma_f32_16x16x32_bf16 v[128:131], v[44:47], a[48:51], v[128:131]
ds_read_b64_tr_b16 v[40:41], v8 offset:20480
v_mfma_f32_16x16x32_bf16 v[132:135], v[44:47], a[52:55], v[132:135]
ds_read_b64_tr_b16 v[42:43], v8 offset:20736
v_mfma_f32_16x16x32_bf16 v[136:139], v[44:47], a[56:59], v[136:139]
v_mfma_f32_16x16x32_bf16 v[140:143], v[44:47], a[60:63], v[140:143]
s_waitcnt lgkmcnt(4)
v_mfma_f32_16x16x32_bf16 v[112:115], v[32:35], a[64:67], v[112:115]
ds_read_b64_tr_b16 v[44:45], v10 offset:20480
s_waitcnt vmcnt(30)
v_mfma_f32_16x16x32_bf16 v[84:87], v[184:187], a[192:195], v[156:159]
v_mfma_f32_16x16x32_bf16 v[116:119], v[32:35], a[68:71], v[116:119]
ds_read_b64_tr_b16 v[46:47], v10 offset:20736
v_mfma_f32_16x16x32_bf16 v[120:123], v[32:35], a[72:75], v[120:123]
v_mfma_f32_16x16x32_bf16 v[124:127], v[32:35], a[76:79], v[124:127]
s_waitcnt lgkmcnt(4)
v_mfma_f32_16x16x32_bf16 v[128:131], v[36:39], a[64:67], v[128:131]
s_waitcnt lgkmcnt(0)
s_barrier
ds_read_b64_tr_b16 v[32:33], v7 offset:0
s_waitcnt vmcnt(22)
v_mfma_f32_16x16x32_bf16 v[84:87], v[184:187], a[196:199], v[84:87]
v_mfma_f32_16x16x32_bf16 v[132:135], v[36:39], a[68:71], v[132:135]
ds_read_b64_tr_b16 v[34:35], v7 offset:256
v_mfma_f32_16x16x32_bf16 v[136:139], v[36:39], a[72:75], v[136:139]
v_mfma_f32_16x16x32_bf16 v[140:143], v[36:39], a[76:79], v[140:143]
v_mfma_f32_16x16x32_bf16 v[112:115], v[40:43], a[80:83], v[112:115]
ds_read_b64_tr_b16 v[36:37], v9 offset:0
s_waitcnt vmcnt(21)
v_mfma_f32_16x16x32_bf16 v[84:87], v[184:187], a[200:203], v[84:87]
v_mfma_f32_16x16x32_bf16 v[116:119], v[40:43], a[84:87], v[116:119]
ds_read_b64_tr_b16 v[38:39], v9 offset:256
v_mfma_f32_16x16x32_bf16 v[120:123], v[40:43], a[88:91], v[120:123]
v_mfma_f32_16x16x32_bf16 v[124:127], v[40:43], a[92:95], v[124:127]
v_mfma_f32_16x16x32_bf16 v[128:131], v[44:47], a[80:83], v[128:131]
ds_read_b64_tr_b16 v[40:41], v7 offset:4096
s_waitcnt vmcnt(20)
v_mfma_f32_16x16x32_bf16 v[84:87], v[184:187], a[204:207], v[84:87]
v_mfma_f32_16x16x32_bf16 v[132:135], v[44:47], a[84:87], v[132:135]
ds_read_b64_tr_b16 v[42:43], v7 offset:4352
v_mfma_f32_16x16x32_bf16 v[136:139], v[44:47], a[88:91], v[136:139]
v_mfma_f32_16x16x32_bf16 v[140:143], v[44:47], a[92:95], v[140:143]
s_waitcnt lgkmcnt(4)
v_mfma_f32_16x16x32_bf16 v[112:115], v[32:35], a[96:99], v[112:115]
ds_read_b64_tr_b16 v[44:45], v9 offset:4096
v_mfma_f32_16x16x32_bf16 v[116:119], v[32:35], a[100:103], v[116:119]
ds_read_b64_tr_b16 v[46:47], v9 offset:4352
v_mfma_f32_16x16x32_bf16 v[120:123], v[32:35], a[104:107], v[120:123]
v_mfma_f32_16x16x32_bf16 v[124:127], v[32:35], a[108:111], v[124:127]
s_waitcnt lgkmcnt(4)
v_mfma_f32_16x16x32_bf16 v[128:131], v[36:39], a[96:99], v[128:131]
ds_read_b64_tr_b16 v[32:33], v7 offset:8192
v_mfma_f32_16x16x32_bf16 v[132:135], v[36:39], a[100:103], v[132:135]
ds_read_b64_tr_b16 v[34:35], v7 offset:8448
v_mfma_f32_16x16x32_bf16 v[136:139], v[36:39], a[104:107], v[136:139]
v_mfma_f32_16x16x32_bf16 v[140:143], v[36:39], a[108:111], v[140:143]
s_waitcnt lgkmcnt(4)
v_mfma_f32_16x16x32_bf16 v[112:115], v[40:43], a[112:115], v[112:115]
ds_read_b64_tr_b16 v[36:37], v9 offset:8192
v_cmp_u_f32 vcc, v84, v84
s_cbranch_vccnz L1_rs2
L1_rb2:
v_mfma_f32_16x16x32_bf16 v[116:119], v[40:43], a[116:119], v[116:119]
ds_read_b64_tr_b16 v[38:39], v9 offset:8448
v_mfma_f32_16x16x32_bf16 v[120:123], v[40:43], a[120:123], v[120:123]
v_mfma_f32_16x16x32_bf16 v[124:127], v[40:43], a[124:127], v[124:127]
s_waitcnt lgkmcnt(4)
v_mfma_f32_16x16x32_bf16 v[128:131], v[44:47], a[112:115], v[128:131]
ds_read_b64_tr_b16 v[40:41], v7 offset:12288
v_mfma_f32_16x16x32_bf16 v[132:135], v[44:47], a[116:119], v[132:135]
ds_read_b64_tr_b16 v[42:43], v7 offset:12544
v_mfma_f32_16x16x32_bf16 v[136:139], v[44:47], a[120:123], v[136:139]
v_mfma_f32_16x16x32_bf16 v[140:143], v[44:47], a[124:127], v[140:143]
s_waitcnt lgkmcnt(4)
v_mfma_f32_16x16x32_bf16 v[112:115], v[32:35], a[128:131], v[112:115]
ds_read_b64_tr_b16 v[44:45], v9 offset:12288
v_mfma_f32_16x16x32_bf16 v[116:119], v[32:35], a[132:135], v[116:119]
ds_read_b64_tr_b16 v[46:47], v9 offset:12544
v_mfma_f32_16x16x32_bf16 v[120:123], v[32:35], a[136:139], v[120:123]
v_mfma_f32_16x16x32_bf16 v[124:127], v[32:35], a[140:143], v[124:127]
s_waitcnt lgkmcnt(4)
v_mfma_f32_16x16x32_bf16 v[128:131], v[36:39], a[128:131], v[128:131]
ds_read_b64_tr_b16 v[32:33], v24 offset:16384
v_mfma_f32_16x16x32_bf16 v[132:135], v[36:39], a[132:135], v[132:135]
v_mfma_f32_16x16x32_bf16 v[136:139], v[36:39], a[136:139], v[136:139]
v_mfma_f32_16x16x32_bf16 v[140:143], v[36:39], a[140:143], v[140:143]
s_waitcnt lgkmcnt(3)
v_mfma_f32_16x16x32_bf16 v[112:115], v[40:43], a[144:147], v[112:115]
ds_read_b64_tr_b16 v[36:37], v24 offset:16416
v_mfma_f32_16x16x32_bf16 v[116:119], v[40:43], a[148:151], v[116:119]
v_mfma_f32_16x16x32_bf16 v[120:123], v[40:43], a[152:155], v[120:123]
v_mfma_f32_16x16x32_bf16 v[124:127], v[40:43], a[156:159], v[124:127]
s_waitcnt lgkmcnt(2)
v_mfma_f32_16x16x32_bf16 v[128:131], v[44:47], a[144:147], v[128:131]
s_waitcnt lgkmcnt(0)
s_barrier
ds_read_b64_tr_b16 v[40:41], v8 offset:24576
v_mfma_f32_16x16x32_bf16 v[132:135], v[44:47], a[148:151], v[132:135]
ds_read_b64_tr_b16 v[42:43], v8 offset:24832
v_mfma_f32_16x16x32_bf16 v[136:139], v[44:47], a[152:155], v[136:139]
v_mfma_f32_16x16x32_bf16 v[140:143], v[44:47], a[156:159], v[140:143]
v_mfma_f32_16x16x16_bf16 v[112:115], v[32:33], v[144:145], v[112:115]
ds_read_b64_tr_b16 v[44:45], v10 offset:24576
v_mfma_f32_16x16x16_bf16 v[116:119], v[32:33], v[146:147], v[116:119]
ds_read_b64_tr_b16 v[46:47], v10 offset:24832
v_mfma_f32_16x16x16_bf16 v[120:123], v[32:33], v[148:149], v[120:123]
v_mfma_f32_16x16x16_bf16 v[124:127], v[32:33], v[150:151], v[124:127]
v_mfma_f32_16x16x16_bf16 v[128:131], v[36:37], v[144:145], v[128:131]
ds_read_b64_tr_b16 v[32:33], v8 offset:28672
v_mfma_f32_16x16x16_bf16 v[132:135], v[36:37], v[146:147], v[132:135]
ds_read_b64_tr_b16 v[34:35], v8 offset:28928
v_mfma_f32_16x16x16_bf16 v[136:139], v[36:37], v[148:149], v[136:139]
v_mfma_f32_16x16x16_bf16 v[140:143], v[36:37], v[150:151], v[140:143]
s_waitcnt lgkmcnt(4)
v_mfma_f32_16x16x32_bf16 v[48:51], v[40:43], a[0:3], 0
ds_read_b64_tr_b16 v[36:37], v10 offset:28672
s_add_u32 s88, s68, 8192
buffer_load_dwordx4 a[224:227], v26, s[36:39], s88 offen sc1
v_mfma_f32_16x16x32_bf16 v[52:55], v[40:43], a[4:7], 0
ds_read_b64_tr_b16 v[38:39], v10 offset:28928
v_mfma_f32_16x16x32_bf16 v[56:59], v[40:43], a[8:11], 0
v_mfma_f32_16x16x32_bf16 v[60:63], v[40:43], a[12:15], 0
s_waitcnt lgkmcnt(4)
v_mfma_f32_16x16x32_bf16 v[64:67], v[44:47], a[0:3], 0
ds_read_b64_tr_b16 v[40:41], v8 offset:32768
v_cvt_pk_bf16_f32 v112, v112, v113
v_mfma_f32_16x16x32_bf16 v[68:71], v[44:47], a[4:7], 0
ds_read_b64_tr_b16 v[42:43], v8 offset:33024
v_cvt_pk_bf16_f32 v113, v114, v115
v_mfma_f32_16x16x32_bf16 v[72:75], v[44:47], a[8:11], 0
v_cvt_pk_bf16_f32 v114, v128, v129
v_cvt_pk_bf16_f32 v115, v130, v131
v_mfma_f32_16x16x32_bf16 v[76:79], v[44:47], a[12:15], 0
s_add_u32 s46, s53, 12288
buffer_store_dwordx4 v[112:115], v1, s[36:39], s46 offen sc1
v_cvt_pk_bf16_f32 v116, v116, v117
s_waitcnt lgkmcnt(4)
v_mfma_f32_16x16x32_bf16 v[48:51], v[32:35], a[16:19], v[48:51]
ds_read_b64_tr_b16 v[44:45], v10 offset:32768
v_cvt_pk_bf16_f32 v117, v118, v119
v_mfma_f32_16x16x32_bf16 v[52:55], v[32:35], a[20:23], v[52:55]
ds_read_b64_tr_b16 v[46:47], v10 offset:33024
v_cvt_pk_bf16_f32 v118, v132, v133
v_mfma_f32_16x16x32_bf16 v[56:59], v[32:35], a[24:27], v[56:59]
v_cvt_pk_bf16_f32 v119, v134, v135
s_add_u32 s46, s53, 30720
buffer_store_dwordx4 v[116:119], v1, s[36:39], s46 offen sc1
v_mfma_f32_16x16x32_bf16 v[60:63], v[32:35], a[28:31], v[60:63]
v_cvt_pk_bf16_f32 v120, v120, v121
v_cvt_pk_bf16_f32 v121, v122, v123
s_waitcnt lgkmcnt(4)
v_mfma_f32_16x16x32_bf16 v[64:67], v[36:39], a[16:19], v[64:67]
ds_read_b64_tr_b16 v[32:33], v8 offset:36864
v_cvt_pk_bf16_f32 v122, v136, v137
v_mfma_f32_16x16x32_bf16 v[68:71], v[36:39], a[20:23], v[68:71]
ds_read_b64_tr_b16 v[34:35], v8 offset:37120
v_cvt_pk_bf16_f32 v123, v138, v139
v_mfma_f32_16x16x32_bf16 v[72:75], v[36:39], a[24:27], v[72:75]
s_add_u32 s46, s53, 12288
buffer_store_dwordx4 v[120:123], v2, s[36:39], s46 offen sc1
v_cvt_pk_bf16_f32 v124, v124, v125
v_mfma_f32_16x16x32_bf16 v[76:79], v[36:39], a[28:31], v[76:79]
v_cvt_pk_bf16_f32 v125, v126, v127
v_cvt_pk_bf16_f32 v126, v140, v141
s_waitcnt lgkmcnt(4)
v_mfma_f32_16x16x32_bf16 v[48:51], v[40:43], a[32:35], v[48:51]
ds_read_b64_tr_b16 v[36:37], v10 offset:36864
v_cvt_pk_bf16_f32 v127, v142, v143
v_mfma_f32_16x16x32_bf16 v[52:55], v[40:43], a[36:39], v[52:55]
ds_read_b64_tr_b16 v[38:39], v10 offset:37120
s_add_u32 s46, s53, 30720
buffer_store_dwordx4 v[124:127], v2, s[36:39], s46 offen sc1
v_mfma_f32_16x16x32_bf16 v[56:59], v[40:43], a[40:43], v[56:59]
s_add_u32 s88, s68, 9445376
buffer_load_dwordx4 a[228:231], v26, s[36:39], s88 offen sc1
s_add_u32 s88, s68, 18882560
buffer_load_dwordx4 a[232:235], v26, s[36:39], s88 offen sc1
v_mfma_f32_16x16x32_bf16 v[60:63], v[40:43], a[44:47], v[60:63]
s_waitcnt lgkmcnt(4)
v_mfma_f32_16x16x32_bf16 v[64:67], v[44:47], a[32:35], v[64:67]
ds_read_b64_tr_b16 v[40:41], v8 offset:40960
v_mfma_f32_16x16x32_bf16 v[68:71], v[44:47], a[36:39], v[68:71]
ds_read_b64_tr_b16 v[42:43], v8 offset:41216
v_mfma_f32_16x16x32_bf16 v[72:75], v[44:47], a[40:43], v[72:75]
v_mfma_f32_16x16x32_bf16 v[76:79], v[44:47], a[44:47], v[76:79]
s_waitcnt lgkmcnt(4)
v_mfma_f32_16x16x32_bf16 v[48:51], v[32:35], a[48:51], v[48:51]
ds_read_b64_tr_b16 v[44:45], v10 offset:40960
s_add_u32 s88, s68, 28319744
buffer_load_dwordx4 a[236:239], v26, s[36:39], s88 offen sc1
v_mfma_f32_16x16x32_bf16 v[52:55], v[32:35], a[52:55], v[52:55]
ds_read_b64_tr_b16 v[46:47], v10 offset:41216
v_mfma_f32_16x16x32_bf16 v[56:59], v[32:35], a[56:59], v[56:59]
v_mfma_f32_16x16x32_bf16 v[60:63], v[32:35], a[60:63], v[60:63]
s_waitcnt lgkmcnt(4)
v_mfma_f32_16x16x32_bf16 v[64:67], v[36:39], a[48:51], v[64:67]
ds_read_b64_tr_b16 v[32:33], v8 offset:45056
v_mfma_f32_16x16x32_bf16 v[68:71], v[36:39], a[52:55], v[68:71]
ds_read_b64_tr_b16 v[34:35], v8 offset:45312
v_mfma_f32_16x16x32_bf16 v[72:75], v[36:39], a[56:59], v[72:75]
v_mfma_f32_16x16x32_bf16 v[76:79], v[36:39], a[60:63], v[76:79]
s_waitcnt lgkmcnt(4)
v_mfma_f32_16x16x32_bf16 v[48:51], v[40:43], a[64:67], v[48:51]
ds_read_b64_tr_b16 v[36:37], v10 offset:45056
s_waitcnt vmcnt(18)
v_mfma_f32_16x16x32_bf16 v[156:159], v[188:191], a[208:211], v[84:87]
v_mfma_f32_16x16x32_bf16 v[52:55], v[40:43], a[68:71], v[52:55]
ds_read_b64_tr_b16 v[38:39], v10 offset:45312
v_mfma_f32_16x16x32_bf16 v[56:59], v[40:43], a[72:75], v[56:59]
v_mfma_f32_16x16x32_bf16 v[60:63], v[40:43], a[76:79], v[60:63]
s_waitcnt lgkmcnt(4)
v_mfma_f32_16x16x32_bf16 v[64:67], v[44:47], a[64:67], v[64:67]
s_waitcnt lgkmcnt(0)
s_barrier
ds_read_b64_tr_b16 v[40:41], v7 offset:40960
s_waitcnt vmcnt(10)
v_mfma_f32_16x16x32_bf16 v[156:159], v[188:191], a[212:215], v[156:159]
v_mfma_f32_16x16x32_bf16 v[68:71], v[44:47], a[68:71], v[68:71]
ds_read_b64_tr_b16 v[42:43], v7 offset:41216
v_mfma_f32_16x16x32_bf16 v[72:75], v[44:47], a[72:75], v[72:75]
v_mfma_f32_16x16x32_bf16 v[76:79], v[44:47], a[76:79], v[76:79]
v_mfma_f32_16x16x32_bf16 v[48:51], v[32:35], a[80:83], v[48:51]
ds_read_b64_tr_b16 v[44:45], v9 offset:40960
s_waitcnt vmcnt(9)
v_mfma_f32_16x16x32_bf16 v[156:159], v[188:191], a[216:219], v[156:159]
v_mfma_f32_16x16x32_bf16 v[52:55], v[32:35], a[84:87], v[52:55]
ds_read_b64_tr_b16 v[46:47], v9 offset:41216
v_mfma_f32_16x16x32_bf16 v[56:59], v[32:35], a[88:91], v[56:59]
v_mfma_f32_16x16x32_bf16 v[60:63], v[32:35], a[92:95], v[60:63]
v_mfma_f32_16x16x32_bf16 v[64:67], v[36:39], a[80:83], v[64:67]
ds_read_b64_tr_b16 v[32:33], v7 offset:45056
s_waitcnt vmcnt(8)
v_mfma_f32_16x16x32_bf16 v[156:159], v[188:191], a[220:223], v[156:159]
v_mfma_f32_16x16x32_bf16 v[68:71], v[36:39], a[84:87], v[68:71]
ds_read_b64_tr_b16 v[34:35], v7 offset:45312
v_mfma_f32_16x16x32_bf16 v[72:75], v[36:39], a[88:91], v[72:75]
v_mfma_f32_16x16x32_bf16 v[76:79], v[36:39], a[92:95], v[76:79]
s_waitcnt lgkmcnt(4)
v_mfma_f32_16x16x32_bf16 v[48:51], v[40:43], a[96:99], v[48:51]
ds_read_b64_tr_b16 v[36:37], v9 offset:45056
v_mfma_f32_16x16x32_bf16 v[52:55], v[40:43], a[100:103], v[52:55]
ds_read_b64_tr_b16 v[38:39], v9 offset:45312
v_mfma_f32_16x16x32_bf16 v[56:59], v[40:43], a[104:107], v[56:59]
v_mfma_f32_16x16x32_bf16 v[60:63], v[40:43], a[108:111], v[60:63]
s_waitcnt lgkmcnt(4)
v_mfma_f32_16x16x32_bf16 v[64:67], v[44:47], a[96:99], v[64:67]
ds_read_b64_tr_b16 v[40:41], v7 offset:49152
v_mfma_f32_16x16x32_bf16 v[68:71], v[44:47], a[100:103], v[68:71]
ds_read_b64_tr_b16 v[42:43], v7 offset:49408
v_mfma_f32_16x16x32_bf16 v[72:75], v[44:47], a[104:107], v[72:75]
v_mfma_f32_16x16x32_bf16 v[76:79], v[44:47], a[108:111], v[76:79]
s_waitcnt lgkmcnt(4)
v_mfma_f32_16x16x32_bf16 v[48:51], v[32:35], a[112:115], v[48:51]
ds_read_b64_tr_b16 v[44:45], v9 offset:49152
v_cmp_u_f32 vcc, v156, v156
s_cbranch_vccnz L1_rs3
L1_rb3:
v_mfma_f32_16x16x32_bf16 v[52:55], v[32:35], a[116:119], v[52:55]
ds_read_b64_tr_b16 v[46:47], v9 offset:49408
v_cvt_pk_bf16_f32 v156, v156, v157
v_mfma_f32_16x16x32_bf16 v[56:59], v[32:35], a[120:123], v[56:59]
v_cvt_pk_bf16_f32 v157, v158, v159
buffer_store_dwordx2 v[156:157], v31, s[96:99], s69 offen offset:256
v_mfma_f32_16x16x32_bf16 v[60:63], v[32:35], a[124:127], v[60:63]
s_waitcnt lgkmcnt(4)
v_mfma_f32_16x16x32_bf16 v[64:67], v[36:39], a[112:115], v[64:67]
ds_read_b64_tr_b16 v[32:33], v7 offset:53248
v_mfma_f32_16x16x32_bf16 v[68:71], v[36:39], a[116:119], v[68:71]
ds_read_b64_tr_b16 v[34:35], v7 offset:53504
v_mfma_f32_16x16x32_bf16 v[72:75], v[36:39], a[120:123], v[72:75]
v_mfma_f32_16x16x32_bf16 v[76:79], v[36:39], a[124:127], v[76:79]
s_waitcnt lgkmcnt(4)
v_mfma_f32_16x16x32_bf16 v[48:51], v[40:43], a[128:131], v[48:51]
ds_read_b64_tr_b16 v[36:37], v9 offset:53248
v_mfma_f32_16x16x32_bf16 v[52:55], v[40:43], a[132:135], v[52:55]
ds_read_b64_tr_b16 v[38:39], v9 offset:53504
v_mfma_f32_16x16x32_bf16 v[56:59], v[40:43], a[136:139], v[56:59]
v_mfma_f32_16x16x32_bf16 v[60:63], v[40:43], a[140:143], v[60:63]
s_waitcnt lgkmcnt(4)
v_mfma_f32_16x16x32_bf16 v[64:67], v[44:47], a[128:131], v[64:67]
ds_read_b64_tr_b16 v[40:41], v24 offset:57344
v_mfma_f32_16x16x32_bf16 v[68:71], v[44:47], a[132:135], v[68:71]
v_mfma_f32_16x16x32_bf16 v[72:75], v[44:47], a[136:139], v[72:75]
v_mfma_f32_16x16x32_bf16 v[76:79], v[44:47], a[140:143], v[76:79]
s_waitcnt lgkmcnt(3)
v_mfma_f32_16x16x32_bf16 v[48:51], v[32:35], a[144:147], v[48:51]
ds_read_b64_tr_b16 v[44:45], v24 offset:57376
v_mfma_f32_16x16x32_bf16 v[52:55], v[32:35], a[148:151], v[52:55]
v_mfma_f32_16x16x32_bf16 v[56:59], v[32:35], a[152:155], v[56:59]
v_mfma_f32_16x16x32_bf16 v[60:63], v[32:35], a[156:159], v[60:63]
s_waitcnt lgkmcnt(2)
v_mfma_f32_16x16x32_bf16 v[64:67], v[36:39], a[144:147], v[64:67]
s_waitcnt lgkmcnt(0)
s_barrier
ds_read_b64_tr_b16 v[32:33], v11 offset:0
v_mfma_f32_16x16x32_bf16 v[68:71], v[36:39], a[148:151], v[68:71]
ds_read_b64_tr_b16 v[34:35], v11 offset:256
v_mfma_f32_16x16x32_bf16 v[72:75], v[36:39], a[152:155], v[72:75]
v_mfma_f32_16x16x32_bf16 v[76:79], v[36:39], a[156:159], v[76:79]
v_mfma_f32_16x16x16_bf16 v[48:51], v[40:41], v[144:145], v[48:51]
ds_read_b64_tr_b16 v[36:37], v12 offset:0
v_mfma_f32_16x16x16_bf16 v[52:55], v[40:41], v[146:147], v[52:55]
ds_read_b64_tr_b16 v[38:39], v12 offset:256
v_mfma_f32_16x16x16_bf16 v[56:59], v[40:41], v[148:149], v[56:59]
v_mfma_f32_16x16x16_bf16 v[60:63], v[40:41], v[150:151], v[60:63]
v_mfma_f32_16x16x16_bf16 v[64:67], v[44:45], v[144:145], v[64:67]
ds_read_b64_tr_b16 v[40:41], v11 offset:4096
v_mfma_f32_16x16x16_bf16 v[68:71], v[44:45], v[146:147], v[68:71]
ds_read_b64_tr_b16 v[42:43], v11 offset:4352
v_mfma_f32_16x16x16_bf16 v[72:75], v[44:45], v[148:149], v[72:75]
v_mfma_f32_16x16x16_bf16 v[76:79], v[44:45], v[150:151], v[76:79]
s_waitcnt lgkmcnt(4)
v_mfma_f32_16x16x32_bf16 v[112:115], v[32:35], a[0:3], 0
ds_read_b64_tr_b16 v[44:45], v12 offset:4096
s_add_u32 s88, s68, 10240
buffer_load_dwordx4 a[240:243], v26, s[36:39], s88 offen sc1
v_mfma_f32_16x16x32_bf16 v[116:119], v[32:35], a[4:7], 0
ds_read_b64_tr_b16 v[46:47], v12 offset:4352
v_mfma_f32_16x16x32_bf16 v[120:123], v[32:35], a[8:11], 0
v_mfma_f32_16x16x32_bf16 v[124:127], v[32:35], a[12:15], 0
s_waitcnt lgkmcnt(4)
v_mfma_f32_16x16x32_bf16 v[128:131], v[36:39], a[0:3], 0
ds_read_b64_tr_b16 v[32:33], v11 offset:8192
v_cvt_pk_bf16_f32 v48, v48, v49
v_mfma_f32_16x16x32_bf16 v[132:135], v[36:39], a[4:7], 0
ds_read_b64_tr_b16 v[34:35], v11 offset:8448
v_cvt_pk_bf16_f32 v49, v50, v51
v_mfma_f32_16x16x32_bf16 v[136:139], v[36:39], a[8:11], 0
v_cvt_pk_bf16_f32 v50, v64, v65
v_cvt_pk_bf16_f32 v51, v66, v67
v_mfma_f32_16x16x32_bf16 v[140:143], v[36:39], a[12:15], 0
s_add_u32 s46, s53, 14336
buffer_store_dwordx4 v[48:51], v1, s[36:39], s46 offen sc1
v_cvt_pk_bf16_f32 v52, v52, v53
s_waitcnt lgkmcnt(4)
v_mfma_f32_16x16x32_bf16 v[112:115], v[40:43], a[16:19], v[112:115]
ds_read_b64_tr_b16 v[36:37], v12 offset:8192
v_cvt_pk_bf16_f32 v53, v54, v55
v_mfma_f32_16x16x32_bf16 v[116:119], v[40:43], a[20:23], v[116:119]
ds_read_b64_tr_b16 v[38:39], v12 offset:8448
v_cvt_pk_bf16_f32 v54, v68, v69
v_mfma_f32_16x16x32_bf16 v[120:123], v[40:43], a[24:27], v[120:123]
v_cvt_pk_bf16_f32 v55, v70, v71
s_add_u32 s46, s53, 32768
buffer_store_dwordx4 v[52:55], v1, s[36:39], s46 offen sc1
v_mfma_f32_16x16x32_bf16 v[124:127], v[40:43], a[28:31], v[124:127]
v_cvt_pk_bf16_f32 v56, v56, v57
v_cvt_pk_bf16_f32 v57, v58, v59
s_waitcnt lgkmcnt(4)
v_mfma_f32_16x16x32_bf16 v[128:131], v[44:47], a[16:19], v[128:131]
ds_read_b64_tr_b16 v[40:41], v11 offset:12288
v_cvt_pk_bf16_f32 v58, v72, v73
v_mfma_f32_16x16x32_bf16 v[132:135], v[44:47], a[20:23], v[132:135]
ds_read_b64_tr_b16 v[42:43], v11 offset:12544
v_cvt_pk_bf16_f32 v59, v74, v75
v_mfma_f32_16x16x32_bf16 v[136:139], v[44:47], a[24:27], v[136:139]
s_add_u32 s46, s53, 14336
buffer_store_dwordx4 v[56:59], v2, s[36:39], s46 offen sc1
v_cvt_pk_bf16_f32 v60, v60, v61
v_mfma_f32_16x16x32_bf16 v[140:143], v[44:47], a[28:31], v[140:143]
v_cvt_pk_bf16_f32 v61, v62, v63
v_cvt_pk_bf16_f32 v62, v76, v77
s_waitcnt lgkmcnt(4)
v_mfma_f32_16x16x32_bf16 v[112:115], v[32:35], a[32:35], v[112:115]
ds_read_b64_tr_b16 v[44:45], v12 offset:12288
v_cvt_pk_bf16_f32 v63, v78, v79
v_mfma_f32_16x16x32_bf16 v[116:119], v[32:35], a[36:39], v[116:119]
ds_read_b64_tr_b16 v[46:47], v12 offset:12544
s_add_u32 s46, s53, 32768
buffer_store_dwordx4 v[60:63], v2, s[36:39], s46 offen sc1
v_mfma_f32_16x16x32_bf16 v[120:123], v[32:35], a[40:43], v[120:123]
s_add_u32 s88, s68, 9447424
buffer_load_dwordx4 a[244:247], v26, s[36:39], s88 offen sc1
s_add_u32 s88, s68, 18884608
buffer_load_dwordx4 a[248:251], v26, s[36:39], s88 offen sc1
v_mfma_f32_16x16x32_bf16 v[124:127], v[32:35], a[44:47], v[124:127]
s_waitcnt lgkmcnt(4)
v_mfma_f32_16x16x32_bf16 v[128:131], v[36:39], a[32:35], v[128:131]
ds_read_b64_tr_b16 v[32:33], v11 offset:16384
v_mfma_f32_16x16x32_bf16 v[132:135], v[36:39], a[36:39], v[132:135]
ds_read_b64_tr_b16 v[34:35], v11 offset:16640
v_mfma_f32_16x16x32_bf16 v[136:139], v[36:39], a[40:43], v[136:139]
v_mfma_f32_16x16x32_bf16 v[140:143], v[36:39], a[44:47], v[140:143]
s_waitcnt lgkmcnt(4)
v_mfma_f32_16x16x32_bf16 v[112:115], v[40:43], a[48:51], v[112:115]
ds_read_b64_tr_b16 v[36:37], v12 offset:16384
s_add_u32 s88, s68, 28321792
buffer_load_dwordx4 a[252:255], v26, s[36:39], s88 offen sc1
v_mfma_f32_16x16x32_bf16 v[116:119], v[40:43], a[52:55], v[116:119]
ds_read_b64_tr_b16 v[38:39], v12 offset:16640
v_mfma_f32_16x16x32_bf16 v[120:123], v[40:43], a[56:59], v[120:123]
v_mfma_f32_16x16x32_bf16 v[124:127], v[40:43], a[60:63], v[124:127]
s_waitcnt lgkmcnt(4)
v_mfma_f32_16x16x32_bf16 v[128:131], v[44:47], a[48:51], v[128:131]
ds_read_b64_tr_b16 v[40:41], v11 offset:20480
v_mfma_f32_16x16x32_bf16 v[132:135], v[44:47], a[52:55], v[132:135]
ds_read_b64_tr_b16 v[42:43], v11 offset:20736
v_mfma_f32_16x16x32_bf16 v[136:139], v[44:47], a[56:59], v[136:139]
v_mfma_f32_16x16x32_bf16 v[140:143], v[44:47], a[60:63], v[140:143]
s_waitcnt lgkmcnt(4)
v_mfma_f32_16x16x32_bf16 v[112:115], v[32:35], a[64:67], v[112:115]
ds_read_b64_tr_b16 v[44:45], v12 offset:20480
s_waitcnt vmcnt(16)
v_mfma_f32_16x16x32_bf16 v[88:91], v[184:187], a[224:227], v[160:163]
v_mfma_f32_16x16x32_bf16 v[116:119], v[32:35], a[68:71], v[116:119]
ds_read_b64_tr_b16 v[46:47], v12 offset:20736
v_mfma_f32_16x16x32_bf16 v[120:123], v[32:35], a[72:75], v[120:123]
v_mfma_f32_16x16x32_bf16 v[124:127], v[32:35], a[76:79], v[124:127]
s_waitcnt lgkmcnt(4)
v_mfma_f32_16x16x32_bf16 v[128:131], v[36:39], a[64:67], v[128:131]
s_waitcnt lgkmcnt(0)
s_barrier
ds_read_b64_tr_b16 v[32:33], v11 offset:24576
s_waitcnt vmcnt(11)
v_mfma_f32_16x16x32_bf16 v[88:91], v[184:187], a[228:231], v[88:91]
v_mfma_f32_16x16x32_bf16 v[132:135], v[36:39], a[68:71], v[132:135]
ds_read_b64_tr_b16 v[34:35], v11 offset:24832
v_mfma_f32_16x16x32_bf16 v[136:139], v[36:39], a[72:75], v[136:139]
v_mfma_f32_16x16x32_bf16 v[140:143], v[36:39], a[76:79], v[140:143]
v_mfma_f32_16x16x32_bf16 v[112:115], v[40:43], a[80:83], v[112:115]
ds_read_b64_tr_b16 v[36:37], v12 offset:24576
s_waitcnt vmcnt(10)
v_mfma_f32_16x16x32_bf16 v[88:91], v[184:187], a[232:235], v[88:91]
v_mfma_f32_16x16x32_bf16 v[116:119], v[40:43], a[84:87], v[116:119]
ds_read_b64_tr_b16 v[38:39], v12 offset:24832
v_mfma_f32_16x16x32_bf16 v[120:123], v[40:43], a[88:91], v[120:123]
v_mfma_f32_16x16x32_bf16 v[124:127], v[40:43], a[92:95], v[124:127]
v_mfma_f32_16x16x32_bf16 v[128:131], v[44:47], a[80:83], v[128:131]
ds_read_b64_tr_b16 v[40:41], v11 offset:28672
s_waitcnt vmcnt(9)
v_mfma_f32_16x16x32_bf16 v[88:91], v[184:187], a[236:239], v[88:91]
v_mfma_f32_16x16x32_bf16 v[132:135], v[44:47], a[84:87], v[132:135]
ds_read_b64_tr_b16 v[42:43], v11 offset:28928
v_mfma_f32_16x16x32_bf16 v[136:139], v[44:47], a[88:91], v[136:139]
v_mfma_f32_16x16x32_bf16 v[140:143], v[44:47], a[92:95], v[140:143]
s_waitcnt lgkmcnt(4)
v_mfma_f32_16x16x32_bf16 v[112:115], v[32:35], a[96:99], v[112:115]
ds_read_b64_tr_b16 v[44:45], v12 offset:28672
v_mfma_f32_16x16x32_bf16 v[116:119], v[32:35], a[100:103], v[116:119]
ds_read_b64_tr_b16 v[46:47], v12 offset:28928
v_mfma_f32_16x16x32_bf16 v[120:123], v[32:35], a[104:107], v[120:123]
v_mfma_f32_16x16x32_bf16 v[124:127], v[32:35], a[108:111], v[124:127]
s_waitcnt lgkmcnt(4)
v_mfma_f32_16x16x32_bf16 v[128:131], v[36:39], a[96:99], v[128:131]
ds_read_b64_tr_b16 v[32:33], v11 offset:32768
v_mfma_f32_16x16x32_bf16 v[132:135], v[36:39], a[100:103], v[132:135]
ds_read_b64_tr_b16 v[34:35], v11 offset:33024
v_mfma_f32_16x16x32_bf16 v[136:139], v[36:39], a[104:107], v[136:139]
v_mfma_f32_16x16x32_bf16 v[140:143], v[36:39], a[108:111], v[140:143]
s_waitcnt lgkmcnt(4)
v_mfma_f32_16x16x32_bf16 v[112:115], v[40:43], a[112:115], v[112:115]
ds_read_b64_tr_b16 v[36:37], v12 offset:32768
v_cmp_u_f32 vcc, v88, v88
s_cbranch_vccnz L1_rs4
L1_rb4:
v_mfma_f32_16x16x32_bf16 v[116:119], v[40:43], a[116:119], v[116:119]
ds_read_b64_tr_b16 v[38:39], v12 offset:33024
v_mfma_f32_16x16x32_bf16 v[120:123], v[40:43], a[120:123], v[120:123]
v_mfma_f32_16x16x32_bf16 v[124:127], v[40:43], a[124:127], v[124:127]
s_waitcnt lgkmcnt(4)
v_mfma_f32_16x16x32_bf16 v[128:131], v[44:47], a[112:115], v[128:131]
ds_read_b64_tr_b16 v[40:41], v11 offset:36864
v_mfma_f32_16x16x32_bf16 v[132:135], v[44:47], a[116:119], v[132:135]
ds_read_b64_tr_b16 v[42:43], v11 offset:37120
v_mfma_f32_16x16x32_bf16 v[136:139], v[44:47], a[120:123], v[136:139]
v_mfma_f32_16x16x32_bf16 v[140:143], v[44:47], a[124:127], v[140:143]
s_waitcnt lgkmcnt(4)
v_mfma_f32_16x16x32_bf16 v[112:115], v[32:35], a[128:131], v[112:115]
ds_read_b64_tr_b16 v[44:45], v12 offset:36864
v_mfma_f32_16x16x32_bf16 v[116:119], v[32:35], a[132:135], v[116:119]
ds_read_b64_tr_b16 v[46:47], v12 offset:37120
v_mfma_f32_16x16x32_bf16 v[120:123], v[32:35], a[136:139], v[120:123]
v_mfma_f32_16x16x32_bf16 v[124:127], v[32:35], a[140:143], v[124:127]
s_waitcnt lgkmcnt(4)
v_mfma_f32_16x16x32_bf16 v[128:131], v[36:39], a[128:131], v[128:131]
ds_read_b64_tr_b16 v[32:33], v3 offset:40960
v_mfma_f32_16x16x32_bf16 v[132:135], v[36:39], a[132:135], v[132:135]
v_mfma_f32_16x16x32_bf16 v[136:139], v[36:39], a[136:139], v[136:139]
v_mfma_f32_16x16x32_bf16 v[140:143], v[36:39], a[140:143], v[140:143]
s_waitcnt lgkmcnt(3)
v_mfma_f32_16x16x32_bf16 v[112:115], v[40:43], a[144:147], v[112:115]
ds_read_b64_tr_b16 v[36:37], v3 offset:40992
v_mfma_f32_16x16x32_bf16 v[116:119], v[40:43], a[148:151], v[116:119]
v_mfma_f32_16x16x32_bf16 v[120:123], v[40:43], a[152:155], v[120:123]
v_mfma_f32_16x16x32_bf16 v[124:127], v[40:43], a[156:159], v[124:127]
s_waitcnt lgkmcnt(2)
v_mfma_f32_16x16x32_bf16 v[128:131], v[44:47], a[144:147], v[128:131]
v_mfma_f32_16x16x32_bf16 v[132:135], v[44:47], a[148:151], v[132:135]
v_mfma_f32_16x16x32_bf16 v[136:139], v[44:47], a[152:155], v[136:139]
v_mfma_f32_16x16x32_bf16 v[140:143], v[44:47], a[156:159], v[140:143]
s_waitcnt lgkmcnt(1)
v_mfma_f32_16x16x16_bf16 v[112:115], v[32:33], v[144:145], v[112:115]
v_mfma_f32_16x16x16_bf16 v[116:119], v[32:33], v[146:147], v[116:119]
v_mfma_f32_16x16x16_bf16 v[120:123], v[32:33], v[148:149], v[120:123]
v_mfma_f32_16x16x16_bf16 v[124:127], v[32:33], v[150:151], v[124:127]
s_waitcnt lgkmcnt(0)
v_mfma_f32_16x16x16_bf16 v[128:131], v[36:37], v[144:145], v[128:131]
v_mfma_f32_16x16x16_bf16 v[132:135], v[36:37], v[146:147], v[132:135]
v_mfma_f32_16x16x16_bf16 v[136:139], v[36:37], v[148:149], v[136:139]
v_mfma_f32_16x16x16_bf16 v[140:143], v[36:37], v[150:151], v[140:143]
v_cvt_pk_bf16_f32 v112, v112, v113
v_cvt_pk_bf16_f32 v113, v114, v115
s_nop 2
v_cvt_pk_bf16_f32 v114, v128, v129
v_cvt_pk_bf16_f32 v115, v130, v131
s_add_u32 s46, s53, 16384
buffer_store_dwordx4 v[112:115], v1, s[36:39], s46 offen sc1
v_cvt_pk_bf16_f32 v116, v116, v117
v_cvt_pk_bf16_f32 v117, v118, v119
v_cvt_pk_bf16_f32 v118, v132, v133
v_cvt_pk_bf16_f32 v119, v134, v135
s_add_u32 s46, s53, 34816
buffer_store_dwordx4 v[116:119], v1, s[36:39], s46 offen sc1
v_cvt_pk_bf16_f32 v120, v120, v121
v_cvt_pk_bf16_f32 v121, v122, v123
v_cvt_pk_bf16_f32 v122, v136, v137
v_cvt_pk_bf16_f32 v123, v138, v139
s_add_u32 s46, s53, 16384
buffer_store_dwordx4 v[120:123], v2, s[36:39], s46 offen sc1
v_cvt_pk_bf16_f32 v124, v124, v125
v_cvt_pk_bf16_f32 v125, v126, v127
v_cvt_pk_bf16_f32 v126, v140, v141
v_cvt_pk_bf16_f32 v127, v142, v143
s_add_u32 s46, s53, 34816
buffer_store_dwordx4 v[124:127], v2, s[36:39], s46 offen sc1
s_add_u32 s88, s68, 12288
buffer_load_dwordx4 v[192:195], v26, s[36:39], s88 offen sc1
s_add_u32 s88, s68, 9449472
buffer_load_dwordx4 v[196:199], v26, s[36:39], s88 offen sc1
s_add_u32 s88, s68, 18886656
buffer_load_dwordx4 v[200:203], v26, s[36:39], s88 offen sc1
s_add_u32 s88, s68, 28323840
buffer_load_dwordx4 v[204:207], v26, s[36:39], s88 offen sc1
s_waitcnt vmcnt(15)
v_mfma_f32_16x16x32_bf16 v[160:163], v[188:191], a[240:243], v[88:91]
s_waitcnt vmcnt(10)
v_mfma_f32_16x16x32_bf16 v[160:163], v[188:191], a[244:247], v[160:163]
s_waitcnt vmcnt(9)
v_mfma_f32_16x16x32_bf16 v[160:163], v[188:191], a[248:251], v[160:163]
s_waitcnt vmcnt(8)
v_mfma_f32_16x16x32_bf16 v[160:163], v[188:191], a[252:255], v[160:163]
s_nop 7
v_cmp_u_f32 vcc, v160, v160
s_cbranch_vccnz L1_rs5
L1_rb5:
v_cvt_pk_bf16_f32 v160, v160, v161
v_cvt_pk_bf16_f32 v161, v162, v163
buffer_store_dwordx2 v[160:161], v31, s[96:99], s69 offen offset:512
s_add_u32 s88, s68, 14336
buffer_load_dwordx4 v[208:211], v26, s[36:39], s88 offen sc1
s_add_u32 s88, s68, 9451520
buffer_load_dwordx4 v[212:215], v26, s[36:39], s88 offen sc1
s_add_u32 s88, s68, 18888704
buffer_load_dwordx4 v[216:219], v26, s[36:39], s88 offen sc1
s_add_u32 s88, s68, 28325888
buffer_load_dwordx4 v[220:223], v26, s[36:39], s88 offen sc1
s_waitcnt vmcnt(8)
v_mfma_f32_16x16x32_bf16 v[92:95], v[184:187], v[192:195], v[164:167]
s_waitcnt vmcnt(7)
v_mfma_f32_16x16x32_bf16 v[92:95], v[184:187], v[196:199], v[92:95]
s_waitcnt vmcnt(6)
v_mfma_f32_16x16x32_bf16 v[92:95], v[184:187], v[200:203], v[92:95]
s_waitcnt vmcnt(5)
v_mfma_f32_16x16x32_bf16 v[92:95], v[184:187], v[204:207], v[92:95]
s_nop 7
v_cmp_u_f32 vcc, v92, v92
s_cbranch_vccnz L1_rs6
L1_rb6:
s_waitcnt vmcnt(3)
v_mfma_f32_16x16x32_bf16 v[164:167], v[188:191], v[208:211], v[92:95]
s_waitcnt vmcnt(2)
v_mfma_f32_16x16x32_bf16 v[164:167], v[188:191], v[212:215], v[164:167]
s_waitcnt vmcnt(1)
v_mfma_f32_16x16x32_bf16 v[164:167], v[188:191], v[216:219], v[164:167]
s_waitcnt vmcnt(0)
v_mfma_f32_16x16x32_bf16 v[164:167], v[188:191], v[220:223], v[164:167]
s_add_u32 s88, s68, 16384
buffer_load_dwordx4 v[224:227], v26, s[36:39], s88 offen sc1
s_add_u32 s88, s68, 9453568
buffer_load_dwordx4 v[228:231], v26, s[36:39], s88 offen sc1
s_add_u32 s88, s68, 18890752
buffer_load_dwordx4 v[232:235], v26, s[36:39], s88 offen sc1
s_add_u32 s88, s68, 28327936
buffer_load_dwordx4 v[236:239], v26, s[36:39], s88 offen sc1
v_cmp_u_f32 vcc, v164, v164
s_cbranch_vccnz L1_rs7
L1_rb7:
v_cvt_pk_bf16_f32 v164, v164, v165
v_cvt_pk_bf16_f32 v165, v166, v167
buffer_store_dwordx2 v[164:165], v31, s[96:99], s69 offen offset:768
s_waitcnt vmcnt(4)
v_mfma_f32_16x16x32_bf16 v[96:99], v[184:187], v[224:227], v[168:171]
s_waitcnt vmcnt(3)
v_mfma_f32_16x16x32_bf16 v[96:99], v[184:187], v[228:231], v[96:99]
s_waitcnt vmcnt(2)
v_mfma_f32_16x16x32_bf16 v[96:99], v[184:187], v[232:235], v[96:99]
s_waitcnt vmcnt(1)
v_mfma_f32_16x16x32_bf16 v[96:99], v[184:187], v[236:239], v[96:99]
s_nop 7
v_cmp_u_f32 vcc, v96, v96
s_cbranch_vccnz L1_rs8
L1_rb8:
v_cvt_pk_bf16_f32 v96, v96, v97
v_cvt_pk_bf16_f32 v97, v98, v99
s_mov_b32 exec_hi, 0
buffer_store_dwordx2 v[96:97], v31, s[96:99], s69 offen offset:1024
s_mov_b64 exec, -1
L1_end:
s_endpgm
L1_spin:
s_mov_b32 s89, 0
L1_sp2:
s_sleep 2
buffer_load_dword v192, v18, s[40:43], 0 offen sc1
s_waitcnt vmcnt(0)
v_and_b32 v192, 0x0f, v192
v_cmp_ne_u32 vcc, s71, v192
s_add_u32 s89, s89, 1
s_cbranch_vccz L1_back
s_cmp_lt_u32 s89, 200000
s_cbranch_scc1 L1_sp2
s_branch L1_back
L1_h2:
s_mov_b32 s89, 0
L1_h2l:
buffer_load_dwordx4 v[192:195], v19, s[36:39], s70 offen sc1
s_waitcnt vmcnt(0)
v_max3_u32 v196, v192, v193, v194
v_max_u32 v196, v196, v195
v_cmp_eq_u32 vcc, -1, v196
s_add_u32 s89, s89, 1
s_cbranch_vccz L1_h2b
s_cmp_lt_u32 s89, 200000
s_cbranch_scc1 L1_h2l
s_branch L1_h2b
L1_spin1:
s_mov_b32 s89, 0
L1_spin1b:
s_sleep 2
buffer_load_ubyte v28, v27, s[40:43], 0 offen sc1
s_waitcnt vmcnt(0)
v_and_b32 v28, s71, v28
v_cmp_ne_u32 vcc, s71, v28
s_add_u32 s89, s89, 1
s_cbranch_vccz L1_back1
s_cmp_lt_u32 s89, 200000
s_cbranch_scc1 L1_spin1b
s_branch L1_back1
L1_rs0:
s_mov_b32 s89, 0
L1_rs0b:
s_add_u32 s88, s68, 0
buffer_load_dwordx4 a[160:163], v26, s[36:39], s88 offen sc1
s_add_u32 s88, s68, 9437184
buffer_load_dwordx4 a[164:167], v26, s[36:39], s88 offen sc1
s_add_u32 s88, s68, 18874368
buffer_load_dwordx4 a[168:171], v26, s[36:39], s88 offen sc1
s_add_u32 s88, s68, 28311552
buffer_load_dwordx4 a[172:175], v26, s[36:39], s88 offen sc1
s_waitcnt vmcnt(0)
v_mfma_f32_16x16x32_bf16 v[80:83], v[184:187], a[160:163], v[152:155]
v_mfma_f32_16x16x32_bf16 v[80:83], v[184:187], a[164:167], v[80:83]
v_mfma_f32_16x16x32_bf16 v[80:83], v[184:187], a[168:171], v[80:83]
v_mfma_f32_16x16x32_bf16 v[80:83], v[184:187], a[172:175], v[80:83]
s_nop 7
s_nop 3
v_cmp_u_f32 vcc, v80, v80
s_add_u32 s89, s89, 1
s_cbranch_vccz L1_rb0
s_cmp_lt_u32 s89, 20000
s_cbranch_scc1 L1_rs0b
s_branch L1_rb0
L1_rs1:
s_mov_b32 s89, 0
L1_rs1b:
s_add_u32 s88, s68, 2048
buffer_load_dwordx4 a[176:179], v26, s[36:39], s88 offen sc1
s_add_u32 s88, s68, 9439232
buffer_load_dwordx4 a[180:183], v26, s[36:39], s88 offen sc1
s_add_u32 s88, s68, 18876416
buffer_load_dwordx4 a[184:187], v26, s[36:39], s88 offen sc1
s_add_u32 s88, s68, 28313600
buffer_load_dwordx4 a[188:191], v26, s[36:39], s88 offen sc1
s_waitcnt vmcnt(0)
v_mfma_f32_16x16x32_bf16 v[152:155], v[188:191], a[176:179], v[80:83]
v_mfma_f32_16x16x32_bf16 v[152:155], v[188:191], a[180:183], v[152:155]
v_mfma_f32_16x16x32_bf16 v[152:155], v[188:191], a[184:187], v[152:155]
v_mfma_f32_16x16x32_bf16 v[152:155], v[188:191], a[188:191], v[152:155]
s_nop 7
s_nop 3
v_cmp_u_f32 vcc, v152, v152
s_add_u32 s89, s89, 1
s_cbranch_vccz L1_rb1
s_cmp_lt_u32 s89, 20000
s_cbranch_scc1 L1_rs1b
s_branch L1_rb1
L1_rs2:
s_mov_b32 s89, 0
L1_rs2b:
s_add_u32 s88, s68, 4096
buffer_load_dwordx4 a[192:195], v26, s[36:39], s88 offen sc1
s_add_u32 s88, s68, 9441280
buffer_load_dwordx4 a[196:199], v26, s[36:39], s88 offen sc1
s_add_u32 s88, s68, 18878464
buffer_load_dwordx4 a[200:203], v26, s[36:39], s88 offen sc1
s_add_u32 s88, s68, 28315648
buffer_load_dwordx4 a[204:207], v26, s[36:39], s88 offen sc1
s_waitcnt vmcnt(0)
v_mfma_f32_16x16x32_bf16 v[84:87], v[184:187], a[192:195], v[156:159]
v_mfma_f32_16x16x32_bf16 v[84:87], v[184:187], a[196:199], v[84:87]
v_mfma_f32_16x16x32_bf16 v[84:87], v[184:187], a[200:203], v[84:87]
v_mfma_f32_16x16x32_bf16 v[84:87], v[184:187], a[204:207], v[84:87]
s_nop 7
s_nop 3
v_cmp_u_f32 vcc, v84, v84
s_add_u32 s89, s89, 1
s_cbranch_vccz L1_rb2
s_cmp_lt_u32 s89, 20000
s_cbranch_scc1 L1_rs2b
s_branch L1_rb2
L1_rs3:
s_mov_b32 s89, 0
L1_rs3b:
s_add_u32 s88, s68, 6144
buffer_load_dwordx4 a[208:211], v26, s[36:39], s88 offen sc1
s_add_u32 s88, s68, 9443328
buffer_load_dwordx4 a[212:215], v26, s[36:39], s88 offen sc1
s_add_u32 s88, s68, 18880512
buffer_load_dwordx4 a[216:219], v26, s[36:39], s88 offen sc1
s_add_u32 s88, s68, 28317696
buffer_load_dwordx4 a[220:223], v26, s[36:39], s88 offen sc1
s_waitcnt vmcnt(0)
v_mfma_f32_16x16x32_bf16 v[156:159], v[188:191], a[208:211], v[84:87]
v_mfma_f32_16x16x32_bf16 v[156:159], v[188:191], a[212:215], v[156:159]
v_mfma_f32_16x16x32_bf16 v[156:159], v[188:191], a[216:219], v[156:159]
v_mfma_f32_16x16x32_bf16 v[156:159], v[188:191], a[220:223], v[156:159]
s_nop 7
s_nop 3
v_cmp_u_f32 vcc, v156, v156
s_add_u32 s89, s89, 1
s_cbranch_vccz L1_rb3
s_cmp_lt_u32 s89, 20000
s_cbranch_scc1 L1_rs3b
s_branch L1_rb3
L1_rs4:
s_mov_b32 s89, 0
L1_rs4b:
s_add_u32 s88, s68, 8192
buffer_load_dwordx4 a[224:227], v26, s[36:39], s88 offen sc1
s_add_u32 s88, s68, 9445376
buffer_load_dwordx4 a[228:231], v26, s[36:39], s88 offen sc1
s_add_u32 s88, s68, 18882560
buffer_load_dwordx4 a[232:235], v26, s[36:39], s88 offen sc1
s_add_u32 s88, s68, 28319744
buffer_load_dwordx4 a[236:239], v26, s[36:39], s88 offen sc1
s_waitcnt vmcnt(0)
v_mfma_f32_16x16x32_bf16 v[88:91], v[184:187], a[224:227], v[160:163]
v_mfma_f32_16x16x32_bf16 v[88:91], v[184:187], a[228:231], v[88:91]
v_mfma_f32_16x16x32_bf16 v[88:91], v[184:187], a[232:235], v[88:91]
v_mfma_f32_16x16x32_bf16 v[88:91], v[184:187], a[236:239], v[88:91]
s_nop 7
s_nop 3
v_cmp_u_f32 vcc, v88, v88
s_add_u32 s89, s89, 1
s_cbranch_vccz L1_rb4
s_cmp_lt_u32 s89, 20000
s_cbranch_scc1 L1_rs4b
s_branch L1_rb4
L1_rs5:
s_mov_b32 s89, 0
L1_rs5b:
s_add_u32 s88, s68, 10240
buffer_load_dwordx4 a[240:243], v26, s[36:39], s88 offen sc1
s_add_u32 s88, s68, 9447424
buffer_load_dwordx4 a[244:247], v26, s[36:39], s88 offen sc1
s_add_u32 s88, s68, 18884608
buffer_load_dwordx4 a[248:251], v26, s[36:39], s88 offen sc1
s_add_u32 s88, s68, 28321792
buffer_load_dwordx4 a[252:255], v26, s[36:39], s88 offen sc1
s_waitcnt vmcnt(0)
v_mfma_f32_16x16x32_bf16 v[160:163], v[188:191], a[240:243], v[88:91]
v_mfma_f32_16x16x32_bf16 v[160:163], v[188:191], a[244:247], v[160:163]
v_mfma_f32_16x16x32_bf16 v[160:163], v[188:191], a[248:251], v[160:163]
v_mfma_f32_16x16x32_bf16 v[160:163], v[188:191], a[252:255], v[160:163]
s_nop 7
s_nop 3
v_cmp_u_f32 vcc, v160, v160
s_add_u32 s89, s89, 1
s_cbranch_vccz L1_rb5
s_cmp_lt_u32 s89, 20000
s_cbranch_scc1 L1_rs5b
s_branch L1_rb5
L1_rs6:
s_mov_b32 s89, 0
L1_rs6b:
s_add_u32 s88, s68, 12288
buffer_load_dwordx4 v[192:195], v26, s[36:39], s88 offen sc1
s_add_u32 s88, s68, 9449472
buffer_load_dwordx4 v[196:199], v26, s[36:39], s88 offen sc1
s_add_u32 s88, s68, 18886656
buffer_load_dwordx4 v[200:203], v26, s[36:39], s88 offen sc1
s_add_u32 s88, s68, 28323840
buffer_load_dwordx4 v[204:207], v26, s[36:39], s88 offen sc1
s_waitcnt vmcnt(0)
v_mfma_f32_16x16x32_bf16 v[92:95], v[184:187], v[192:195], v[164:167]
v_mfma_f32_16x16x32_bf16 v[92:95], v[184:187], v[196:199], v[92:95]
v_mfma_f32_16x16x32_bf16 v[92:95], v[184:187], v[200:203], v[92:95]
v_mfma_f32_16x16x32_bf16 v[92:95], v[184:187], v[204:207], v[92:95]
s_nop 7
s_nop 3
v_cmp_u_f32 vcc, v92, v92
s_add_u32 s89, s89, 1
s_cbranch_vccz L1_rb6
s_cmp_lt_u32 s89, 20000
s_cbranch_scc1 L1_rs6b
s_branch L1_rb6
L1_rs7:
s_mov_b32 s89, 0
L1_rs7b:
s_add_u32 s88, s68, 14336
buffer_load_dwordx4 v[208:211], v26, s[36:39], s88 offen sc1
s_add_u32 s88, s68, 9451520
buffer_load_dwordx4 v[212:215], v26, s[36:39], s88 offen sc1
s_add_u32 s88, s68, 18888704
buffer_load_dwordx4 v[216:219], v26, s[36:39], s88 offen sc1
s_add_u32 s88, s68, 28325888
buffer_load_dwordx4 v[220:223], v26, s[36:39], s88 offen sc1
s_waitcnt vmcnt(0)
v_mfma_f32_16x16x32_bf16 v[164:167], v[188:191], v[208:211], v[92:95]
v_mfma_f32_16x16x32_bf16 v[164:167], v[188:191], v[212:215], v[164:167]
v_mfma_f32_16x16x32_bf16 v[164:167], v[188:191], v[216:219], v[164:167]
v_mfma_f32_16x16x32_bf16 v[164:167], v[188:191], v[220:223], v[164:167]
s_nop 7
s_nop 3
v_cmp_u_f32 vcc, v164, v164
s_add_u32 s89, s89, 1
s_cbranch_vccz L1_rb7
s_cmp_lt_u32 s89, 20000
s_cbranch_scc1 L1_rs7b
s_branch L1_rb7
L1_rs8:
s_mov_b32 s89, 0
L1_rs8b:
s_add_u32 s88, s68, 16384
buffer_load_dwordx4 v[224:227], v26, s[36:39], s88 offen sc1
s_add_u32 s88, s68, 9453568
buffer_load_dwordx4 v[228:231], v26, s[36:39], s88 offen sc1
s_add_u32 s88, s68, 18890752
buffer_load_dwordx4 v[232:235], v26, s[36:39], s88 offen sc1
s_add_u32 s88, s68, 28327936
buffer_load_dwordx4 v[236:239], v26, s[36:39], s88 offen sc1
s_waitcnt vmcnt(0)
v_mfma_f32_16x16x32_bf16 v[96:99], v[184:187], v[224:227], v[168:171]
v_mfma_f32_16x16x32_bf16 v[96:99], v[184:187], v[228:231], v[96:99]
v_mfma_f32_16x16x32_bf16 v[96:99], v[184:187], v[232:235], v[96:99]
v_mfma_f32_16x16x32_bf16 v[96:99], v[184:187], v[236:239], v[96:99]
s_nop 7
s_nop 3
v_cmp_u_f32 vcc, v96, v96
s_add_u32 s89, s89, 1
s_cbranch_vccz L1_rb8
s_cmp_lt_u32 s89, 20000
s_cbranch_scc1 L1_rs8b
s_branch L1_rb8
L1_cend:
.section .rodata,"a"
.p2align 6
.amdhsa_kernel parallel_sum__linear_attn_block__glu_gated_reglu__prompt_kernel
  .amdhsa_next_free_vgpr 512
  .amdhsa_next_free_sgpr 102
  .amdhsa_accum_offset 256
  .amdhsa_group_segment_fixed_size 0
  .amdhsa_kernarg_size 80
  .amdhsa_user_sgpr_count 2
  .amdhsa_user_sgpr_kernarg_segment_ptr 1
  .amdhsa_system_sgpr_workgroup_id_x 1
.end_amdhsa_kernel
```
